```python
import torch

def _softmax(x, axis=-1):
    return torch.softmax(x, dim=axis)
def _gelu(x):
    return torch.nn.functional.gelu(x, approximate="tanh")
def _silu(x):
    return torch.nn.functional.silu(x)
def _sigmoid(x):
    return torch.sigmoid(x)
def _layernorm(x, axis=-1, eps=1e-5):
    m = x.mean(dim=axis, keepdim=True)
    v = x.var(dim=axis, keepdim=True, unbiased=False)
    return (x - m) / torch.sqrt(v + eps)
def _scatter_add(tgt, idx, src, axis=0):
    return tgt.clone().index_add_(axis, idx, src)
def _segment_sum(src, seg, n):
    out = torch.zeros((n,) + src.shape[1:], dtype=src.dtype)
    return out.index_add_(0, seg, src)
def _pad(x, pw):
    flat = tuple(v for pair in reversed(pw) for v in pair)
    return torch.nn.functional.pad(x, flat)

kernel_name = 'interleave_layers__ssm_conv_h3__sliding_local_dilated__prompt'

def setup_inputs():

    _w = (lambda a: (lambda t: t.to(torch.bfloat16) if t.is_floating_point() else t)(torch.as_tensor(a)))
    def _A_setup():
        B, S, D = 1, 2048, 640
        ks = 4
        return {
            "q": _w((lambda *s: torch.randn(*s, dtype=torch.bfloat16) * 0.05)(B, S, D)),
            "k": _w((lambda *s: torch.randn(*s, dtype=torch.bfloat16) * 0.4)(B, S, D)),
            "v": _w((lambda *s: torch.randn(*s, dtype=torch.bfloat16) * 0.4)(B, S, D)),
            "shift_k": _w((lambda *s: torch.randn(*s, dtype=torch.bfloat16) * 0.4)(D, ks) * 0.5),
            "ssm_k": _w((lambda *s: torch.randn(*s, dtype=torch.bfloat16) * 0.4)(D, S) * (1.0 / S ** 0.5)),
            "ssm_D": _w((lambda *s: torch.randn(*s, dtype=torch.bfloat16) * 0.4)(D)),
        }
    _A_in = _A_setup()

    def _B_setup():
        B, S, D = 1, 2048, 640
        return {
            "x": _w((lambda *s: torch.randn(*s, dtype=torch.bfloat16) * 0.05)(B, S, D)),
            "wqkv": _w((lambda *s: torch.randn(*s, dtype=torch.bfloat16) * 0.05)(D, 3 * D)),
            "wo": _w((lambda *s: torch.randn(*s, dtype=torch.bfloat16) * 0.05)(D, D)),
        }
    _B_in = _B_setup()

    return {
        "A_q": _A_in["q"],
        "A_k": _A_in["k"],
        "A_v": _A_in["v"],
        "A_shift_k": _A_in["shift_k"],
        "A_ssm_k": _A_in["ssm_k"],
        "A_ssm_D": _A_in["ssm_D"],
        "B_x": _B_in["x"],
        "B_wqkv": _B_in["wqkv"],
        "B_wo": _B_in["wo"],
    }

def reference(A_q, A_k, A_v, A_shift_k, A_ssm_k, A_ssm_D, B_x, B_wqkv, B_wo):
    def _A_ref(q, k, v, shift_k, ssm_k, ssm_D):
        B, S, D = q.shape
        ks = shift_k.shape[-1]
        k_pad = _pad(k, ((0, 0), (ks - 1, 0), (0, 0)))
        k_shift = torch.zeros_like(k)
        for t in range(ks):
            k_shift = k_shift + k_pad[:, t:t + S, :] * shift_k[:, ks - 1 - t][None, None, :]
        kv = k_shift * v
        L = 2 * S
        kv_pad = _pad(kv, ((0, 0), (0, S), (0, 0)))
        kf_pad = _pad(ssm_k, ((0, 0), (0, S)))
        kv_f = (lambda x, axes=(-2,-1): torch.fft.rfft2(x.float(), dim=axes))(kv_pad[:, None, :, :], axes=(1, 2))
        kf_f = (lambda x, axes=(-2,-1): torch.fft.rfft2(x.float(), dim=axes))(kf_pad[:, None, :], axes=(1, 2))
        kf_f = (lambda x, *d: x.permute(*d))(kf_f, 1, 2, 0)
        y_f = kv_f * kf_f[None, :, :, :]
        y = (lambda x, s, axes=(-2,-1): torch.fft.irfft2(x, s=s, dim=axes).to(torch.bfloat16))(y_f, (1, L), axes=(1, 2))[:, 0, :S, :]
        y = y + kv * ssm_D[None, None, :]
        return q * y

    def _B_ref(x, wqkv, wo):
        B, S, D = x.shape
        H = 32; Dh = D // H
        W, dil = 8, 2
        qkv = (lambda x, *d: x.permute(*d))((x @ wqkv).reshape(B, S, 3, H, Dh), 2, 0, 3, 1, 4)
        q, k, v = qkv[0], qkv[1], qkv[2]
        scale = Dh ** -0.5
        pos = torch.arange(S)
        off = torch.arange(W) * dil
        idx = pos[:, None] - off[None, :]
        mask = idx >= 0
        idx_c = torch.where(mask, idx, 0).reshape(-1)
        kg = k[:, :, idx_c, :].reshape(B, H, S, W, Dh)
        vg = v[:, :, idx_c, :].reshape(B, H, S, W, Dh)
        logits = torch.einsum("bhsd,bhswd->bhsw", q, kg) * scale
        logits = torch.where(mask[None, None, :, :], logits, -1e9)
        attn = _softmax(logits, axis=-1)
        o = torch.einsum("bhsw,bhswd->bhsd", attn, vg)
        return (lambda x, *d: x.permute(*d))(o, 0, 2, 1, 3).reshape(B, S, D) @ wo

    x = A_q
    x = x + _A_ref(_layernorm(x, axis=-1), A_k, A_v, A_shift_k, A_ssm_k, A_ssm_D)
    x = x + _B_ref(_layernorm(x, axis=-1), B_wqkv, B_wo)
    x = x + _A_ref(_layernorm(x, axis=-1), A_k, A_v, A_shift_k, A_ssm_k, A_ssm_D)
    x = x + _B_ref(_layernorm(x, axis=-1), B_wqkv, B_wo)
    return x
```

```asm
; @launch grid=(256,1,1) block=(256,1,1) lds=163840
.amdgcn_target "amdgcn-amd-amdhsa--gfx950"
.text
.set CODE_BYTES, MEGA_LAST - MEGA_PC
.globl interleave_layers__ssm_conv_h3__sliding_local_dilated__prompt_kernel
.p2align 8
.type interleave_layers__ssm_conv_h3__sliding_local_dilated__prompt_kernel,@function
interleave_layers__ssm_conv_h3__sliding_local_dilated__prompt_kernel:
    s_cmp_ge_u32 s2, 256
    s_cbranch_scc1 MEGA_END
    s_load_dwordx16 s[4:19], s[0:1], 0
    s_load_dwordx8 s[20:27], s[0:1], 64
    v_lshrrev_b32 v1, 6, v0
    s_nop 0
    v_readfirstlane_b32 s3, v1
    v_and_b32 v1, 63, v0
    v_and_b32 v2, 15, v1
    v_lshrrev_b32 v3, 4, v1
    v_lshlrev_b32 v4, 4, v1
    s_getpc_b64 s[52:53]
MEGA_PC:
    s_lshr_b32 s49, s2, 3
    s_lshl_b32 s49, s49, 2
    s_add_u32 s49, s49, s3
    s_lshl_b32 s49, s49, 11
    v_and_b32 v5, 15, v1
    v_lshl_add_u32 v5, v5, 7, s49
    v_min_u32 v5, CODE_BYTES, v5
    global_load_dword v255, v5, s[52:53]
    s_and_b32 s49, s2, 7
    s_lshr_b32 s50, s2, 3
    s_sub_u32 s51, s50, 12
    s_lshr_b32 s51, s51, 1
    s_add_u32 s51, s51, 12
    s_cmp_lt_u32 s50, 12
    s_cselect_b32 s46, s50, s51
    s_and_b32 s51, s50, 1
    s_cselect_b32 s51, s51, s51
    s_cmp_lt_u32 s50, 12
    s_cselect_b32 s51, 0, s51
    s_sub_u32 s52, s50, 20
    s_cmp_ge_u32 s50, 20
    s_cselect_b32 s46, s52, s46
    s_cselect_b32 s51, 1, s51
    s_lshl_b32 s45, s49, 1
    s_add_u32 s45, s45, s51
    s_lshl_b32 s47, s49, 2
    s_and_b32 s51, s50, 3
    s_add_u32 s47, s47, s51
    s_lshr_b32 s48, s50, 2
    s_waitcnt lgkmcnt(0)
    s_mov_b32 s28, s26
    s_mov_b32 s29, s27
    s_mov_b32 s30, 0x1900000
    s_mov_b32 s31, 0x20000
    s_mov_b32 s49, 0xb4c000
    s_load_dword s44, s[26:27], s49
    s_cmp_ge_u32 s2, 160
    s_cbranch_scc1 MEGA_HELPER
    s_lshr_b32 s65, s2, 4
    s_lshl_b32 s65, s65, 3
    s_and_b32 s49, s2, 7
    s_add_u32 s65, s65, s49
    s_lshl_b32 s65, s65, 1
    s_bfe_u32 s49, s2, 0x10003
    s_add_u32 s65, s65, s49
    s_lshl_b32 s66, s65, 2
    s_add_u32 s66, s66, s3
    s_mul_i32 s67, s3, 21248
    s_lshr_b32 s49, s66, 1
    s_lshl_b32 s49, s49, 2
    s_load_dword s64, s[14:15], s49
    s_mov_b32 s32, s6
    s_mov_b32 s33, s7
    s_mov_b32 s34, 0x280000
    s_mov_b32 s35, 0x20000
    s_mov_b32 s36, s8
    s_mov_b32 s37, s9
    s_mov_b32 s38, 0x280000
    s_mov_b32 s39, 0x20000
    s_mov_b32 s40, s10
    s_mov_b32 s41, s11
    s_mov_b32 s42, 0x1400
    s_mov_b32 s43, 0x20000
    s_and_b32 s49, s2, 31
    s_lshl_b32 s49, s49, 6
    s_lshr_b32 s50, s2, 5
    s_lshl_b32 s51, s50, 7
    v_lshrrev_b32 v9, 3, v1
    v_and_b32 v10, 7, v1
    s_add_u32 s52, s3, 0
    s_and_b32 s53, s52, 7
    s_lshl_b32 s54, s52, 3
    v_xor_b32 v11, s53, v10
    v_lshl_add_u32 v11, v11, 4, s51
    v_add_u32 v12, s54, v9
    s_sub_u32 s55, s49, 3
    v_add_u32 v13, s55, v12
    v_mul_i32_i24 v14, 1280, v13
    v_add_u32 v14, v14, v11
    v_cmp_gt_u32 vcc, 67, v12
    v_cmp_le_i32 s[56:57], 0, v13
    s_nop 1
    s_and_b64 vcc, vcc, s[56:57]
    v_mov_b32 v17, 0x7ff00000
    v_cndmask_b32 v14, v17, v14, vcc
    s_lshl_b32 s52, s52, 10
    s_add_u32 m0, s52, 99328
    s_nop 0
    buffer_load_dwordx4 v14, s[32:35], 0 offen lds
    s_add_u32 s52, s3, 4
    s_and_b32 s53, s52, 7
    s_lshl_b32 s54, s52, 3
    v_xor_b32 v11, s53, v10
    v_lshl_add_u32 v11, v11, 4, s51
    v_add_u32 v12, s54, v9
    s_sub_u32 s55, s49, 3
    v_add_u32 v13, s55, v12
    v_mul_i32_i24 v15, 1280, v13
    v_add_u32 v15, v15, v11
    v_cmp_gt_u32 vcc, 67, v12
    v_cmp_le_i32 s[56:57], 0, v13
    s_nop 1
    s_and_b64 vcc, vcc, s[56:57]
    v_mov_b32 v17, 0x7ff00000
    v_cndmask_b32 v15, v17, v15, vcc
    s_lshl_b32 s52, s52, 10
    s_add_u32 m0, s52, 99328
    s_nop 0
    buffer_load_dwordx4 v15, s[32:35], 0 offen lds
    s_add_u32 s52, s3, 8
    s_and_b32 s53, s52, 7
    s_lshl_b32 s54, s52, 3
    v_xor_b32 v11, s53, v10
    v_lshl_add_u32 v11, v11, 4, s51
    v_add_u32 v12, s54, v9
    s_sub_u32 s55, s49, 3
    v_add_u32 v13, s55, v12
    v_mul_i32_i24 v16, 1280, v13
    v_add_u32 v16, v16, v11
    v_cmp_gt_u32 vcc, 67, v12
    v_cmp_le_i32 s[56:57], 0, v13
    s_nop 1
    s_and_b64 vcc, vcc, s[56:57]
    v_mov_b32 v17, 0x7ff00000
    v_cndmask_b32 v16, v17, v16, vcc
    s_lshl_b32 s52, s52, 10
    s_add_u32 m0, s52, 99328
    s_nop 0
    buffer_load_dwordx4 v16, s[32:35], 0 offen lds
    s_add_u32 s52, s3, 0
    s_lshl_b32 s54, s52, 3
    v_xor_b32 v11, s52, v10
    v_lshl_add_u32 v11, v11, 4, s51
    s_add_u32 s54, s54, s49
    v_add_u32 v13, s54, v9
    v_mul_u32_u24 v14, 1280, v13
    v_add_u32 v14, v14, v11
    s_lshl_b32 s52, s52, 10
    s_add_u32 m0, s52, 111616
    s_nop 0
    buffer_load_dwordx4 v14, s[36:39], 0 offen lds
    s_add_u32 s52, s3, 4
    s_lshl_b32 s54, s52, 3
    v_xor_b32 v11, s52, v10
    v_lshl_add_u32 v11, v11, 4, s51
    s_add_u32 s54, s54, s49
    v_add_u32 v13, s54, v9
    v_mul_u32_u24 v15, 1280, v13
    v_add_u32 v15, v15, v11
    s_lshl_b32 s52, s52, 10
    s_add_u32 m0, s52, 111616
    s_nop 0
    buffer_load_dwordx4 v15, s[36:39], 0 offen lds
    s_and_b32 s49, s2, 31
    s_lshl_b32 s49, s49, 6
    s_lshr_b32 s50, s2, 5
    v_and_b32 v11, 7, v0
    v_lshrrev_b32 v12, 3, v0
    s_lshl_b32 s51, s50, 5
    v_add_u32 v13, s51, v12
    v_lshlrev_b32 v14, 4, v13
    buffer_load_dwordx4 v[24:27], v14, s[40:43], 0 offen
    v_lshl_add_u32 v8, v11, 3, s49
    v_lshlrev_b32 v8, 1, v8
    v_sub_u32 v8, 4080, v8
    v_lshl_add_u32 v8, v13, 13, v8
    v_lshrrev_b32 v14, 2, v12
    v_and_b32 v12, 3, v12
    v_lshlrev_b32 v12, 2, v12
    v_xor_b32 v9, v14, v11
    v_lshl_add_u32 v9, v9, 4, v12
    v_lshl_add_u32 v9, v11, 10, v9
    v_add_u32 v11, 1, v11
    v_and_b32 v13, 7, v11
    v_xor_b32 v10, v14, v13
    v_lshl_add_u32 v10, v10, 4, v12
    v_lshl_add_u32 v10, v11, 10, v10
    s_lshl_b32 s49, s66, 12
    v_add_u32 v5, s49, v4
    s_add_u32 s63, s67, 16640
    v_mov_b32 v6, 0
    v_mov_b32 v7, 0
    v_lshl_add_u32 v14, v1, 3, s63
    ds_write_b64 v14, v[6:7] offset:4096
    v_add_u32 v14, 1, v2
    v_and_b32 v15, 3, v14
    v_mul_u32_u24 v204, 4160, v15
    v_sub_u32 v14, v14, v15
    v_lshl_add_u32 v204, v14, 1, v204
    v_lshl_add_u32 v204, v3, 4, v204
    v_add_u32 v204, s67, v204
    v_lshlrev_b32 v205, 5, v2
    v_lshlrev_b32 v14, 4, v3
    v_sub_u32 v205, v14, v205
    s_add_u32 s49, s63, 480
    v_add_u32 v205, s49, v205
    v_add_u32 v170, s67, v4
    s_waitcnt lgkmcnt(0)
    s_mul_i32 s44, s44, 0x9E3779B1
    s_add_u32 s44, s44, 0x7F4A7C15
    s_cmp_lg_u32 s3, 0
    s_cbranch_scc1 NOXID_1
    s_getreg_b32 s49, hwreg(HW_REG_XCC_ID, 0, 4)
    s_and_b32 s50, s2, 7
    s_lshl_b32 s50, s50, 5
    s_lshr_b32 s51, s2, 3
    s_add_u32 s50, s50, s51
    s_lshl_b32 s50, s50, 3
    s_add_u32 s50, s50, 0xb78000
    v_mov_b32 v250, s50
    v_mov_b32 v252, s44
    v_mov_b32 v253, s49
    s_mov_b64 exec, 1
    buffer_store_dwordx2 v[252:253], v250, s[28:31], 0 offen sc1
    s_mov_b64 exec, -1
NOXID_1:
    v_lshrrev_b32 v184, 2, v2
    s_mul_i32 s49, s3, 160
    s_cmp_eq_u32 s3, 3
    s_cselect_b32 s49, 325, s49
    v_add_u32 v185, s49, v184
    v_and_b32 v186, 1, v184
    v_mul_u32_u24 v186, 5, v186
    v_lshrrev_b32 v187, 1, v184
    v_mul_u32_u24 v187, 160, v187
    v_add3_u32 v186, v186, v187, 4
    s_cmp_eq_u32 s3, 2
    s_cselect_b64 s[52:53], -1, 0
    v_cndmask_b32 v250, v185, v186, s[52:53]
    s_mul_i32 s49, s3, 160
    s_add_u32 s50, s49, 5
    s_cmp_eq_u32 s3, 2
    s_cselect_b32 s49, s49, s50
    v_add_u32 v185, s49, v184
    v_mul_u32_u24 v186, 5, v184
    v_add_u32 v186, 324, v186
    s_cmp_eq_u32 s3, 3
    s_cselect_b64 s[52:53], -1, 0
    v_cndmask_b32 v251, v185, v186, s[52:53]
    s_mul_i32 s49, s46, 10
    v_lshlrev_b32 v184, 6, v3
    v_and_b32 v185, 3, v2
    v_lshl_add_u32 v184, v185, 4, v184
    v_add_u32 v184, 0x780000, v184
    v_add_u32 v250, s49, v250
    v_lshl_add_u32 v250, v250, 8, v184
    v_add_u32 v251, s49, v251
    v_lshl_add_u32 v251, v251, 8, v184
    v_cmp_le_u32 vcc, 8, v2
    s_nop 1
    s_and_b64 vcc, vcc, s[52:53]
    v_mov_b32 v187, 0x7ff00000
    v_cndmask_b32 v251, v251, v187, vcc
    s_mul_i32 s61, s2, 20480
    s_cmp_ge_u32 s2, 128
    s_cselect_b32 s61, 0x7ff00000, s61
    s_lshl_b32 s59, s3, 6
    s_add_u32 s49, s59, 0
    v_add_u32 v192, s49, v1
    v_mul_u32_u24 v190, 52429, v192
    v_lshrrev_b32 v190, 22, v190
    v_mul_u32_u24 v191, 80, v190
    v_sub_u32 v192, v192, v191
    v_and_b32 v191, 14, v190
    v_xor_b32 v192, v192, v191
    v_mul_u32_u24 v190, 1280, v190
    v_lshl_add_u32 v192, v192, 4, v190
    v_add_u32 v192, s61, v192
    s_add_u32 s49, s59, 256
    v_add_u32 v193, s49, v1
    v_mul_u32_u24 v190, 52429, v193
    v_lshrrev_b32 v190, 22, v190
    v_mul_u32_u24 v191, 80, v190
    v_sub_u32 v193, v193, v191
    v_and_b32 v191, 14, v190
    v_xor_b32 v193, v193, v191
    v_mul_u32_u24 v190, 1280, v190
    v_lshl_add_u32 v193, v193, 4, v190
    v_add_u32 v193, s61, v193
    s_add_u32 s49, s59, 512
    v_add_u32 v194, s49, v1
    v_mul_u32_u24 v190, 52429, v194
    v_lshrrev_b32 v190, 22, v190
    v_mul_u32_u24 v191, 80, v190
    v_sub_u32 v194, v194, v191
    v_and_b32 v191, 14, v190
    v_xor_b32 v194, v194, v191
    v_mul_u32_u24 v190, 1280, v190
    v_lshl_add_u32 v194, v194, 4, v190
    v_add_u32 v194, s61, v194
    s_add_u32 s49, s59, 768
    v_add_u32 v195, s49, v1
    v_mul_u32_u24 v190, 52429, v195
    v_lshrrev_b32 v190, 22, v190
    v_mul_u32_u24 v191, 80, v190
    v_sub_u32 v195, v195, v191
    v_and_b32 v191, 14, v190
    v_xor_b32 v195, v195, v191
    v_mul_u32_u24 v190, 1280, v190
    v_lshl_add_u32 v195, v195, 4, v190
    v_add_u32 v195, s61, v195
    s_add_u32 s49, s59, 1024
    v_add_u32 v196, s49, v1
    v_mul_u32_u24 v190, 52429, v196
    v_lshrrev_b32 v190, 22, v190
    v_mul_u32_u24 v191, 80, v190
    v_sub_u32 v196, v196, v191
    v_and_b32 v191, 14, v190
    v_xor_b32 v196, v196, v191
    v_mul_u32_u24 v190, 1280, v190
    v_lshl_add_u32 v196, v196, 4, v190
    v_add_u32 v196, s61, v196
    s_and_b32 s49, s66, 1
    s_lshl_b32 s49, s49, 4
    s_lshr_b32 s64, s64, s49
    s_and_b32 s64, s64, 0xffff
    v_sub_u32 v176, 15, v2
    v_lshrrev_b32 v177, 3, v176
    v_and_b32 v176, 7, v176
    v_and_b32 v178, 1, v176
    v_lshlrev_b32 v178, 4, v178
    v_lshlrev_b32 v178, v178, s64
    v_lshrrev_b32 v176, 1, v176
    v_mov_b32 v179, 64
    v_cmp_eq_u32 vcc, v177, v3
    s_nop 1
    v_cndmask_b32 v176, v179, v176, vcc
    v_cmp_eq_u32 vcc, 0, v176
    s_nop 1
    v_cndmask_b32 v200, 0, v178, vcc
    v_cmp_eq_u32 vcc, 1, v176
    s_nop 1
    v_cndmask_b32 v201, 0, v178, vcc
    v_cmp_eq_u32 vcc, 2, v176
    s_nop 1
    v_cndmask_b32 v202, 0, v178, vcc
    v_cmp_eq_u32 vcc, 3, v176
    s_nop 1
    v_cndmask_b32 v203, 0, v178, vcc
    v_lshrrev_b32 v14, 1, v1
    v_mul_u32_u24 v14, 4160, v14
    v_and_b32 v15, 1, v1
    v_lshl_add_u32 v14, v15, 4, v14
    v_add_u32 v207, s67, v14
    v_lshrrev_b32 v14, 3, v0
    v_and_b32 v15, 7, v0
    v_lshlrev_b32 v206, 4, v0
    v_add_u32 v206, 0xb70000, v206
    v_mul_u32_u24 v199, 20480, v14
    v_lshl_add_u32 v199, v15, 4, v199
    s_lshl_b32 s49, s65, 7
    v_add_u32 v199, s49, v199
    s_waitcnt vmcnt(0)
    s_barrier
    s_mov_b32 s32, s4
    s_mov_b32 s33, s5
    s_mov_b32 s34, 0x280000
    s_mov_b32 s35, 0x20000
    s_lshl_b32 s59, s3, 10
    s_add_u32 m0, s59, 120832
    s_nop 0
    buffer_load_dwordx4 v192, s[32:35], 0 offen lds
    s_add_u32 m0, s59, 124928
    s_nop 0
    buffer_load_dwordx4 v193, s[32:35], 0 offen lds
    s_add_u32 m0, s59, 129024
    s_nop 0
    buffer_load_dwordx4 v194, s[32:35], 0 offen lds
    s_add_u32 m0, s59, 133120
    s_nop 0
    buffer_load_dwordx4 v195, s[32:35], 0 offen lds
    s_add_u32 m0, s59, 137216
    s_nop 0
    buffer_load_dwordx4 v196, s[32:35], 0 offen lds
    v_add_u32 v9, 65536, v9
    v_add_u32 v10, 65536, v10
    ds_read_b32 v28, v9 offset:33792
    ds_read_b32 v29, v9 offset:33920
    ds_read_b32 v30, v9 offset:34048
    ds_read_b32 v31, v9 offset:34176
    ds_read_b32 v32, v9 offset:34304
    ds_read_b32 v33, v9 offset:34432
    ds_read_b32 v34, v9 offset:34560
    ds_read_b32 v35, v9 offset:34688
    ds_read_b32 v36, v10 offset:33792
    ds_read_b32 v37, v10 offset:33920
    ds_read_b32 v38, v10 offset:34048
    ds_read_b32 v39, v9 offset:46080
    ds_read_b32 v40, v9 offset:46208
    ds_read_b32 v41, v9 offset:46336
    ds_read_b32 v42, v9 offset:46464
    ds_read_b32 v43, v9 offset:46592
    ds_read_b32 v44, v9 offset:46720
    ds_read_b32 v45, v9 offset:46848
    ds_read_b32 v46, v9 offset:46976
    s_waitcnt lgkmcnt(0)
    s_mov_b32 s49, 0xffff0000
    v_lshlrev_b32 v56, 16, v24
    v_lshlrev_b32 v57, 16, v26
    v_and_b32 v58, s49, v24
    v_and_b32 v59, s49, v26
    v_lshlrev_b32 v60, 16, v25
    v_lshlrev_b32 v61, 16, v27
    v_and_b32 v62, s49, v25
    v_and_b32 v63, s49, v27
    v_lshlrev_b32 v64, 16, v28
    v_and_b32 v65, s49, v28
    v_lshlrev_b32 v66, 16, v29
    v_and_b32 v67, s49, v29
    v_lshlrev_b32 v68, 16, v30
    v_and_b32 v69, s49, v30
    v_lshlrev_b32 v70, 16, v31
    v_and_b32 v71, s49, v31
    v_lshlrev_b32 v72, 16, v32
    v_and_b32 v73, s49, v32
    v_lshlrev_b32 v74, 16, v33
    v_and_b32 v75, s49, v33
    v_lshlrev_b32 v76, 16, v34
    v_and_b32 v77, s49, v34
    v_lshlrev_b32 v78, 16, v35
    v_and_b32 v79, s49, v35
    v_lshlrev_b32 v80, 16, v36
    v_and_b32 v81, s49, v36
    v_lshlrev_b32 v82, 16, v37
    v_and_b32 v83, s49, v37
    v_lshlrev_b32 v84, 16, v38
    v_and_b32 v85, s49, v38
    v_pk_mul_f32 v[86:87], v[70:71], v[56:57]
    v_pk_mul_f32 v[88:89], v[72:73], v[56:57]
    v_pk_mul_f32 v[90:91], v[74:75], v[56:57]
    v_pk_mul_f32 v[92:93], v[76:77], v[56:57]
    v_pk_mul_f32 v[94:95], v[78:79], v[56:57]
    v_pk_mul_f32 v[96:97], v[80:81], v[56:57]
    v_pk_mul_f32 v[98:99], v[82:83], v[56:57]
    v_pk_mul_f32 v[100:101], v[84:85], v[56:57]
    v_pk_fma_f32 v[86:87], v[68:69], v[58:59], v[86:87]
    v_pk_fma_f32 v[88:89], v[70:71], v[58:59], v[88:89]
    v_pk_fma_f32 v[90:91], v[72:73], v[58:59], v[90:91]
    v_pk_fma_f32 v[92:93], v[74:75], v[58:59], v[92:93]
    v_pk_fma_f32 v[94:95], v[76:77], v[58:59], v[94:95]
    v_pk_fma_f32 v[96:97], v[78:79], v[58:59], v[96:97]
    v_pk_fma_f32 v[98:99], v[80:81], v[58:59], v[98:99]
    v_pk_fma_f32 v[100:101], v[82:83], v[58:59], v[100:101]
    v_pk_fma_f32 v[86:87], v[66:67], v[60:61], v[86:87]
    v_pk_fma_f32 v[88:89], v[68:69], v[60:61], v[88:89]
    v_pk_fma_f32 v[90:91], v[70:71], v[60:61], v[90:91]
    v_pk_fma_f32 v[92:93], v[72:73], v[60:61], v[92:93]
    v_pk_fma_f32 v[94:95], v[74:75], v[60:61], v[94:95]
    v_pk_fma_f32 v[96:97], v[76:77], v[60:61], v[96:97]
    v_pk_fma_f32 v[98:99], v[78:79], v[60:61], v[98:99]
    v_pk_fma_f32 v[100:101], v[80:81], v[60:61], v[100:101]
    v_pk_fma_f32 v[86:87], v[64:65], v[62:63], v[86:87]
    v_pk_fma_f32 v[88:89], v[66:67], v[62:63], v[88:89]
    v_pk_fma_f32 v[90:91], v[68:69], v[62:63], v[90:91]
    v_pk_fma_f32 v[92:93], v[70:71], v[62:63], v[92:93]
    v_pk_fma_f32 v[94:95], v[72:73], v[62:63], v[94:95]
    v_pk_fma_f32 v[96:97], v[74:75], v[62:63], v[96:97]
    v_pk_fma_f32 v[98:99], v[76:77], v[62:63], v[98:99]
    v_pk_fma_f32 v[100:101], v[78:79], v[62:63], v[100:101]
    v_lshlrev_b32 v64, 16, v39
    v_and_b32 v65, s49, v39
    v_lshlrev_b32 v66, 16, v40
    v_and_b32 v67, s49, v40
    v_lshlrev_b32 v68, 16, v41
    v_and_b32 v69, s49, v41
    v_lshlrev_b32 v70, 16, v42
    v_and_b32 v71, s49, v42
    v_lshlrev_b32 v72, 16, v43
    v_and_b32 v73, s49, v43
    v_lshlrev_b32 v74, 16, v44
    v_and_b32 v75, s49, v44
    v_lshlrev_b32 v76, 16, v45
    v_and_b32 v77, s49, v45
    v_lshlrev_b32 v78, 16, v46
    v_and_b32 v79, s49, v46
    v_pk_mul_f32 v[86:87], v[86:87], v[64:65]
    v_pk_mul_f32 v[88:89], v[88:89], v[66:67]
    v_pk_mul_f32 v[90:91], v[90:91], v[68:69]
    v_pk_mul_f32 v[92:93], v[92:93], v[70:71]
    v_pk_mul_f32 v[94:95], v[94:95], v[72:73]
    v_pk_mul_f32 v[96:97], v[96:97], v[74:75]
    v_pk_mul_f32 v[98:99], v[98:99], v[76:77]
    v_pk_mul_f32 v[100:101], v[100:101], v[78:79]
    v_cvt_pk_bf16_f32 v102, v100, v98
    v_cvt_pk_bf16_f32 v103, v96, v94
    v_cvt_pk_bf16_f32 v104, v92, v90
    v_cvt_pk_bf16_f32 v105, v88, v86
    v_cvt_pk_bf16_f32 v106, v101, v99
    v_cvt_pk_bf16_f32 v107, v97, v95
    v_cvt_pk_bf16_f32 v108, v93, v91
    v_cvt_pk_bf16_f32 v109, v89, v87
    v_add_u32 v11, 4096, v8
    buffer_store_dwordx4 v[102:105], v8, s[28:31], 0 offen sc1
    buffer_store_dwordx4 v[106:109], v11, s[28:31], 0 offen sc1
    s_mov_b32 s40, s12
    s_mov_b32 s41, s13
    s_mov_b32 s42, 0x280000
    s_mov_b32 s43, 0x20000
    s_mul_i32 s62, s3, 4224
    s_add_u32 s62, s62, 141312
    s_mov_b32 m0, s62
    s_nop 0
    buffer_load_dwordx4 v5, s[40:43], 0 offen offset:0 lds
    buffer_load_dwordx4 v5, s[40:43], 0 offen offset:1024 lds
    buffer_load_dwordx4 v5, s[40:43], 0 offen offset:2048 lds
    buffer_load_dwordx4 v5, s[40:43], 0 offen offset:3072 lds
    s_waitcnt vmcnt(4)
    s_barrier
    s_cmp_lg_u32 s3, 0
    s_cbranch_scc1 NOFLAG_2
    s_lshl_b32 s49, s2, 2
    s_add_u32 s49, s49, 0xb40000
    v_mov_b32 v14, s49
    v_mov_b32 v15, s44
    s_mov_b64 exec, 1
    buffer_store_dword v15, v14, s[28:31], 0 offen sc1
    s_mov_b64 exec, -1
NOFLAG_2:
    v_add_u32 v17, s62, v4
    v_lshrrev_b32 v12, 4, v0
    v_mul_u32_u24 v10, 1280, v12
    v_lshl_add_u32 v10, v2, 4, v10
    v_add_u32 v10, 120832, v10
    v_and_b32 v9, 7, v0
    v_mul_u32_u24 v11, 2560, v9
    v_lshlrev_b32 v9, 1, v9
    v_lshrrev_b32 v8, 4, v0
    v_xor_b32 v8, v8, v9
    v_lshl_add_u32 v11, v8, 4, v11
    v_bfe_u32 v8, v0, 3, 1
    v_lshl_add_u32 v11, v8, 3, v11
    v_add_u32 v11, 120832, v11
    s_mul_i32 s61, s2, 20480
    s_add_u32 s61, s61, 0x280000
    s_cmp_ge_u32 s2, 128
    s_cselect_b32 s61, 0x7ff00000, s61
    v_lshl_add_u32 v8, v0, 4, s61
    s_lshl_b32 s61, s2, 7
    s_add_u32 s61, s61, 0xb70000
    s_cmp_ge_u32 s2, 128
    s_cselect_b32 s61, 0x7ff00000, s61
    v_lshl_add_u32 v12, v12, 3, s61
    v_mov_b32 v19, 0x7ff00000
    v_cmp_eq_u32 vcc, 0, v2
    s_nop 1
    v_cndmask_b32 v12, v19, v12, vcc
    s_mov_b32 s60, 0x3f803f80
    ds_read_b128 v[24:27], v10 offset:0
    ds_read_b128 v[28:31], v10 offset:256
    ds_read_b128 v[32:35], v10 offset:512
    ds_read_b128 v[36:39], v10 offset:768
    ds_read_b128 v[40:43], v10 offset:1024
    ds_read_b64 v[44:45], v11 offset:0
    ds_read_b64 v[46:47], v11 offset:1280
    ds_read_b64 v[48:49], v11 offset:256
    ds_read_b64 v[50:51], v11 offset:1536
    ds_read_b64 v[52:53], v11 offset:512
    ds_read_b64 v[54:55], v11 offset:1792
    ds_read_b64 v[56:57], v11 offset:768
    ds_read_b64 v[58:59], v11 offset:2048
    ds_read_b64 v[60:61], v11 offset:1024
    ds_read_b64 v[62:63], v11 offset:2304
    v_mov_b32 v20, 0
    v_mov_b32 v21, 0
    v_mov_b32 v22, 0
    v_mov_b32 v23, 0
    s_waitcnt lgkmcnt(10)
    v_dot2_f32_bf16 v20, v24, s60, v20
    v_dot2_f32_bf16 v21, v24, v24, v21
    v_dot2_f32_bf16 v22, v25, s60, v22
    v_dot2_f32_bf16 v23, v25, v25, v23
    v_dot2_f32_bf16 v20, v26, s60, v20
    v_dot2_f32_bf16 v21, v26, v26, v21
    v_dot2_f32_bf16 v22, v27, s60, v22
    v_dot2_f32_bf16 v23, v27, v27, v23
    v_dot2_f32_bf16 v20, v28, s60, v20
    v_dot2_f32_bf16 v21, v28, v28, v21
    v_dot2_f32_bf16 v22, v29, s60, v22
    v_dot2_f32_bf16 v23, v29, v29, v23
    v_dot2_f32_bf16 v20, v30, s60, v20
    v_dot2_f32_bf16 v21, v30, v30, v21
    v_dot2_f32_bf16 v22, v31, s60, v22
    v_dot2_f32_bf16 v23, v31, v31, v23
    v_dot2_f32_bf16 v20, v32, s60, v20
    v_dot2_f32_bf16 v21, v32, v32, v21
    v_dot2_f32_bf16 v22, v33, s60, v22
    v_dot2_f32_bf16 v23, v33, v33, v23
    v_dot2_f32_bf16 v20, v34, s60, v20
    v_dot2_f32_bf16 v21, v34, v34, v21
    v_dot2_f32_bf16 v22, v35, s60, v22
    v_dot2_f32_bf16 v23, v35, v35, v23
    v_dot2_f32_bf16 v20, v36, s60, v20
    v_dot2_f32_bf16 v21, v36, v36, v21
    v_dot2_f32_bf16 v22, v37, s60, v22
    v_dot2_f32_bf16 v23, v37, v37, v23
    v_dot2_f32_bf16 v20, v38, s60, v20
    v_dot2_f32_bf16 v21, v38, v38, v21
    v_dot2_f32_bf16 v22, v39, s60, v22
    v_dot2_f32_bf16 v23, v39, v39, v23
    v_dot2_f32_bf16 v20, v40, s60, v20
    v_dot2_f32_bf16 v21, v40, v40, v21
    v_dot2_f32_bf16 v22, v41, s60, v22
    v_dot2_f32_bf16 v23, v41, v41, v23
    v_dot2_f32_bf16 v20, v42, s60, v20
    v_dot2_f32_bf16 v21, v42, v42, v21
    v_dot2_f32_bf16 v22, v43, s60, v22
    v_dot2_f32_bf16 v23, v43, v43, v23
    s_waitcnt lgkmcnt(0)
    s_mov_b32 s49, 0
    buffer_store_dwordx4 v[44:47], v8, s[28:31], s49 offen sc1
    s_mov_b32 s49, 4096
    buffer_store_dwordx4 v[48:51], v8, s[28:31], s49 offen sc1
    s_mov_b32 s49, 8192
    buffer_store_dwordx4 v[52:55], v8, s[28:31], s49 offen sc1
    s_mov_b32 s49, 12288
    buffer_store_dwordx4 v[56:59], v8, s[28:31], s49 offen sc1
    s_mov_b32 s49, 16384
    buffer_store_dwordx4 v[60:63], v8, s[28:31], s49 offen sc1
    v_add_f32 v20, v20, v22
    v_add_f32 v21, v21, v23
    s_nop 0
    v_add_f32_dpp v20, v20, v20 row_ror:8 row_mask:0xf bank_mask:0xf
    v_add_f32_dpp v21, v21, v21 row_ror:8 row_mask:0xf bank_mask:0xf
    s_nop 0
    v_add_f32_dpp v20, v20, v20 row_ror:4 row_mask:0xf bank_mask:0xf
    v_add_f32_dpp v21, v21, v21 row_ror:4 row_mask:0xf bank_mask:0xf
    s_nop 0
    v_add_f32_dpp v20, v20, v20 row_ror:2 row_mask:0xf bank_mask:0xf
    v_add_f32_dpp v21, v21, v21 row_ror:2 row_mask:0xf bank_mask:0xf
    s_nop 0
    v_add_f32_dpp v20, v20, v20 row_ror:1 row_mask:0xf bank_mask:0xf
    v_add_f32_dpp v21, v21, v21 row_ror:1 row_mask:0xf bank_mask:0xf
    v_mul_f32 v20, 0xbacccccd, v20
    v_mov_b32 v22, 0x3727c5ac
    v_fmac_f32 v22, 0x3acccccd, v21
    v_fma_f32 v22, -v20, v20, v22
    v_max_f32 v22, 0x3727c5ac, v22
    v_rsq_f32 v21, v22
    buffer_store_dwordx2 v[20:21], v12, s[28:31], 0 offen sc1
    s_waitcnt vmcnt(6)
    ds_read_b128 v[128:131], v17 offset:0
    ds_read_b64 v[132:133], v17 offset:16
    ds_read_b128 v[134:137], v17 offset:1024
    ds_read_b64 v[138:139], v17 offset:1040
    ds_read_b128 v[140:143], v17 offset:2048
    ds_read_b64 v[144:145], v17 offset:2064
    ds_read_b128 v[146:149], v17 offset:3072
    ds_read_b64 v[150:151], v17 offset:3088
    s_waitcnt lgkmcnt(6)
    v_readfirstlane_b32 s50, v128
    v_readfirstlane_b32 s51, v129
    ds_write_b128 v170, v[128:131] offset:32
    v_mov_b32 v152, v129
    v_mov_b32 v153, v130
    v_mov_b32 v154, v131
    v_mov_b32 v155, v132
    v_alignbit_b32 v180, v129, v128, 16
    v_alignbit_b32 v181, v130, v129, 16
    v_alignbit_b32 v182, v131, v130, 16
    v_alignbit_b32 v183, v132, v131, 16
    v_alignbit_b32 v184, v130, v129, 16
    v_alignbit_b32 v185, v131, v130, 16
    v_alignbit_b32 v186, v132, v131, 16
    v_alignbit_b32 v187, v133, v132, 16
    ds_write_b128 v170, v[152:155] offset:8352
    ds_write_b128 v170, v[180:183] offset:4192
    ds_write_b128 v170, v[184:187] offset:12512
    s_waitcnt lgkmcnt(8)
    ds_write_b128 v170, v[134:137] offset:1056
    v_mov_b32 v156, v135
    v_mov_b32 v157, v136
    v_mov_b32 v158, v137
    v_mov_b32 v159, v138
    v_alignbit_b32 v188, v135, v134, 16
    v_alignbit_b32 v189, v136, v135, 16
    v_alignbit_b32 v190, v137, v136, 16
    v_alignbit_b32 v191, v138, v137, 16
    v_alignbit_b32 v192, v136, v135, 16
    v_alignbit_b32 v193, v137, v136, 16
    v_alignbit_b32 v194, v138, v137, 16
    v_alignbit_b32 v195, v139, v138, 16
    ds_write_b128 v170, v[156:159] offset:9376
    ds_write_b128 v170, v[188:191] offset:5216
    ds_write_b128 v170, v[192:195] offset:13536
    s_waitcnt lgkmcnt(10)
    ds_write_b128 v170, v[140:143] offset:2080
    v_mov_b32 v160, v141
    v_mov_b32 v161, v142
    v_mov_b32 v162, v143
    v_mov_b32 v163, v144
    v_alignbit_b32 v180, v141, v140, 16
    v_alignbit_b32 v181, v142, v141, 16
    v_alignbit_b32 v182, v143, v142, 16
    v_alignbit_b32 v183, v144, v143, 16
    v_alignbit_b32 v184, v142, v141, 16
    v_alignbit_b32 v185, v143, v142, 16
    v_alignbit_b32 v186, v144, v143, 16
    v_alignbit_b32 v187, v145, v144, 16
    ds_write_b128 v170, v[160:163] offset:10400
    ds_write_b128 v170, v[180:183] offset:6240
    ds_write_b128 v170, v[184:187] offset:14560
    s_waitcnt lgkmcnt(12)
    ds_write_b128 v170, v[146:149] offset:3104
    v_mov_b32 v164, v147
    v_mov_b32 v165, v148
    v_mov_b32 v166, v149
    v_mov_b32 v167, v150
    v_alignbit_b32 v188, v147, v146, 16
    v_alignbit_b32 v189, v148, v147, 16
    v_alignbit_b32 v190, v149, v148, 16
    v_alignbit_b32 v191, v150, v149, 16
    v_alignbit_b32 v192, v148, v147, 16
    v_alignbit_b32 v193, v149, v148, 16
    v_alignbit_b32 v194, v150, v149, 16
    v_alignbit_b32 v195, v151, v150, 16
    ds_write_b128 v170, v[164:167] offset:11424
    ds_write_b128 v170, v[188:191] offset:7264
    ds_write_b128 v170, v[192:195] offset:15584
    s_lshl_b32 s52, s50, 16
    s_lshr_b32 s53, s50, 16
    s_lshl_b32 s54, s51, 16
    s_or_b32 s53, s53, s54
    v_mov_b32 v13, v199
    v_mov_b32 v196, 0
    v_mov_b32 v197, 0
    v_mov_b32 v198, 0
    v_mov_b32 v199, 0
    v_writelane_b32 v198, s52, 7
    v_writelane_b32 v199, s52, 3
    v_writelane_b32 v199, s50, 5
    v_writelane_b32 v199, s53, 7
    s_mov_b64 exec, 0xff
    ds_write_b128 v207, v[196:199]
    s_mov_b64 exec, -1
    s_lshr_b32 s58, s65, 4
    s_lshl_b32 s58, s58, 5
    s_waitcnt vmcnt(0)
    s_barrier
    s_cmp_ge_u32 s2, 128
    s_cbranch_scc1 NOFB_3
    s_cmp_lg_u32 s3, 0
    s_cbranch_scc1 NOFLAG_4
    s_lshl_b32 s49, s2, 2
    s_add_u32 s49, s49, 0xb44000
    v_mul_u32_u24 v14, 2048, v1
    v_add_u32 v14, s49, v14
    v_mov_b32 v15, s44
    s_mov_b64 exec, 255
    buffer_store_dword v15, v14, s[28:31], 0 offen sc1
    s_mov_b64 exec, -1
NOFLAG_4:
NOFB_3:
    s_cmp_lg_u32 s3, 0
    s_cbranch_scc1 POLLDONE_5
    s_lshl_b32 s49, s58, 2
    s_add_u32 s49, s49, 0xb40000
    v_add_u32 v16, 0, v1
    v_min_u32 v16, 31, v16
    v_lshl_add_u32 v16, v16, 2, s49
    s_mov_b32 s51, 0x8000
POLL_6:
    buffer_load_dword v17, v16, s[28:31], 0 offen sc1
    s_waitcnt vmcnt(0)
    v_cmp_ne_u32 vcc, s44, v17
    s_nop 1
    s_cbranch_vccz POLLDONE_5
    s_sleep 2
    s_sub_u32 s51, s51, 1
    s_cmp_lg_u32 s51, 0
    s_cbranch_scc1 POLL_6
POLLDONE_5:
    s_barrier
    s_mov_b32 m0, s63
    s_mov_b32 s49, 0x0
    buffer_load_dwordx4 v5, s[28:31], s49 offen offset:0 sc1 lds
    buffer_load_dwordx4 v5, s[28:31], s49 offen offset:1024 sc1 lds
    buffer_load_dwordx4 v5, s[28:31], s49 offen offset:2048 sc1 lds
    buffer_load_dwordx4 v5, s[28:31], s49 offen offset:3072 sc1 lds
    s_waitcnt vmcnt(0)
    s_waitcnt lgkmcnt(0)
    ds_read_b64 v[64:65], v204 offset:0
    ds_read_b64 v[66:67], v204 offset:8
    ds_read_b128 v[96:99], v205 offset:3584
    ds_read_b128 v[100:103], v205 offset:3072
    ds_read_b128 v[104:107], v205 offset:2560
    ds_read_b128 v[108:111], v205 offset:2048
    ds_read_b128 v[112:115], v205 offset:1536
    ds_read_b128 v[116:119], v205 offset:1024
    ds_read_b128 v[120:123], v205 offset:512
    ds_read_b128 v[124:127], v205 offset:0
    ds_read_b64 v[68:69], v204 offset:512
    ds_read_b64 v[70:71], v204 offset:520
    ds_read_b64 v[72:73], v204 offset:1024
    ds_read_b64 v[74:75], v204 offset:1032
    ds_read_b64 v[76:77], v204 offset:1536
    ds_read_b64 v[78:79], v204 offset:1544
    ds_read_b64 v[80:81], v204 offset:2048
    ds_read_b64 v[82:83], v204 offset:2056
    ds_read_b64 v[84:85], v204 offset:2560
    ds_read_b64 v[86:87], v204 offset:2568
    ds_read_b64 v[88:89], v204 offset:3072
    ds_read_b64 v[90:91], v204 offset:3080
    ds_read_b64 v[92:93], v204 offset:3584
    ds_read_b64 v[94:95], v204 offset:3592
    s_waitcnt lgkmcnt(0)
    v_mfma_f32_16x16x32_bf16 v[16:19], v[200:203], v[96:99], 0
    v_mfma_f32_16x16x32_bf16 v[20:23], v[200:203], v[100:103], 0
    v_mfma_f32_16x16x32_bf16 v[24:27], v[200:203], v[104:107], 0
    v_mfma_f32_16x16x32_bf16 v[28:31], v[200:203], v[108:111], 0
    v_mfma_f32_16x16x32_bf16 v[32:35], v[200:203], v[112:115], 0
    v_mfma_f32_16x16x32_bf16 v[36:39], v[200:203], v[116:119], 0
    v_mfma_f32_16x16x32_bf16 v[40:43], v[200:203], v[120:123], 0
    v_mfma_f32_16x16x32_bf16 v[44:47], v[200:203], v[124:127], 0
    v_mfma_f32_16x16x32_bf16 v[16:19], v[64:67], v[96:99], v[16:19]
    ds_read_b64 v[128:129], v204 offset:64
    v_mfma_f32_16x16x32_bf16 v[20:23], v[64:67], v[100:103], v[20:23]
    ds_read_b64 v[130:131], v204 offset:72
    v_mfma_f32_16x16x32_bf16 v[24:27], v[64:67], v[104:107], v[24:27]
    ds_read_b128 v[160:163], v205 offset:3648
    v_mfma_f32_16x16x32_bf16 v[28:31], v[64:67], v[108:111], v[28:31]
    ds_read_b128 v[164:167], v205 offset:3136
    v_mfma_f32_16x16x32_bf16 v[32:35], v[64:67], v[112:115], v[32:35]
    ds_read_b128 v[168:171], v205 offset:2624
    v_mfma_f32_16x16x32_bf16 v[36:39], v[64:67], v[116:119], v[36:39]
    ds_read_b128 v[172:175], v205 offset:2112
    v_mfma_f32_16x16x32_bf16 v[40:43], v[64:67], v[120:123], v[40:43]
    ds_read_b128 v[176:179], v205 offset:1600
    v_mfma_f32_16x16x32_bf16 v[44:47], v[64:67], v[124:127], v[44:47]
    ds_read_b128 v[180:183], v205 offset:1088
    v_mfma_f32_16x16x32_bf16 v[20:23], v[68:71], v[96:99], v[20:23]
    ds_read_b128 v[184:187], v205 offset:576
    v_mfma_f32_16x16x32_bf16 v[24:27], v[68:71], v[100:103], v[24:27]
    ds_read_b128 v[188:191], v205 offset:64
    v_mfma_f32_16x16x32_bf16 v[28:31], v[68:71], v[104:107], v[28:31]
    ds_read_b64 v[132:133], v204 offset:576
    v_mfma_f32_16x16x32_bf16 v[32:35], v[68:71], v[108:111], v[32:35]
    ds_read_b64 v[134:135], v204 offset:584
    v_mfma_f32_16x16x32_bf16 v[36:39], v[68:71], v[112:115], v[36:39]
    ds_read_b64 v[136:137], v204 offset:1088
    v_mfma_f32_16x16x32_bf16 v[40:43], v[68:71], v[116:119], v[40:43]
    ds_read_b64 v[138:139], v204 offset:1096
    v_mfma_f32_16x16x32_bf16 v[44:47], v[68:71], v[120:123], v[44:47]
    ds_read_b64 v[140:141], v204 offset:1600
    v_mfma_f32_16x16x32_bf16 v[24:27], v[72:75], v[96:99], v[24:27]
    ds_read_b64 v[142:143], v204 offset:1608
    v_mfma_f32_16x16x32_bf16 v[28:31], v[72:75], v[100:103], v[28:31]
    ds_read_b64 v[144:145], v204 offset:2112
    v_mfma_f32_16x16x32_bf16 v[32:35], v[72:75], v[104:107], v[32:35]
    ds_read_b64 v[146:147], v204 offset:2120
    v_mfma_f32_16x16x32_bf16 v[36:39], v[72:75], v[108:111], v[36:39]
    ds_read_b64 v[148:149], v204 offset:2624
    v_mfma_f32_16x16x32_bf16 v[40:43], v[72:75], v[112:115], v[40:43]
    ds_read_b64 v[150:151], v204 offset:2632
    v_mfma_f32_16x16x32_bf16 v[44:47], v[72:75], v[116:119], v[44:47]
    ds_read_b64 v[152:153], v204 offset:3136
    v_mfma_f32_16x16x32_bf16 v[28:31], v[76:79], v[96:99], v[28:31]
    ds_read_b64 v[154:155], v204 offset:3144
    v_mfma_f32_16x16x32_bf16 v[32:35], v[76:79], v[100:103], v[32:35]
    ds_read_b64 v[156:157], v204 offset:3648
    v_mfma_f32_16x16x32_bf16 v[36:39], v[76:79], v[104:107], v[36:39]
    ds_read_b64 v[158:159], v204 offset:3656
    v_mfma_f32_16x16x32_bf16 v[40:43], v[76:79], v[108:111], v[40:43]
    v_mfma_f32_16x16x32_bf16 v[44:47], v[76:79], v[112:115], v[44:47]
    v_mfma_f32_16x16x32_bf16 v[32:35], v[80:83], v[96:99], v[32:35]
    v_mfma_f32_16x16x32_bf16 v[36:39], v[80:83], v[100:103], v[36:39]
    v_mfma_f32_16x16x32_bf16 v[40:43], v[80:83], v[104:107], v[40:43]
    v_mfma_f32_16x16x32_bf16 v[44:47], v[80:83], v[108:111], v[44:47]
    v_mfma_f32_16x16x32_bf16 v[36:39], v[84:87], v[96:99], v[36:39]
    v_mfma_f32_16x16x32_bf16 v[40:43], v[84:87], v[100:103], v[40:43]
    v_mfma_f32_16x16x32_bf16 v[44:47], v[84:87], v[104:107], v[44:47]
    v_mfma_f32_16x16x32_bf16 v[40:43], v[88:91], v[96:99], v[40:43]
    v_mfma_f32_16x16x32_bf16 v[44:47], v[88:91], v[100:103], v[44:47]
    v_mfma_f32_16x16x32_bf16 v[44:47], v[92:95], v[96:99], v[44:47]
    s_waitcnt lgkmcnt(0)
    v_mfma_f32_16x16x32_bf16 v[16:19], v[128:131], v[160:163], v[16:19]
    ds_read_b64 v[64:65], v204 offset:128
    v_mfma_f32_16x16x32_bf16 v[20:23], v[128:131], v[164:167], v[20:23]
    ds_read_b64 v[66:67], v204 offset:136
    v_mfma_f32_16x16x32_bf16 v[24:27], v[128:131], v[168:171], v[24:27]
    ds_read_b128 v[96:99], v205 offset:3712
    v_mfma_f32_16x16x32_bf16 v[28:31], v[128:131], v[172:175], v[28:31]
    ds_read_b128 v[100:103], v205 offset:3200
    v_mfma_f32_16x16x32_bf16 v[32:35], v[128:131], v[176:179], v[32:35]
    ds_read_b128 v[104:107], v205 offset:2688
    v_mfma_f32_16x16x32_bf16 v[36:39], v[128:131], v[180:183], v[36:39]
    ds_read_b128 v[108:111], v205 offset:2176
    v_mfma_f32_16x16x32_bf16 v[40:43], v[128:131], v[184:187], v[40:43]
    ds_read_b128 v[112:115], v205 offset:1664
    v_mfma_f32_16x16x32_bf16 v[44:47], v[128:131], v[188:191], v[44:47]
    ds_read_b128 v[116:119], v205 offset:1152
    v_mfma_f32_16x16x32_bf16 v[20:23], v[132:135], v[160:163], v[20:23]
    ds_read_b128 v[120:123], v205 offset:640
    v_mfma_f32_16x16x32_bf16 v[24:27], v[132:135], v[164:167], v[24:27]
    ds_read_b128 v[124:127], v205 offset:128
    v_mfma_f32_16x16x32_bf16 v[28:31], v[132:135], v[168:171], v[28:31]
    ds_read_b64 v[68:69], v204 offset:640
    v_mfma_f32_16x16x32_bf16 v[32:35], v[132:135], v[172:175], v[32:35]
    ds_read_b64 v[70:71], v204 offset:648
    v_mfma_f32_16x16x32_bf16 v[36:39], v[132:135], v[176:179], v[36:39]
    ds_read_b64 v[72:73], v204 offset:1152
    v_mfma_f32_16x16x32_bf16 v[40:43], v[132:135], v[180:183], v[40:43]
    ds_read_b64 v[74:75], v204 offset:1160
    v_mfma_f32_16x16x32_bf16 v[44:47], v[132:135], v[184:187], v[44:47]
    ds_read_b64 v[76:77], v204 offset:1664
    v_mfma_f32_16x16x32_bf16 v[24:27], v[136:139], v[160:163], v[24:27]
    ds_read_b64 v[78:79], v204 offset:1672
    v_mfma_f32_16x16x32_bf16 v[28:31], v[136:139], v[164:167], v[28:31]
    ds_read_b64 v[80:81], v204 offset:2176
    v_mfma_f32_16x16x32_bf16 v[32:35], v[136:139], v[168:171], v[32:35]
    ds_read_b64 v[82:83], v204 offset:2184
    v_mfma_f32_16x16x32_bf16 v[36:39], v[136:139], v[172:175], v[36:39]
    ds_read_b64 v[84:85], v204 offset:2688
    v_mfma_f32_16x16x32_bf16 v[40:43], v[136:139], v[176:179], v[40:43]
    ds_read_b64 v[86:87], v204 offset:2696
    v_mfma_f32_16x16x32_bf16 v[44:47], v[136:139], v[180:183], v[44:47]
    ds_read_b64 v[88:89], v204 offset:3200
    v_mfma_f32_16x16x32_bf16 v[28:31], v[140:143], v[160:163], v[28:31]
    ds_read_b64 v[90:91], v204 offset:3208
    v_mfma_f32_16x16x32_bf16 v[32:35], v[140:143], v[164:167], v[32:35]
    ds_read_b64 v[92:93], v204 offset:3712
    v_mfma_f32_16x16x32_bf16 v[36:39], v[140:143], v[168:171], v[36:39]
    ds_read_b64 v[94:95], v204 offset:3720
    v_mfma_f32_16x16x32_bf16 v[40:43], v[140:143], v[172:175], v[40:43]
    v_mfma_f32_16x16x32_bf16 v[44:47], v[140:143], v[176:179], v[44:47]
    v_mfma_f32_16x16x32_bf16 v[32:35], v[144:147], v[160:163], v[32:35]
    v_mfma_f32_16x16x32_bf16 v[36:39], v[144:147], v[164:167], v[36:39]
    v_mfma_f32_16x16x32_bf16 v[40:43], v[144:147], v[168:171], v[40:43]
    v_mfma_f32_16x16x32_bf16 v[44:47], v[144:147], v[172:175], v[44:47]
    v_mfma_f32_16x16x32_bf16 v[36:39], v[148:151], v[160:163], v[36:39]
    v_mfma_f32_16x16x32_bf16 v[40:43], v[148:151], v[164:167], v[40:43]
    v_mfma_f32_16x16x32_bf16 v[44:47], v[148:151], v[168:171], v[44:47]
    v_mfma_f32_16x16x32_bf16 v[40:43], v[152:155], v[160:163], v[40:43]
    v_mfma_f32_16x16x32_bf16 v[44:47], v[152:155], v[164:167], v[44:47]
    v_mfma_f32_16x16x32_bf16 v[44:47], v[156:159], v[160:163], v[44:47]
    s_waitcnt lgkmcnt(0)
    s_mov_b32 s49, 0xb44000
    s_and_b32 s50, s2, 7
    s_mul_i32 s50, s50, 2048
    s_add_u32 s49, s49, s50
    v_add_u32 v8, 0, v1
    v_lshl_add_u32 v8, v8, 2, s49
    v_add_u32 v9, 64, v1
    v_lshl_add_u32 v9, v9, 2, s49
    buffer_load_dword v10, v8, s[28:31], 0 offen sc1
    buffer_load_dword v11, v9, s[28:31], 0 offen sc1
    v_mfma_f32_16x16x32_bf16 v[16:19], v[64:67], v[96:99], v[16:19]
    ds_read_b64 v[128:129], v204 offset:192
    v_mfma_f32_16x16x32_bf16 v[20:23], v[64:67], v[100:103], v[20:23]
    ds_read_b64 v[130:131], v204 offset:200
    v_mfma_f32_16x16x32_bf16 v[24:27], v[64:67], v[104:107], v[24:27]
    ds_read_b128 v[160:163], v205 offset:3776
    v_mfma_f32_16x16x32_bf16 v[28:31], v[64:67], v[108:111], v[28:31]
    ds_read_b128 v[164:167], v205 offset:3264
    v_mfma_f32_16x16x32_bf16 v[32:35], v[64:67], v[112:115], v[32:35]
    ds_read_b128 v[168:171], v205 offset:2752
    v_mfma_f32_16x16x32_bf16 v[36:39], v[64:67], v[116:119], v[36:39]
    ds_read_b128 v[172:175], v205 offset:2240
    v_mfma_f32_16x16x32_bf16 v[40:43], v[64:67], v[120:123], v[40:43]
    ds_read_b128 v[176:179], v205 offset:1728
    v_mfma_f32_16x16x32_bf16 v[44:47], v[64:67], v[124:127], v[44:47]
    ds_read_b128 v[180:183], v205 offset:1216
    v_mfma_f32_16x16x32_bf16 v[20:23], v[68:71], v[96:99], v[20:23]
    ds_read_b128 v[184:187], v205 offset:704
    v_mfma_f32_16x16x32_bf16 v[24:27], v[68:71], v[100:103], v[24:27]
    ds_read_b128 v[188:191], v205 offset:192
    v_mfma_f32_16x16x32_bf16 v[28:31], v[68:71], v[104:107], v[28:31]
    ds_read_b64 v[132:133], v204 offset:704
    v_mfma_f32_16x16x32_bf16 v[32:35], v[68:71], v[108:111], v[32:35]
    ds_read_b64 v[134:135], v204 offset:712
    v_mfma_f32_16x16x32_bf16 v[36:39], v[68:71], v[112:115], v[36:39]
    ds_read_b64 v[136:137], v204 offset:1216
    v_mfma_f32_16x16x32_bf16 v[40:43], v[68:71], v[116:119], v[40:43]
    ds_read_b64 v[138:139], v204 offset:1224
    v_mfma_f32_16x16x32_bf16 v[44:47], v[68:71], v[120:123], v[44:47]
    ds_read_b64 v[140:141], v204 offset:1728
    v_mfma_f32_16x16x32_bf16 v[24:27], v[72:75], v[96:99], v[24:27]
    ds_read_b64 v[142:143], v204 offset:1736
    v_mfma_f32_16x16x32_bf16 v[28:31], v[72:75], v[100:103], v[28:31]
    ds_read_b64 v[144:145], v204 offset:2240
    v_mfma_f32_16x16x32_bf16 v[32:35], v[72:75], v[104:107], v[32:35]
    ds_read_b64 v[146:147], v204 offset:2248
    v_mfma_f32_16x16x32_bf16 v[36:39], v[72:75], v[108:111], v[36:39]
    ds_read_b64 v[148:149], v204 offset:2752
    v_mfma_f32_16x16x32_bf16 v[40:43], v[72:75], v[112:115], v[40:43]
    ds_read_b64 v[150:151], v204 offset:2760
    v_mfma_f32_16x16x32_bf16 v[44:47], v[72:75], v[116:119], v[44:47]
    ds_read_b64 v[152:153], v204 offset:3264
    v_mfma_f32_16x16x32_bf16 v[28:31], v[76:79], v[96:99], v[28:31]
    ds_read_b64 v[154:155], v204 offset:3272
    v_mfma_f32_16x16x32_bf16 v[32:35], v[76:79], v[100:103], v[32:35]
    ds_read_b64 v[156:157], v204 offset:3776
    v_mfma_f32_16x16x32_bf16 v[36:39], v[76:79], v[104:107], v[36:39]
    ds_read_b64 v[158:159], v204 offset:3784
    v_mfma_f32_16x16x32_bf16 v[40:43], v[76:79], v[108:111], v[40:43]
    v_mfma_f32_16x16x32_bf16 v[44:47], v[76:79], v[112:115], v[44:47]
    v_mfma_f32_16x16x32_bf16 v[32:35], v[80:83], v[96:99], v[32:35]
    v_mfma_f32_16x16x32_bf16 v[36:39], v[80:83], v[100:103], v[36:39]
    v_mfma_f32_16x16x32_bf16 v[40:43], v[80:83], v[104:107], v[40:43]
    v_mfma_f32_16x16x32_bf16 v[44:47], v[80:83], v[108:111], v[44:47]
    v_mfma_f32_16x16x32_bf16 v[36:39], v[84:87], v[96:99], v[36:39]
    v_mfma_f32_16x16x32_bf16 v[40:43], v[84:87], v[100:103], v[40:43]
    v_mfma_f32_16x16x32_bf16 v[44:47], v[84:87], v[104:107], v[44:47]
    v_mfma_f32_16x16x32_bf16 v[40:43], v[88:91], v[96:99], v[40:43]
    v_mfma_f32_16x16x32_bf16 v[44:47], v[88:91], v[100:103], v[44:47]
    v_mfma_f32_16x16x32_bf16 v[44:47], v[92:95], v[96:99], v[44:47]
    s_waitcnt lgkmcnt(0)
    v_mfma_f32_16x16x32_bf16 v[16:19], v[128:131], v[160:163], v[16:19]
    ds_read_b64 v[64:65], v204 offset:256
    v_mfma_f32_16x16x32_bf16 v[20:23], v[128:131], v[164:167], v[20:23]
    ds_read_b64 v[66:67], v204 offset:264
    v_mfma_f32_16x16x32_bf16 v[24:27], v[128:131], v[168:171], v[24:27]
    ds_read_b128 v[96:99], v205 offset:3840
    v_mfma_f32_16x16x32_bf16 v[28:31], v[128:131], v[172:175], v[28:31]
    ds_read_b128 v[100:103], v205 offset:3328
    v_mfma_f32_16x16x32_bf16 v[32:35], v[128:131], v[176:179], v[32:35]
    ds_read_b128 v[104:107], v205 offset:2816
    v_mfma_f32_16x16x32_bf16 v[36:39], v[128:131], v[180:183], v[36:39]
    ds_read_b128 v[108:111], v205 offset:2304
    v_mfma_f32_16x16x32_bf16 v[40:43], v[128:131], v[184:187], v[40:43]
    ds_read_b128 v[112:115], v205 offset:1792
    v_mfma_f32_16x16x32_bf16 v[44:47], v[128:131], v[188:191], v[44:47]
    ds_read_b128 v[116:119], v205 offset:1280
    v_mfma_f32_16x16x32_bf16 v[20:23], v[132:135], v[160:163], v[20:23]
    ds_read_b128 v[120:123], v205 offset:768
    v_mfma_f32_16x16x32_bf16 v[24:27], v[132:135], v[164:167], v[24:27]
    ds_read_b128 v[124:127], v205 offset:256
    v_mfma_f32_16x16x32_bf16 v[28:31], v[132:135], v[168:171], v[28:31]
    ds_read_b64 v[68:69], v204 offset:768
    v_mfma_f32_16x16x32_bf16 v[32:35], v[132:135], v[172:175], v[32:35]
    ds_read_b64 v[70:71], v204 offset:776
    v_mfma_f32_16x16x32_bf16 v[36:39], v[132:135], v[176:179], v[36:39]
    ds_read_b64 v[72:73], v204 offset:1280
    v_mfma_f32_16x16x32_bf16 v[40:43], v[132:135], v[180:183], v[40:43]
    ds_read_b64 v[74:75], v204 offset:1288
    v_mfma_f32_16x16x32_bf16 v[44:47], v[132:135], v[184:187], v[44:47]
    ds_read_b64 v[76:77], v204 offset:1792
    v_mfma_f32_16x16x32_bf16 v[24:27], v[136:139], v[160:163], v[24:27]
    ds_read_b64 v[78:79], v204 offset:1800
    v_mfma_f32_16x16x32_bf16 v[28:31], v[136:139], v[164:167], v[28:31]
    ds_read_b64 v[80:81], v204 offset:2304
    v_mfma_f32_16x16x32_bf16 v[32:35], v[136:139], v[168:171], v[32:35]
    ds_read_b64 v[82:83], v204 offset:2312
    v_mfma_f32_16x16x32_bf16 v[36:39], v[136:139], v[172:175], v[36:39]
    ds_read_b64 v[84:85], v204 offset:2816
    v_mfma_f32_16x16x32_bf16 v[40:43], v[136:139], v[176:179], v[40:43]
    ds_read_b64 v[86:87], v204 offset:2824
    v_mfma_f32_16x16x32_bf16 v[44:47], v[136:139], v[180:183], v[44:47]
    ds_read_b64 v[88:89], v204 offset:3328
    v_mfma_f32_16x16x32_bf16 v[28:31], v[140:143], v[160:163], v[28:31]
    ds_read_b64 v[90:91], v204 offset:3336
    v_mfma_f32_16x16x32_bf16 v[32:35], v[140:143], v[164:167], v[32:35]
    ds_read_b64 v[92:93], v204 offset:3840
    v_mfma_f32_16x16x32_bf16 v[36:39], v[140:143], v[168:171], v[36:39]
    ds_read_b64 v[94:95], v204 offset:3848
    v_mfma_f32_16x16x32_bf16 v[40:43], v[140:143], v[172:175], v[40:43]
    v_mfma_f32_16x16x32_bf16 v[44:47], v[140:143], v[176:179], v[44:47]
    v_mfma_f32_16x16x32_bf16 v[32:35], v[144:147], v[160:163], v[32:35]
    v_mfma_f32_16x16x32_bf16 v[36:39], v[144:147], v[164:167], v[36:39]
    v_mfma_f32_16x16x32_bf16 v[40:43], v[144:147], v[168:171], v[40:43]
    v_mfma_f32_16x16x32_bf16 v[44:47], v[144:147], v[172:175], v[44:47]
    v_mfma_f32_16x16x32_bf16 v[36:39], v[148:151], v[160:163], v[36:39]
    v_mfma_f32_16x16x32_bf16 v[40:43], v[148:151], v[164:167], v[40:43]
    v_mfma_f32_16x16x32_bf16 v[44:47], v[148:151], v[168:171], v[44:47]
    v_mfma_f32_16x16x32_bf16 v[40:43], v[152:155], v[160:163], v[40:43]
    v_mfma_f32_16x16x32_bf16 v[44:47], v[152:155], v[164:167], v[44:47]
    v_mfma_f32_16x16x32_bf16 v[44:47], v[156:159], v[160:163], v[44:47]
    s_waitcnt lgkmcnt(0)
    s_waitcnt vmcnt(0)
    v_cmp_ne_u32 vcc, s44, v10
    v_cmp_ne_u32 s[52:53], s44, v11
    s_nop 1
    s_or_b64 vcc, vcc, s[52:53]
    s_cbranch_vccz FBOK_7
    s_mov_b32 s51, 0x8000
POLL_8:
    buffer_load_dword v10, v8, s[28:31], 0 offen sc1
    buffer_load_dword v11, v9, s[28:31], 0 offen sc1
    s_waitcnt vmcnt(0)
    v_cmp_ne_u32 vcc, s44, v10
    v_cmp_ne_u32 s[52:53], s44, v11
    s_nop 1
    s_or_b64 vcc, vcc, s[52:53]
    s_cbranch_vccz FBOK_7
    s_sleep 2
    s_sub_u32 s51, s51, 1
    s_cmp_lg_u32 s51, 0
    s_cbranch_scc1 POLL_8
FBOK_7:
    s_mov_b32 s49, 0x280000
    s_mov_b32 s50, 0
    buffer_load_dwordx4 v[208:211], v13, s[28:31], s49 offen sc1
    buffer_load_dwordx4 v[212:215], v206, s[28:31], s50 offen sc1
    s_mov_b32 s49, 0x320000
    s_mov_b32 s50, 4096
    buffer_load_dwordx4 v[216:219], v13, s[28:31], s49 offen sc1
    buffer_load_dwordx4 v[220:223], v206, s[28:31], s50 offen sc1
    s_mov_b32 s49, 0x3c0000
    s_mov_b32 s50, 8192
    buffer_load_dwordx4 v[224:227], v13, s[28:31], s49 offen sc1
    buffer_load_dwordx4 v[228:231], v206, s[28:31], s50 offen sc1
    s_mov_b32 s49, 0x460000
    s_mov_b32 s50, 12288
    buffer_load_dwordx4 v[232:235], v13, s[28:31], s49 offen sc1
    buffer_load_dwordx4 v[236:239], v206, s[28:31], s50 offen sc1
    v_mfma_f32_16x16x32_bf16 v[16:19], v[64:67], v[96:99], v[16:19]
    ds_read_b64 v[128:129], v204 offset:320
    v_mfma_f32_16x16x32_bf16 v[20:23], v[64:67], v[100:103], v[20:23]
    ds_read_b64 v[130:131], v204 offset:328
    v_mfma_f32_16x16x32_bf16 v[24:27], v[64:67], v[104:107], v[24:27]
    ds_read_b128 v[160:163], v205 offset:3904
    v_mfma_f32_16x16x32_bf16 v[28:31], v[64:67], v[108:111], v[28:31]
    ds_read_b128 v[164:167], v205 offset:3392
    v_mfma_f32_16x16x32_bf16 v[32:35], v[64:67], v[112:115], v[32:35]
    ds_read_b128 v[168:171], v205 offset:2880
    v_mfma_f32_16x16x32_bf16 v[36:39], v[64:67], v[116:119], v[36:39]
    ds_read_b128 v[172:175], v205 offset:2368
    v_mfma_f32_16x16x32_bf16 v[40:43], v[64:67], v[120:123], v[40:43]
    ds_read_b128 v[176:179], v205 offset:1856
    v_mfma_f32_16x16x32_bf16 v[44:47], v[64:67], v[124:127], v[44:47]
    ds_read_b128 v[180:183], v205 offset:1344
    v_mfma_f32_16x16x32_bf16 v[20:23], v[68:71], v[96:99], v[20:23]
    ds_read_b128 v[184:187], v205 offset:832
    v_mfma_f32_16x16x32_bf16 v[24:27], v[68:71], v[100:103], v[24:27]
    ds_read_b128 v[188:191], v205 offset:320
    v_mfma_f32_16x16x32_bf16 v[28:31], v[68:71], v[104:107], v[28:31]
    ds_read_b64 v[132:133], v204 offset:832
    v_mfma_f32_16x16x32_bf16 v[32:35], v[68:71], v[108:111], v[32:35]
    ds_read_b64 v[134:135], v204 offset:840
    v_mfma_f32_16x16x32_bf16 v[36:39], v[68:71], v[112:115], v[36:39]
    ds_read_b64 v[136:137], v204 offset:1344
    v_mfma_f32_16x16x32_bf16 v[40:43], v[68:71], v[116:119], v[40:43]
    ds_read_b64 v[138:139], v204 offset:1352
    v_mfma_f32_16x16x32_bf16 v[44:47], v[68:71], v[120:123], v[44:47]
    ds_read_b64 v[140:141], v204 offset:1856
    v_mfma_f32_16x16x32_bf16 v[24:27], v[72:75], v[96:99], v[24:27]
    ds_read_b64 v[142:143], v204 offset:1864
    v_mfma_f32_16x16x32_bf16 v[28:31], v[72:75], v[100:103], v[28:31]
    ds_read_b64 v[144:145], v204 offset:2368
    v_mfma_f32_16x16x32_bf16 v[32:35], v[72:75], v[104:107], v[32:35]
    ds_read_b64 v[146:147], v204 offset:2376
    v_mfma_f32_16x16x32_bf16 v[36:39], v[72:75], v[108:111], v[36:39]
    ds_read_b64 v[148:149], v204 offset:2880
    v_mfma_f32_16x16x32_bf16 v[40:43], v[72:75], v[112:115], v[40:43]
    ds_read_b64 v[150:151], v204 offset:2888
    v_mfma_f32_16x16x32_bf16 v[44:47], v[72:75], v[116:119], v[44:47]
    ds_read_b64 v[152:153], v204 offset:3392
    v_mfma_f32_16x16x32_bf16 v[28:31], v[76:79], v[96:99], v[28:31]
    ds_read_b64 v[154:155], v204 offset:3400
    v_mfma_f32_16x16x32_bf16 v[32:35], v[76:79], v[100:103], v[32:35]
    ds_read_b64 v[156:157], v204 offset:3904
    v_mfma_f32_16x16x32_bf16 v[36:39], v[76:79], v[104:107], v[36:39]
    ds_read_b64 v[158:159], v204 offset:3912
    v_mfma_f32_16x16x32_bf16 v[40:43], v[76:79], v[108:111], v[40:43]
    v_mfma_f32_16x16x32_bf16 v[44:47], v[76:79], v[112:115], v[44:47]
    v_mfma_f32_16x16x32_bf16 v[32:35], v[80:83], v[96:99], v[32:35]
    v_mfma_f32_16x16x32_bf16 v[36:39], v[80:83], v[100:103], v[36:39]
    v_mfma_f32_16x16x32_bf16 v[40:43], v[80:83], v[104:107], v[40:43]
    v_mfma_f32_16x16x32_bf16 v[44:47], v[80:83], v[108:111], v[44:47]
    v_mfma_f32_16x16x32_bf16 v[36:39], v[84:87], v[96:99], v[36:39]
    v_mfma_f32_16x16x32_bf16 v[40:43], v[84:87], v[100:103], v[40:43]
    v_mfma_f32_16x16x32_bf16 v[44:47], v[84:87], v[104:107], v[44:47]
    v_mfma_f32_16x16x32_bf16 v[40:43], v[88:91], v[96:99], v[40:43]
    v_mfma_f32_16x16x32_bf16 v[44:47], v[88:91], v[100:103], v[44:47]
    v_mfma_f32_16x16x32_bf16 v[44:47], v[92:95], v[96:99], v[44:47]
    s_waitcnt lgkmcnt(0)
    v_mfma_f32_16x16x32_bf16 v[16:19], v[128:131], v[160:163], v[16:19]
    ds_read_b64 v[64:65], v204 offset:384
    v_mfma_f32_16x16x32_bf16 v[20:23], v[128:131], v[164:167], v[20:23]
    ds_read_b64 v[66:67], v204 offset:392
    v_mfma_f32_16x16x32_bf16 v[24:27], v[128:131], v[168:171], v[24:27]
    ds_read_b128 v[96:99], v205 offset:3968
    v_mfma_f32_16x16x32_bf16 v[28:31], v[128:131], v[172:175], v[28:31]
    ds_read_b128 v[100:103], v205 offset:3456
    v_mfma_f32_16x16x32_bf16 v[32:35], v[128:131], v[176:179], v[32:35]
    ds_read_b128 v[104:107], v205 offset:2944
    v_mfma_f32_16x16x32_bf16 v[36:39], v[128:131], v[180:183], v[36:39]
    ds_read_b128 v[108:111], v205 offset:2432
    v_mfma_f32_16x16x32_bf16 v[40:43], v[128:131], v[184:187], v[40:43]
    ds_read_b128 v[112:115], v205 offset:1920
    v_mfma_f32_16x16x32_bf16 v[44:47], v[128:131], v[188:191], v[44:47]
    ds_read_b128 v[116:119], v205 offset:1408
    v_mfma_f32_16x16x32_bf16 v[20:23], v[132:135], v[160:163], v[20:23]
    ds_read_b128 v[120:123], v205 offset:896
    v_mfma_f32_16x16x32_bf16 v[24:27], v[132:135], v[164:167], v[24:27]
    ds_read_b128 v[124:127], v205 offset:384
    v_mfma_f32_16x16x32_bf16 v[28:31], v[132:135], v[168:171], v[28:31]
    ds_read_b64 v[68:69], v204 offset:896
    v_mfma_f32_16x16x32_bf16 v[32:35], v[132:135], v[172:175], v[32:35]
    ds_read_b64 v[70:71], v204 offset:904
    v_mfma_f32_16x16x32_bf16 v[36:39], v[132:135], v[176:179], v[36:39]
    ds_read_b64 v[72:73], v204 offset:1408
    v_mfma_f32_16x16x32_bf16 v[40:43], v[132:135], v[180:183], v[40:43]
    ds_read_b64 v[74:75], v204 offset:1416
    v_mfma_f32_16x16x32_bf16 v[44:47], v[132:135], v[184:187], v[44:47]
    ds_read_b64 v[76:77], v204 offset:1920
    v_mfma_f32_16x16x32_bf16 v[24:27], v[136:139], v[160:163], v[24:27]
    ds_read_b64 v[78:79], v204 offset:1928
    v_mfma_f32_16x16x32_bf16 v[28:31], v[136:139], v[164:167], v[28:31]
    ds_read_b64 v[80:81], v204 offset:2432
    v_mfma_f32_16x16x32_bf16 v[32:35], v[136:139], v[168:171], v[32:35]
    ds_read_b64 v[82:83], v204 offset:2440
    v_mfma_f32_16x16x32_bf16 v[36:39], v[136:139], v[172:175], v[36:39]
    ds_read_b64 v[84:85], v204 offset:2944
    v_mfma_f32_16x16x32_bf16 v[40:43], v[136:139], v[176:179], v[40:43]
    ds_read_b64 v[86:87], v204 offset:2952
    v_mfma_f32_16x16x32_bf16 v[44:47], v[136:139], v[180:183], v[44:47]
    ds_read_b64 v[88:89], v204 offset:3456
    v_mfma_f32_16x16x32_bf16 v[28:31], v[140:143], v[160:163], v[28:31]
    ds_read_b64 v[90:91], v204 offset:3464
    v_mfma_f32_16x16x32_bf16 v[32:35], v[140:143], v[164:167], v[32:35]
    ds_read_b64 v[92:93], v204 offset:3968
    v_mfma_f32_16x16x32_bf16 v[36:39], v[140:143], v[168:171], v[36:39]
    ds_read_b64 v[94:95], v204 offset:3976
    v_mfma_f32_16x16x32_bf16 v[40:43], v[140:143], v[172:175], v[40:43]
    v_mfma_f32_16x16x32_bf16 v[44:47], v[140:143], v[176:179], v[44:47]
    v_mfma_f32_16x16x32_bf16 v[32:35], v[144:147], v[160:163], v[32:35]
    v_mfma_f32_16x16x32_bf16 v[36:39], v[144:147], v[164:167], v[36:39]
    v_mfma_f32_16x16x32_bf16 v[40:43], v[144:147], v[168:171], v[40:43]
    v_mfma_f32_16x16x32_bf16 v[44:47], v[144:147], v[172:175], v[44:47]
    v_mfma_f32_16x16x32_bf16 v[36:39], v[148:151], v[160:163], v[36:39]
    v_mfma_f32_16x16x32_bf16 v[40:43], v[148:151], v[164:167], v[40:43]
    v_mfma_f32_16x16x32_bf16 v[44:47], v[148:151], v[168:171], v[44:47]
    v_mfma_f32_16x16x32_bf16 v[40:43], v[152:155], v[160:163], v[40:43]
    v_mfma_f32_16x16x32_bf16 v[44:47], v[152:155], v[164:167], v[44:47]
    v_mfma_f32_16x16x32_bf16 v[44:47], v[156:159], v[160:163], v[44:47]
    s_waitcnt lgkmcnt(0)
    v_mfma_f32_16x16x32_bf16 v[16:19], v[64:67], v[96:99], v[16:19]
    ds_read_b64 v[128:129], v204 offset:448
    v_mfma_f32_16x16x32_bf16 v[20:23], v[64:67], v[100:103], v[20:23]
    ds_read_b64 v[130:131], v204 offset:456
    v_mfma_f32_16x16x32_bf16 v[24:27], v[64:67], v[104:107], v[24:27]
    ds_read_b128 v[160:163], v205 offset:4032
    v_mfma_f32_16x16x32_bf16 v[28:31], v[64:67], v[108:111], v[28:31]
    ds_read_b128 v[164:167], v205 offset:3520
    v_mfma_f32_16x16x32_bf16 v[32:35], v[64:67], v[112:115], v[32:35]
    ds_read_b128 v[168:171], v205 offset:3008
    v_mfma_f32_16x16x32_bf16 v[36:39], v[64:67], v[116:119], v[36:39]
    ds_read_b128 v[172:175], v205 offset:2496
    v_mfma_f32_16x16x32_bf16 v[40:43], v[64:67], v[120:123], v[40:43]
    ds_read_b128 v[176:179], v205 offset:1984
    v_mfma_f32_16x16x32_bf16 v[44:47], v[64:67], v[124:127], v[44:47]
    ds_read_b128 v[180:183], v205 offset:1472
    v_mfma_f32_16x16x32_bf16 v[20:23], v[68:71], v[96:99], v[20:23]
    ds_read_b128 v[184:187], v205 offset:960
    v_mfma_f32_16x16x32_bf16 v[24:27], v[68:71], v[100:103], v[24:27]
    ds_read_b128 v[188:191], v205 offset:448
    v_mfma_f32_16x16x32_bf16 v[28:31], v[68:71], v[104:107], v[28:31]
    ds_read_b64 v[132:133], v204 offset:960
    v_mfma_f32_16x16x32_bf16 v[32:35], v[68:71], v[108:111], v[32:35]
    ds_read_b64 v[134:135], v204 offset:968
    v_mfma_f32_16x16x32_bf16 v[36:39], v[68:71], v[112:115], v[36:39]
    ds_read_b64 v[136:137], v204 offset:1472
    v_mfma_f32_16x16x32_bf16 v[40:43], v[68:71], v[116:119], v[40:43]
    ds_read_b64 v[138:139], v204 offset:1480
    v_mfma_f32_16x16x32_bf16 v[44:47], v[68:71], v[120:123], v[44:47]
    ds_read_b64 v[140:141], v204 offset:1984
    v_mfma_f32_16x16x32_bf16 v[24:27], v[72:75], v[96:99], v[24:27]
    ds_read_b64 v[142:143], v204 offset:1992
    v_mfma_f32_16x16x32_bf16 v[28:31], v[72:75], v[100:103], v[28:31]
    ds_read_b64 v[144:145], v204 offset:2496
    v_mfma_f32_16x16x32_bf16 v[32:35], v[72:75], v[104:107], v[32:35]
    ds_read_b64 v[146:147], v204 offset:2504
    v_mfma_f32_16x16x32_bf16 v[36:39], v[72:75], v[108:111], v[36:39]
    ds_read_b64 v[148:149], v204 offset:3008
    v_mfma_f32_16x16x32_bf16 v[40:43], v[72:75], v[112:115], v[40:43]
    ds_read_b64 v[150:151], v204 offset:3016
    v_mfma_f32_16x16x32_bf16 v[44:47], v[72:75], v[116:119], v[44:47]
    ds_read_b64 v[152:153], v204 offset:3520
    v_mfma_f32_16x16x32_bf16 v[28:31], v[76:79], v[96:99], v[28:31]
    ds_read_b64 v[154:155], v204 offset:3528
    v_mfma_f32_16x16x32_bf16 v[32:35], v[76:79], v[100:103], v[32:35]
    ds_read_b64 v[156:157], v204 offset:4032
    v_mfma_f32_16x16x32_bf16 v[36:39], v[76:79], v[104:107], v[36:39]
    ds_read_b64 v[158:159], v204 offset:4040
    v_mfma_f32_16x16x32_bf16 v[40:43], v[76:79], v[108:111], v[40:43]
    v_mfma_f32_16x16x32_bf16 v[44:47], v[76:79], v[112:115], v[44:47]
    v_mfma_f32_16x16x32_bf16 v[32:35], v[80:83], v[96:99], v[32:35]
    v_mfma_f32_16x16x32_bf16 v[36:39], v[80:83], v[100:103], v[36:39]
    v_mfma_f32_16x16x32_bf16 v[40:43], v[80:83], v[104:107], v[40:43]
    v_mfma_f32_16x16x32_bf16 v[44:47], v[80:83], v[108:111], v[44:47]
    v_mfma_f32_16x16x32_bf16 v[36:39], v[84:87], v[96:99], v[36:39]
    v_mfma_f32_16x16x32_bf16 v[40:43], v[84:87], v[100:103], v[40:43]
    v_mfma_f32_16x16x32_bf16 v[44:47], v[84:87], v[104:107], v[44:47]
    v_mfma_f32_16x16x32_bf16 v[40:43], v[88:91], v[96:99], v[40:43]
    v_mfma_f32_16x16x32_bf16 v[44:47], v[88:91], v[100:103], v[44:47]
    v_mfma_f32_16x16x32_bf16 v[44:47], v[92:95], v[96:99], v[44:47]
    s_waitcnt lgkmcnt(0)
    s_mov_b32 s49, 0xb44200
    s_and_b32 s50, s2, 7
    s_mul_i32 s50, s50, 2048
    s_add_u32 s49, s49, s50
    v_add_u32 v240, 0, v1
    v_lshl_add_u32 v240, v240, 2, s49
    v_add_u32 v241, 64, v1
    v_min_u32 v241, 69, v241
    v_lshl_add_u32 v241, v241, 2, s49
    buffer_load_dword v242, v240, s[28:31], 0 offen sc1
    buffer_load_dword v243, v241, s[28:31], 0 offen sc1
    v_mfma_f32_16x16x32_bf16 v[16:19], v[128:131], v[160:163], v[16:19]
    v_mfma_f32_16x16x32_bf16 v[20:23], v[128:131], v[164:167], v[20:23]
    v_mfma_f32_16x16x32_bf16 v[24:27], v[128:131], v[168:171], v[24:27]
    v_mfma_f32_16x16x32_bf16 v[28:31], v[128:131], v[172:175], v[28:31]
    v_mfma_f32_16x16x32_bf16 v[32:35], v[128:131], v[176:179], v[32:35]
    v_mfma_f32_16x16x32_bf16 v[36:39], v[128:131], v[180:183], v[36:39]
    v_mfma_f32_16x16x32_bf16 v[40:43], v[128:131], v[184:187], v[40:43]
    v_mfma_f32_16x16x32_bf16 v[44:47], v[128:131], v[188:191], v[44:47]
    v_mfma_f32_16x16x32_bf16 v[20:23], v[132:135], v[160:163], v[20:23]
    v_mfma_f32_16x16x32_bf16 v[24:27], v[132:135], v[164:167], v[24:27]
    v_mfma_f32_16x16x32_bf16 v[28:31], v[132:135], v[168:171], v[28:31]
    v_mfma_f32_16x16x32_bf16 v[32:35], v[132:135], v[172:175], v[32:35]
    v_mfma_f32_16x16x32_bf16 v[36:39], v[132:135], v[176:179], v[36:39]
    v_mfma_f32_16x16x32_bf16 v[40:43], v[132:135], v[180:183], v[40:43]
    v_mfma_f32_16x16x32_bf16 v[44:47], v[132:135], v[184:187], v[44:47]
    v_mfma_f32_16x16x32_bf16 v[24:27], v[136:139], v[160:163], v[24:27]
    v_mfma_f32_16x16x32_bf16 v[28:31], v[136:139], v[164:167], v[28:31]
    v_mfma_f32_16x16x32_bf16 v[32:35], v[136:139], v[168:171], v[32:35]
    v_mfma_f32_16x16x32_bf16 v[36:39], v[136:139], v[172:175], v[36:39]
    v_mfma_f32_16x16x32_bf16 v[40:43], v[136:139], v[176:179], v[40:43]
    v_mfma_f32_16x16x32_bf16 v[44:47], v[136:139], v[180:183], v[44:47]
    v_mfma_f32_16x16x32_bf16 v[28:31], v[140:143], v[160:163], v[28:31]
    v_mfma_f32_16x16x32_bf16 v[32:35], v[140:143], v[164:167], v[32:35]
    v_mfma_f32_16x16x32_bf16 v[36:39], v[140:143], v[168:171], v[36:39]
    v_mfma_f32_16x16x32_bf16 v[40:43], v[140:143], v[172:175], v[40:43]
    v_mfma_f32_16x16x32_bf16 v[44:47], v[140:143], v[176:179], v[44:47]
    v_mfma_f32_16x16x32_bf16 v[32:35], v[144:147], v[160:163], v[32:35]
    v_mfma_f32_16x16x32_bf16 v[36:39], v[144:147], v[164:167], v[36:39]
    v_mfma_f32_16x16x32_bf16 v[40:43], v[144:147], v[168:171], v[40:43]
    v_mfma_f32_16x16x32_bf16 v[44:47], v[144:147], v[172:175], v[44:47]
    v_mfma_f32_16x16x32_bf16 v[36:39], v[148:151], v[160:163], v[36:39]
    v_mfma_f32_16x16x32_bf16 v[40:43], v[148:151], v[164:167], v[40:43]
    v_mfma_f32_16x16x32_bf16 v[44:47], v[148:151], v[168:171], v[44:47]
    v_mfma_f32_16x16x32_bf16 v[40:43], v[152:155], v[160:163], v[40:43]
    v_mfma_f32_16x16x32_bf16 v[44:47], v[152:155], v[164:167], v[44:47]
    v_mfma_f32_16x16x32_bf16 v[44:47], v[156:159], v[160:163], v[44:47]
    v_cvt_pk_bf16_f32 v64, v16, v17
    v_cvt_pk_bf16_f32 v65, v18, v19
    v_cvt_pk_bf16_f32 v66, v20, v21
    v_cvt_pk_bf16_f32 v67, v22, v23
    v_cvt_pk_bf16_f32 v68, v24, v25
    v_cvt_pk_bf16_f32 v69, v26, v27
    v_cvt_pk_bf16_f32 v70, v28, v29
    v_cvt_pk_bf16_f32 v71, v30, v31
    v_cvt_pk_bf16_f32 v72, v32, v33
    v_cvt_pk_bf16_f32 v73, v34, v35
    v_cvt_pk_bf16_f32 v74, v36, v37
    v_cvt_pk_bf16_f32 v75, v38, v39
    v_cvt_pk_bf16_f32 v76, v40, v41
    v_cvt_pk_bf16_f32 v77, v42, v43
    v_cvt_pk_bf16_f32 v78, v44, v45
    v_cvt_pk_bf16_f32 v79, v46, v47
    v_mul_u32_u24 v8, 144, v3
    v_lshl_add_u32 v8, v2, 3, v8
    v_add_u32 v8, s67, v8
    ds_write_b64 v8, v[64:65] offset:0
    ds_write_b64 v8, v[66:67] offset:576
    ds_write_b64 v8, v[68:69] offset:1152
    ds_write_b64 v8, v[70:71] offset:1728
    ds_write_b64 v8, v[72:73] offset:2304
    ds_write_b64 v8, v[74:75] offset:2880
    ds_write_b64 v8, v[76:77] offset:3456
    ds_write_b64 v8, v[78:79] offset:4032
    v_lshrrev_b32 v9, 7, v0
    v_mul_u32_u24 v9, 576, v9
    v_bfe_u32 v10, v0, 1, 2
    v_mul_u32_u24 v10, 144, v10
    v_add_u32 v9, v9, v10
    v_bfe_u32 v10, v0, 3, 4
    v_lshl_add_u32 v9, v10, 3, v9
    v_and_b32 v10, 1, v0
    v_lshl_add_u32 v9, v10, 2, v9
    v_add_u32 v10, 42496, v9
    s_waitcnt lgkmcnt(0)
    s_barrier
    ds_read_b32 v96, v9 offset:0
    ds_read_b32 v97, v9 offset:21248
    ds_read_b32 v98, v10 offset:0
    ds_read_b32 v99, v10 offset:21248
    ds_read_b32 v100, v9 offset:1152
    ds_read_b32 v101, v9 offset:22400
    ds_read_b32 v102, v10 offset:1152
    ds_read_b32 v103, v10 offset:22400
    ds_read_b32 v104, v9 offset:2304
    ds_read_b32 v105, v9 offset:23552
    ds_read_b32 v106, v10 offset:2304
    ds_read_b32 v107, v10 offset:23552
    ds_read_b32 v108, v9 offset:3456
    ds_read_b32 v109, v9 offset:24704
    ds_read_b32 v110, v10 offset:3456
    ds_read_b32 v111, v10 offset:24704
    s_mov_b32 s52, 0xffff0000
    s_mov_b32 s53, 0x05040100
    s_mov_b32 s54, 0x07060302
    s_waitcnt vmcnt(2)
    s_waitcnt lgkmcnt(12)
    v_lshlrev_b32 v128, 16, v96
    v_and_b32 v132, s52, v96
    v_lshlrev_b32 v129, 16, v97
    v_and_b32 v133, s52, v97
    v_lshlrev_b32 v130, 16, v98
    v_and_b32 v134, s52, v98
    v_lshlrev_b32 v131, 16, v99
    v_and_b32 v135, s52, v99
    v_perm_b32 v152, v97, v96, s53
    v_perm_b32 v153, v99, v98, s53
    v_perm_b32 v154, v97, v96, s54
    v_perm_b32 v155, v99, v98, s54
    v_lshlrev_b32 v136, 16, v208
    v_and_b32 v137, s52, v208
    v_lshlrev_b32 v138, 16, v209
    v_and_b32 v139, s52, v209
    v_pk_add_f32 v[140:141], v[136:137], v[212:213] op_sel_hi:[1,0]
    v_pk_mul_f32 v[128:129], v[128:129], v[212:213] op_sel:[0,1] op_sel_hi:[1,1]
    v_pk_add_f32 v[142:143], v[138:139], v[212:213] op_sel_hi:[1,0]
    v_pk_mul_f32 v[130:131], v[130:131], v[212:213] op_sel:[0,1] op_sel_hi:[1,1]
    v_pk_fma_f32 v[136:137], v[140:141], v[128:129], v[136:137]
    v_pk_fma_f32 v[138:139], v[142:143], v[130:131], v[138:139]
    v_cvt_pk_bf16_f32 v144, v136, v137
    v_cvt_pk_bf16_f32 v145, v138, v139
    v_lshlrev_b32 v136, 16, v210
    v_and_b32 v137, s52, v210
    v_lshlrev_b32 v138, 16, v211
    v_and_b32 v139, s52, v211
    v_pk_add_f32 v[140:141], v[136:137], v[214:215] op_sel_hi:[1,0]
    v_pk_mul_f32 v[132:133], v[132:133], v[214:215] op_sel:[0,1] op_sel_hi:[1,1]
    v_pk_add_f32 v[142:143], v[138:139], v[214:215] op_sel_hi:[1,0]
    v_pk_mul_f32 v[134:135], v[134:135], v[214:215] op_sel:[0,1] op_sel_hi:[1,1]
    v_pk_fma_f32 v[136:137], v[140:141], v[132:133], v[136:137]
    v_pk_fma_f32 v[138:139], v[142:143], v[134:135], v[138:139]
    v_cvt_pk_bf16_f32 v146, v136, v137
    v_cvt_pk_bf16_f32 v147, v138, v139
    s_mov_b32 s49, 0xe80000
    s_mov_b32 s50, 0xc00000
    buffer_store_dwordx4 v[144:147], v13, s[28:31], s49 offen sc1
    buffer_store_dwordx4 v[152:155], v13, s[28:31], s50 offen sc1
    s_waitcnt lgkmcnt(8)
    v_lshlrev_b32 v160, 16, v100
    v_and_b32 v164, s52, v100
    v_lshlrev_b32 v161, 16, v101
    v_and_b32 v165, s52, v101
    v_lshlrev_b32 v162, 16, v102
    v_and_b32 v166, s52, v102
    v_lshlrev_b32 v163, 16, v103
    v_and_b32 v167, s52, v103
    v_perm_b32 v184, v101, v100, s53
    v_perm_b32 v185, v103, v102, s53
    v_perm_b32 v186, v101, v100, s54
    v_perm_b32 v187, v103, v102, s54
    v_lshlrev_b32 v168, 16, v216
    v_and_b32 v169, s52, v216
    v_lshlrev_b32 v170, 16, v217
    v_and_b32 v171, s52, v217
    v_pk_add_f32 v[172:173], v[168:169], v[220:221] op_sel_hi:[1,0]
    v_pk_mul_f32 v[160:161], v[160:161], v[220:221] op_sel:[0,1] op_sel_hi:[1,1]
    v_pk_add_f32 v[174:175], v[170:171], v[220:221] op_sel_hi:[1,0]
    v_pk_mul_f32 v[162:163], v[162:163], v[220:221] op_sel:[0,1] op_sel_hi:[1,1]
    v_pk_fma_f32 v[168:169], v[172:173], v[160:161], v[168:169]
    v_pk_fma_f32 v[170:171], v[174:175], v[162:163], v[170:171]
    v_cvt_pk_bf16_f32 v176, v168, v169
    v_cvt_pk_bf16_f32 v177, v170, v171
    v_lshlrev_b32 v168, 16, v218
    v_and_b32 v169, s52, v218
    v_lshlrev_b32 v170, 16, v219
    v_and_b32 v171, s52, v219
    v_pk_add_f32 v[172:173], v[168:169], v[222:223] op_sel_hi:[1,0]
    v_pk_mul_f32 v[164:165], v[164:165], v[222:223] op_sel:[0,1] op_sel_hi:[1,1]
    v_pk_add_f32 v[174:175], v[170:171], v[222:223] op_sel_hi:[1,0]
    v_pk_mul_f32 v[166:167], v[166:167], v[222:223] op_sel:[0,1] op_sel_hi:[1,1]
    v_pk_fma_f32 v[168:169], v[172:173], v[164:165], v[168:169]
    v_pk_fma_f32 v[170:171], v[174:175], v[166:167], v[170:171]
    v_cvt_pk_bf16_f32 v178, v168, v169
    v_cvt_pk_bf16_f32 v179, v170, v171
    s_mov_b32 s49, 0xf20000
    s_mov_b32 s50, 0xca0000
    buffer_store_dwordx4 v[176:179], v13, s[28:31], s49 offen sc1
    buffer_store_dwordx4 v[184:187], v13, s[28:31], s50 offen sc1
    s_waitcnt lgkmcnt(4)
    v_lshlrev_b32 v128, 16, v104
    v_and_b32 v132, s52, v104
    v_lshlrev_b32 v129, 16, v105
    v_and_b32 v133, s52, v105
    v_lshlrev_b32 v130, 16, v106
    v_and_b32 v134, s52, v106
    v_lshlrev_b32 v131, 16, v107
    v_and_b32 v135, s52, v107
    v_perm_b32 v152, v105, v104, s53
    v_perm_b32 v153, v107, v106, s53
    v_perm_b32 v154, v105, v104, s54
    v_perm_b32 v155, v107, v106, s54
    v_lshlrev_b32 v136, 16, v224
    v_and_b32 v137, s52, v224
    v_lshlrev_b32 v138, 16, v225
    v_and_b32 v139, s52, v225
    v_pk_add_f32 v[140:141], v[136:137], v[228:229] op_sel_hi:[1,0]
    v_pk_mul_f32 v[128:129], v[128:129], v[228:229] op_sel:[0,1] op_sel_hi:[1,1]
    v_pk_add_f32 v[142:143], v[138:139], v[228:229] op_sel_hi:[1,0]
    v_pk_mul_f32 v[130:131], v[130:131], v[228:229] op_sel:[0,1] op_sel_hi:[1,1]
    v_pk_fma_f32 v[136:137], v[140:141], v[128:129], v[136:137]
    v_pk_fma_f32 v[138:139], v[142:143], v[130:131], v[138:139]
    v_cvt_pk_bf16_f32 v144, v136, v137
    v_cvt_pk_bf16_f32 v145, v138, v139
    v_lshlrev_b32 v136, 16, v226
    v_and_b32 v137, s52, v226
    v_lshlrev_b32 v138, 16, v227
    v_and_b32 v139, s52, v227
    v_pk_add_f32 v[140:141], v[136:137], v[230:231] op_sel_hi:[1,0]
    v_pk_mul_f32 v[132:133], v[132:133], v[230:231] op_sel:[0,1] op_sel_hi:[1,1]
    v_pk_add_f32 v[142:143], v[138:139], v[230:231] op_sel_hi:[1,0]
    v_pk_mul_f32 v[134:135], v[134:135], v[230:231] op_sel:[0,1] op_sel_hi:[1,1]
    v_pk_fma_f32 v[136:137], v[140:141], v[132:133], v[136:137]
    v_pk_fma_f32 v[138:139], v[142:143], v[134:135], v[138:139]
    v_cvt_pk_bf16_f32 v146, v136, v137
    v_cvt_pk_bf16_f32 v147, v138, v139
    s_mov_b32 s49, 0xfc0000
    s_mov_b32 s50, 0xd40000
    buffer_store_dwordx4 v[144:147], v13, s[28:31], s49 offen sc1
    buffer_store_dwordx4 v[152:155], v13, s[28:31], s50 offen sc1
    s_waitcnt lgkmcnt(0)
    v_lshlrev_b32 v160, 16, v108
    v_and_b32 v164, s52, v108
    v_lshlrev_b32 v161, 16, v109
    v_and_b32 v165, s52, v109
    v_lshlrev_b32 v162, 16, v110
    v_and_b32 v166, s52, v110
    v_lshlrev_b32 v163, 16, v111
    v_and_b32 v167, s52, v111
    v_perm_b32 v184, v109, v108, s53
    v_perm_b32 v185, v111, v110, s53
    v_perm_b32 v186, v109, v108, s54
    v_perm_b32 v187, v111, v110, s54
    v_lshlrev_b32 v168, 16, v232
    v_and_b32 v169, s52, v232
    v_lshlrev_b32 v170, 16, v233
    v_and_b32 v171, s52, v233
    v_pk_add_f32 v[172:173], v[168:169], v[236:237] op_sel_hi:[1,0]
    v_pk_mul_f32 v[160:161], v[160:161], v[236:237] op_sel:[0,1] op_sel_hi:[1,1]
    v_pk_add_f32 v[174:175], v[170:171], v[236:237] op_sel_hi:[1,0]
    v_pk_mul_f32 v[162:163], v[162:163], v[236:237] op_sel:[0,1] op_sel_hi:[1,1]
    v_pk_fma_f32 v[168:169], v[172:173], v[160:161], v[168:169]
    v_pk_fma_f32 v[170:171], v[174:175], v[162:163], v[170:171]
    v_cvt_pk_bf16_f32 v176, v168, v169
    v_cvt_pk_bf16_f32 v177, v170, v171
    v_lshlrev_b32 v168, 16, v234
    v_and_b32 v169, s52, v234
    v_lshlrev_b32 v170, 16, v235
    v_and_b32 v171, s52, v235
    v_pk_add_f32 v[172:173], v[168:169], v[238:239] op_sel_hi:[1,0]
    v_pk_mul_f32 v[164:165], v[164:165], v[238:239] op_sel:[0,1] op_sel_hi:[1,1]
    v_pk_add_f32 v[174:175], v[170:171], v[238:239] op_sel_hi:[1,0]
    v_pk_mul_f32 v[166:167], v[166:167], v[238:239] op_sel:[0,1] op_sel_hi:[1,1]
    v_pk_fma_f32 v[168:169], v[172:173], v[164:165], v[168:169]
    v_pk_fma_f32 v[170:171], v[174:175], v[166:167], v[170:171]
    v_cvt_pk_bf16_f32 v178, v168, v169
    v_cvt_pk_bf16_f32 v179, v170, v171
    s_mov_b32 s49, 0x1060000
    s_mov_b32 s50, 0xde0000
    buffer_store_dwordx4 v[176:179], v13, s[28:31], s49 offen sc1
    buffer_store_dwordx4 v[184:187], v13, s[28:31], s50 offen sc1
    s_waitcnt vmcnt(0)
    s_barrier
    s_cmp_lg_u32 s3, 0
    s_cbranch_scc1 NOFLAG_9
    s_lshl_b32 s49, s2, 2
    s_add_u32 s49, s49, 0xb44400
    v_mul_u32_u24 v8, 2048, v1
    v_add_u32 v8, s49, v8
    v_mov_b32 v9, s44
    s_mov_b64 exec, 255
    buffer_store_dword v9, v8, s[28:31], 0 offen sc1
    s_mov_b64 exec, -1
NOFLAG_9:
    v_cmp_ne_u32 vcc, s44, v242
    v_cmp_ne_u32 s[52:53], s44, v243
    s_nop 1
    s_or_b64 vcc, vcc, s[52:53]
    s_cbranch_vccz FCOK_10
    s_mov_b32 s51, 0x8000
POLL_12:
    buffer_load_dword v242, v240, s[28:31], 0 offen sc1
    buffer_load_dword v243, v241, s[28:31], 0 offen sc1
    s_waitcnt vmcnt(0)
    v_cmp_ne_u32 vcc, s44, v242
    v_cmp_ne_u32 s[52:53], s44, v243
    s_nop 1
    s_or_b64 vcc, vcc, s[52:53]
    s_cbranch_vccz FCOK_10
    s_sleep 8
    s_sub_u32 s51, s51, 1
    s_cmp_lg_u32 s51, 0
    s_cbranch_scc1 POLL_12
FCOK_10:
    s_mov_b32 s49, 0
    buffer_load_dwordx4 a[0:3], v250, s[28:31], s49 offen sc1
    buffer_load_dwordx4 a[4:7], v251, s[28:31], s49 offen sc1
    s_mov_b32 s49, 122880
    buffer_load_dwordx4 a[8:11], v250, s[28:31], s49 offen sc1
    buffer_load_dwordx4 a[12:15], v251, s[28:31], s49 offen sc1
    s_mov_b32 s49, 245760
    buffer_load_dwordx4 a[16:19], v250, s[28:31], s49 offen sc1
    buffer_load_dwordx4 a[20:23], v251, s[28:31], s49 offen sc1
    s_mov_b32 s49, 368640
    buffer_load_dwordx4 a[24:27], v250, s[28:31], s49 offen sc1
    buffer_load_dwordx4 a[28:31], v251, s[28:31], s49 offen sc1
    s_mov_b32 s49, 491520
    buffer_load_dwordx4 a[32:35], v250, s[28:31], s49 offen sc1
    buffer_load_dwordx4 a[36:39], v251, s[28:31], s49 offen sc1
    s_mov_b32 s49, 614400
    buffer_load_dwordx4 a[40:43], v250, s[28:31], s49 offen sc1
    buffer_load_dwordx4 a[44:47], v251, s[28:31], s49 offen sc1
    s_mov_b32 s49, 737280
    buffer_load_dwordx4 a[48:51], v250, s[28:31], s49 offen sc1
    buffer_load_dwordx4 a[52:55], v251, s[28:31], s49 offen sc1
    s_mov_b32 s49, 860160
    buffer_load_dwordx4 a[56:59], v250, s[28:31], s49 offen sc1
    buffer_load_dwordx4 a[60:63], v251, s[28:31], s49 offen sc1
    s_mov_b32 s49, 983040
    buffer_load_dwordx4 a[64:67], v250, s[28:31], s49 offen sc1
    buffer_load_dwordx4 a[68:71], v251, s[28:31], s49 offen sc1
    s_mov_b32 s49, 1105920
    buffer_load_dwordx4 a[72:75], v250, s[28:31], s49 offen sc1
    buffer_load_dwordx4 a[76:79], v251, s[28:31], s49 offen sc1
    s_mov_b32 s49, 1228800
    buffer_load_dwordx4 a[80:83], v250, s[28:31], s49 offen sc1
    buffer_load_dwordx4 a[84:87], v251, s[28:31], s49 offen sc1
    s_mov_b32 s49, 1351680
    buffer_load_dwordx4 a[88:91], v250, s[28:31], s49 offen sc1
    buffer_load_dwordx4 a[92:95], v251, s[28:31], s49 offen sc1
    s_mov_b32 s49, 1474560
    buffer_load_dwordx4 a[96:99], v250, s[28:31], s49 offen sc1
    buffer_load_dwordx4 a[100:103], v251, s[28:31], s49 offen sc1
    s_mov_b32 s49, 1597440
    buffer_load_dwordx4 a[104:107], v250, s[28:31], s49 offen sc1
    buffer_load_dwordx4 a[108:111], v251, s[28:31], s49 offen sc1
WDONE_11:
    s_branch MEGA_P3
MEGA_HELPER:
    s_mov_b32 s32, s6
    s_mov_b32 s33, s7
    s_mov_b32 s34, 0x280000
    s_mov_b32 s35, 0x20000
    s_mov_b32 s36, s8
    s_mov_b32 s37, s9
    s_mov_b32 s38, 0x280000
    s_mov_b32 s39, 0x20000
    s_mov_b32 s40, s10
    s_mov_b32 s41, s11
    s_mov_b32 s42, 0x1400
    s_mov_b32 s43, 0x20000
    s_and_b32 s49, s2, 31
    s_lshl_b32 s49, s49, 6
    s_lshr_b32 s50, s2, 5
    s_lshl_b32 s51, s50, 7
    v_lshrrev_b32 v9, 3, v1
    v_and_b32 v10, 7, v1
    s_add_u32 s52, s3, 0
    s_and_b32 s53, s52, 7
    s_lshl_b32 s54, s52, 3
    v_xor_b32 v11, s53, v10
    v_lshl_add_u32 v11, v11, 4, s51
    v_add_u32 v12, s54, v9
    s_sub_u32 s55, s49, 3
    v_add_u32 v13, s55, v12
    v_mul_i32_i24 v14, 1280, v13
    v_add_u32 v14, v14, v11
    v_cmp_gt_u32 vcc, 67, v12
    v_cmp_le_i32 s[56:57], 0, v13
    s_nop 1
    s_and_b64 vcc, vcc, s[56:57]
    v_mov_b32 v17, 0x7ff00000
    v_cndmask_b32 v14, v17, v14, vcc
    s_lshl_b32 s52, s52, 10
    s_add_u32 m0, s52, 0
    s_nop 0
    buffer_load_dwordx4 v14, s[32:35], 0 offen lds
    s_add_u32 s52, s3, 4
    s_and_b32 s53, s52, 7
    s_lshl_b32 s54, s52, 3
    v_xor_b32 v11, s53, v10
    v_lshl_add_u32 v11, v11, 4, s51
    v_add_u32 v12, s54, v9
    s_sub_u32 s55, s49, 3
    v_add_u32 v13, s55, v12
    v_mul_i32_i24 v15, 1280, v13
    v_add_u32 v15, v15, v11
    v_cmp_gt_u32 vcc, 67, v12
    v_cmp_le_i32 s[56:57], 0, v13
    s_nop 1
    s_and_b64 vcc, vcc, s[56:57]
    v_mov_b32 v17, 0x7ff00000
    v_cndmask_b32 v15, v17, v15, vcc
    s_lshl_b32 s52, s52, 10
    s_add_u32 m0, s52, 0
    s_nop 0
    buffer_load_dwordx4 v15, s[32:35], 0 offen lds
    s_add_u32 s52, s3, 8
    s_and_b32 s53, s52, 7
    s_lshl_b32 s54, s52, 3
    v_xor_b32 v11, s53, v10
    v_lshl_add_u32 v11, v11, 4, s51
    v_add_u32 v12, s54, v9
    s_sub_u32 s55, s49, 3
    v_add_u32 v13, s55, v12
    v_mul_i32_i24 v16, 1280, v13
    v_add_u32 v16, v16, v11
    v_cmp_gt_u32 vcc, 67, v12
    v_cmp_le_i32 s[56:57], 0, v13
    s_nop 1
    s_and_b64 vcc, vcc, s[56:57]
    v_mov_b32 v17, 0x7ff00000
    v_cndmask_b32 v16, v17, v16, vcc
    s_lshl_b32 s52, s52, 10
    s_add_u32 m0, s52, 0
    s_nop 0
    buffer_load_dwordx4 v16, s[32:35], 0 offen lds
    s_add_u32 s52, s3, 0
    s_lshl_b32 s54, s52, 3
    v_xor_b32 v11, s52, v10
    v_lshl_add_u32 v11, v11, 4, s51
    s_add_u32 s54, s54, s49
    v_add_u32 v13, s54, v9
    v_mul_u32_u24 v14, 1280, v13
    v_add_u32 v14, v14, v11
    s_lshl_b32 s52, s52, 10
    s_add_u32 m0, s52, 12288
    s_nop 0
    buffer_load_dwordx4 v14, s[36:39], 0 offen lds
    s_add_u32 s52, s3, 4
    s_lshl_b32 s54, s52, 3
    v_xor_b32 v11, s52, v10
    v_lshl_add_u32 v11, v11, 4, s51
    s_add_u32 s54, s54, s49
    v_add_u32 v13, s54, v9
    v_mul_u32_u24 v15, 1280, v13
    v_add_u32 v15, v15, v11
    s_lshl_b32 s52, s52, 10
    s_add_u32 m0, s52, 12288
    s_nop 0
    buffer_load_dwordx4 v15, s[36:39], 0 offen lds
    s_add_u32 s65, s2, 96
    s_cmp_lt_u32 s65, 320
    s_cselect_b64 s[66:67], -1, 0
    s_and_b32 s49, s65, 31
    s_lshl_b32 s49, s49, 6
    s_lshr_b32 s50, s65, 5
    s_lshl_b32 s51, s50, 7
    v_lshrrev_b32 v9, 3, v1
    v_and_b32 v10, 7, v1
    s_add_u32 s52, s3, 0
    s_and_b32 s53, s52, 7
    s_lshl_b32 s54, s52, 3
    v_xor_b32 v11, s53, v10
    v_lshl_add_u32 v11, v11, 4, s51
    v_add_u32 v12, s54, v9
    s_sub_u32 s55, s49, 3
    v_add_u32 v13, s55, v12
    v_mul_i32_i24 v14, 1280, v13
    v_add_u32 v14, v14, v11
    v_cmp_gt_u32 vcc, 67, v12
    v_cmp_le_i32 s[56:57], 0, v13
    s_nop 1
    s_and_b64 vcc, vcc, s[56:57]
    s_and_b64 vcc, vcc, s[66:67]
    v_mov_b32 v17, 0x7ff00000
    v_cndmask_b32 v14, v17, v14, vcc
    s_lshl_b32 s52, s52, 10
    s_add_u32 m0, s52, 20480
    s_nop 0
    buffer_load_dwordx4 v14, s[32:35], 0 offen lds
    s_add_u32 s52, s3, 4
    s_and_b32 s53, s52, 7
    s_lshl_b32 s54, s52, 3
    v_xor_b32 v11, s53, v10
    v_lshl_add_u32 v11, v11, 4, s51
    v_add_u32 v12, s54, v9
    s_sub_u32 s55, s49, 3
    v_add_u32 v13, s55, v12
    v_mul_i32_i24 v15, 1280, v13
    v_add_u32 v15, v15, v11
    v_cmp_gt_u32 vcc, 67, v12
    v_cmp_le_i32 s[56:57], 0, v13
    s_nop 1
    s_and_b64 vcc, vcc, s[56:57]
    s_and_b64 vcc, vcc, s[66:67]
    v_mov_b32 v17, 0x7ff00000
    v_cndmask_b32 v15, v17, v15, vcc
    s_lshl_b32 s52, s52, 10
    s_add_u32 m0, s52, 20480
    s_nop 0
    buffer_load_dwordx4 v15, s[32:35], 0 offen lds
    s_add_u32 s52, s3, 8
    s_and_b32 s53, s52, 7
    s_lshl_b32 s54, s52, 3
    v_xor_b32 v11, s53, v10
    v_lshl_add_u32 v11, v11, 4, s51
    v_add_u32 v12, s54, v9
    s_sub_u32 s55, s49, 3
    v_add_u32 v13, s55, v12
    v_mul_i32_i24 v16, 1280, v13
    v_add_u32 v16, v16, v11
    v_cmp_gt_u32 vcc, 67, v12
    v_cmp_le_i32 s[56:57], 0, v13
    s_nop 1
    s_and_b64 vcc, vcc, s[56:57]
    s_and_b64 vcc, vcc, s[66:67]
    v_mov_b32 v17, 0x7ff00000
    v_cndmask_b32 v16, v17, v16, vcc
    s_lshl_b32 s52, s52, 10
    s_add_u32 m0, s52, 20480
    s_nop 0
    buffer_load_dwordx4 v16, s[32:35], 0 offen lds
    s_add_u32 s52, s3, 0
    s_lshl_b32 s54, s52, 3
    v_xor_b32 v11, s52, v10
    v_lshl_add_u32 v11, v11, 4, s51
    s_add_u32 s54, s54, s49
    v_add_u32 v13, s54, v9
    v_mul_u32_u24 v14, 1280, v13
    v_add_u32 v14, v14, v11
    v_cndmask_b32 v14, v17, v14, s[66:67]
    s_lshl_b32 s52, s52, 10
    s_add_u32 m0, s52, 32768
    s_nop 0
    buffer_load_dwordx4 v14, s[36:39], 0 offen lds
    s_add_u32 s52, s3, 4
    s_lshl_b32 s54, s52, 3
    v_xor_b32 v11, s52, v10
    v_lshl_add_u32 v11, v11, 4, s51
    s_add_u32 s54, s54, s49
    v_add_u32 v13, s54, v9
    v_mul_u32_u24 v15, 1280, v13
    v_add_u32 v15, v15, v11
    v_cndmask_b32 v15, v17, v15, s[66:67]
    s_lshl_b32 s52, s52, 10
    s_add_u32 m0, s52, 32768
    s_nop 0
    buffer_load_dwordx4 v15, s[36:39], 0 offen lds
    s_and_b32 s49, s2, 31
    s_lshl_b32 s49, s49, 6
    s_lshr_b32 s50, s2, 5
    v_and_b32 v11, 7, v0
    v_lshrrev_b32 v12, 3, v0
    s_lshl_b32 s51, s50, 5
    v_add_u32 v13, s51, v12
    v_lshlrev_b32 v14, 4, v13
    buffer_load_dwordx4 v[24:27], v14, s[40:43], 0 offen
    v_lshl_add_u32 v8, v11, 3, s49
    v_lshlrev_b32 v8, 1, v8
    v_sub_u32 v8, 4080, v8
    v_lshl_add_u32 v8, v13, 13, v8
    v_lshrrev_b32 v14, 2, v12
    v_and_b32 v12, 3, v12
    v_lshlrev_b32 v12, 2, v12
    v_xor_b32 v9, v14, v11
    v_lshl_add_u32 v9, v9, 4, v12
    v_lshl_add_u32 v9, v11, 10, v9
    v_add_u32 v11, 1, v11
    v_and_b32 v13, 7, v11
    v_xor_b32 v10, v14, v13
    v_lshl_add_u32 v10, v10, 4, v12
    v_lshl_add_u32 v10, v11, 10, v10
    s_and_b32 s49, s65, 31
    s_lshl_b32 s49, s49, 6
    s_lshr_b32 s50, s65, 5
    v_and_b32 v19, 7, v0
    v_lshrrev_b32 v20, 3, v0
    s_lshl_b32 s51, s50, 5
    v_add_u32 v21, s51, v20
    v_lshlrev_b32 v22, 4, v21
    v_mov_b32 v23, 0x7ff00000
    v_cndmask_b32 v22, v23, v22, s[66:67]
    buffer_load_dwordx4 v[48:51], v22, s[40:43], 0 offen
    v_lshl_add_u32 v16, v19, 3, s49
    v_lshlrev_b32 v16, 1, v16
    v_sub_u32 v16, 4080, v16
    v_lshl_add_u32 v16, v21, 13, v16
    v_cndmask_b32 v16, v23, v16, s[66:67]
    v_lshrrev_b32 v22, 2, v20
    v_and_b32 v20, 3, v20
    v_lshlrev_b32 v20, 2, v20
    v_xor_b32 v17, v22, v19
    v_lshl_add_u32 v17, v17, 4, v20
    v_lshl_add_u32 v17, v19, 10, v17
    v_add_u32 v19, 1, v19
    v_and_b32 v21, 7, v19
    v_xor_b32 v18, v22, v21
    v_lshl_add_u32 v18, v18, 4, v20
    v_lshl_add_u32 v18, v19, 10, v18
    s_waitcnt lgkmcnt(0)
    s_mul_i32 s44, s44, 0x9E3779B1
    s_add_u32 s44, s44, 0x7F4A7C15
    s_cmp_lg_u32 s3, 0
    s_cbranch_scc1 NOXID_13
    s_getreg_b32 s49, hwreg(HW_REG_XCC_ID, 0, 4)
    s_and_b32 s50, s2, 7
    s_lshl_b32 s50, s50, 5
    s_lshr_b32 s51, s2, 3
    s_add_u32 s50, s50, s51
    s_lshl_b32 s50, s50, 3
    s_add_u32 s50, s50, 0xb78000
    v_mov_b32 v250, s50
    v_mov_b32 v252, s44
    v_mov_b32 v253, s49
    s_mov_b64 exec, 1
    buffer_store_dwordx2 v[252:253], v250, s[28:31], 0 offen sc1
    s_mov_b64 exec, -1
NOXID_13:
    s_waitcnt vmcnt(0)
    s_barrier
    ds_read_b32 v28, v9 offset:0
    ds_read_b32 v29, v9 offset:128
    ds_read_b32 v30, v9 offset:256
    ds_read_b32 v31, v9 offset:384
    ds_read_b32 v32, v9 offset:512
    ds_read_b32 v33, v9 offset:640
    ds_read_b32 v34, v9 offset:768
    ds_read_b32 v35, v9 offset:896
    ds_read_b32 v36, v10 offset:0
    ds_read_b32 v37, v10 offset:128
    ds_read_b32 v38, v10 offset:256
    ds_read_b32 v39, v9 offset:12288
    ds_read_b32 v40, v9 offset:12416
    ds_read_b32 v41, v9 offset:12544
    ds_read_b32 v42, v9 offset:12672
    ds_read_b32 v43, v9 offset:12800
    ds_read_b32 v44, v9 offset:12928
    ds_read_b32 v45, v9 offset:13056
    ds_read_b32 v46, v9 offset:13184
    s_waitcnt lgkmcnt(0)
    ds_read_b32 v52, v17 offset:20480
    ds_read_b32 v53, v17 offset:20608
    ds_read_b32 v54, v17 offset:20736
    ds_read_b32 v55, v17 offset:20864
    ds_read_b32 v56, v17 offset:20992
    ds_read_b32 v57, v17 offset:21120
    ds_read_b32 v58, v17 offset:21248
    ds_read_b32 v59, v17 offset:21376
    ds_read_b32 v60, v18 offset:20480
    ds_read_b32 v61, v18 offset:20608
    ds_read_b32 v62, v18 offset:20736
    ds_read_b32 v63, v17 offset:32768
    ds_read_b32 v64, v17 offset:32896
    ds_read_b32 v65, v17 offset:33024
    ds_read_b32 v66, v17 offset:33152
    ds_read_b32 v67, v17 offset:33280
    ds_read_b32 v68, v17 offset:33408
    ds_read_b32 v69, v17 offset:33536
    ds_read_b32 v70, v17 offset:33664
    s_mov_b32 s49, 0xffff0000
    v_lshlrev_b32 v72, 16, v24
    v_lshlrev_b32 v73, 16, v26
    v_and_b32 v74, s49, v24
    v_and_b32 v75, s49, v26
    v_lshlrev_b32 v76, 16, v25
    v_lshlrev_b32 v77, 16, v27
    v_and_b32 v78, s49, v25
    v_and_b32 v79, s49, v27
    v_lshlrev_b32 v80, 16, v28
    v_and_b32 v81, s49, v28
    v_lshlrev_b32 v82, 16, v29
    v_and_b32 v83, s49, v29
    v_lshlrev_b32 v84, 16, v30
    v_and_b32 v85, s49, v30
    v_lshlrev_b32 v86, 16, v31
    v_and_b32 v87, s49, v31
    v_lshlrev_b32 v88, 16, v32
    v_and_b32 v89, s49, v32
    v_lshlrev_b32 v90, 16, v33
    v_and_b32 v91, s49, v33
    v_lshlrev_b32 v92, 16, v34
    v_and_b32 v93, s49, v34
    v_lshlrev_b32 v94, 16, v35
    v_and_b32 v95, s49, v35
    v_lshlrev_b32 v96, 16, v36
    v_and_b32 v97, s49, v36
    v_lshlrev_b32 v98, 16, v37
    v_and_b32 v99, s49, v37
    v_lshlrev_b32 v100, 16, v38
    v_and_b32 v101, s49, v38
    v_pk_mul_f32 v[102:103], v[86:87], v[72:73]
    v_pk_mul_f32 v[104:105], v[88:89], v[72:73]
    v_pk_mul_f32 v[106:107], v[90:91], v[72:73]
    v_pk_mul_f32 v[108:109], v[92:93], v[72:73]
    v_pk_mul_f32 v[110:111], v[94:95], v[72:73]
    v_pk_mul_f32 v[112:113], v[96:97], v[72:73]
    v_pk_mul_f32 v[114:115], v[98:99], v[72:73]
    v_pk_mul_f32 v[116:117], v[100:101], v[72:73]
    v_pk_fma_f32 v[102:103], v[84:85], v[74:75], v[102:103]
    v_pk_fma_f32 v[104:105], v[86:87], v[74:75], v[104:105]
    v_pk_fma_f32 v[106:107], v[88:89], v[74:75], v[106:107]
    v_pk_fma_f32 v[108:109], v[90:91], v[74:75], v[108:109]
    v_pk_fma_f32 v[110:111], v[92:93], v[74:75], v[110:111]
    v_pk_fma_f32 v[112:113], v[94:95], v[74:75], v[112:113]
    v_pk_fma_f32 v[114:115], v[96:97], v[74:75], v[114:115]
    v_pk_fma_f32 v[116:117], v[98:99], v[74:75], v[116:117]
    v_pk_fma_f32 v[102:103], v[82:83], v[76:77], v[102:103]
    v_pk_fma_f32 v[104:105], v[84:85], v[76:77], v[104:105]
    v_pk_fma_f32 v[106:107], v[86:87], v[76:77], v[106:107]
    v_pk_fma_f32 v[108:109], v[88:89], v[76:77], v[108:109]
    v_pk_fma_f32 v[110:111], v[90:91], v[76:77], v[110:111]
    v_pk_fma_f32 v[112:113], v[92:93], v[76:77], v[112:113]
    v_pk_fma_f32 v[114:115], v[94:95], v[76:77], v[114:115]
    v_pk_fma_f32 v[116:117], v[96:97], v[76:77], v[116:117]
    v_pk_fma_f32 v[102:103], v[80:81], v[78:79], v[102:103]
    v_pk_fma_f32 v[104:105], v[82:83], v[78:79], v[104:105]
    v_pk_fma_f32 v[106:107], v[84:85], v[78:79], v[106:107]
    v_pk_fma_f32 v[108:109], v[86:87], v[78:79], v[108:109]
    v_pk_fma_f32 v[110:111], v[88:89], v[78:79], v[110:111]
    v_pk_fma_f32 v[112:113], v[90:91], v[78:79], v[112:113]
    v_pk_fma_f32 v[114:115], v[92:93], v[78:79], v[114:115]
    v_pk_fma_f32 v[116:117], v[94:95], v[78:79], v[116:117]
    v_lshlrev_b32 v80, 16, v39
    v_and_b32 v81, s49, v39
    v_lshlrev_b32 v82, 16, v40
    v_and_b32 v83, s49, v40
    v_lshlrev_b32 v84, 16, v41
    v_and_b32 v85, s49, v41
    v_lshlrev_b32 v86, 16, v42
    v_and_b32 v87, s49, v42
    v_lshlrev_b32 v88, 16, v43
    v_and_b32 v89, s49, v43
    v_lshlrev_b32 v90, 16, v44
    v_and_b32 v91, s49, v44
    v_lshlrev_b32 v92, 16, v45
    v_and_b32 v93, s49, v45
    v_lshlrev_b32 v94, 16, v46
    v_and_b32 v95, s49, v46
    v_pk_mul_f32 v[102:103], v[102:103], v[80:81]
    v_pk_mul_f32 v[104:105], v[104:105], v[82:83]
    v_pk_mul_f32 v[106:107], v[106:107], v[84:85]
    v_pk_mul_f32 v[108:109], v[108:109], v[86:87]
    v_pk_mul_f32 v[110:111], v[110:111], v[88:89]
    v_pk_mul_f32 v[112:113], v[112:113], v[90:91]
    v_pk_mul_f32 v[114:115], v[114:115], v[92:93]
    v_pk_mul_f32 v[116:117], v[116:117], v[94:95]
    v_cvt_pk_bf16_f32 v118, v116, v114
    v_cvt_pk_bf16_f32 v119, v112, v110
    v_cvt_pk_bf16_f32 v120, v108, v106
    v_cvt_pk_bf16_f32 v121, v104, v102
    v_cvt_pk_bf16_f32 v122, v117, v115
    v_cvt_pk_bf16_f32 v123, v113, v111
    v_cvt_pk_bf16_f32 v124, v109, v107
    v_cvt_pk_bf16_f32 v125, v105, v103
    v_add_u32 v11, 4096, v8
    buffer_store_dwordx4 v[118:121], v8, s[28:31], 0 offen sc1
    buffer_store_dwordx4 v[122:125], v11, s[28:31], 0 offen sc1
    s_waitcnt lgkmcnt(0)
    s_mov_b32 s49, 0xffff0000
    v_lshlrev_b32 v72, 16, v48
    v_lshlrev_b32 v73, 16, v50
    v_and_b32 v74, s49, v48
    v_and_b32 v75, s49, v50
    v_lshlrev_b32 v76, 16, v49
    v_lshlrev_b32 v77, 16, v51
    v_and_b32 v78, s49, v49
    v_and_b32 v79, s49, v51
    v_lshlrev_b32 v80, 16, v52
    v_and_b32 v81, s49, v52
    v_lshlrev_b32 v82, 16, v53
    v_and_b32 v83, s49, v53
    v_lshlrev_b32 v84, 16, v54
    v_and_b32 v85, s49, v54
    v_lshlrev_b32 v86, 16, v55
    v_and_b32 v87, s49, v55
    v_lshlrev_b32 v88, 16, v56
    v_and_b32 v89, s49, v56
    v_lshlrev_b32 v90, 16, v57
    v_and_b32 v91, s49, v57
    v_lshlrev_b32 v92, 16, v58
    v_and_b32 v93, s49, v58
    v_lshlrev_b32 v94, 16, v59
    v_and_b32 v95, s49, v59
    v_lshlrev_b32 v96, 16, v60
    v_and_b32 v97, s49, v60
    v_lshlrev_b32 v98, 16, v61
    v_and_b32 v99, s49, v61
    v_lshlrev_b32 v100, 16, v62
    v_and_b32 v101, s49, v62
    v_pk_mul_f32 v[102:103], v[86:87], v[72:73]
    v_pk_mul_f32 v[104:105], v[88:89], v[72:73]
    v_pk_mul_f32 v[106:107], v[90:91], v[72:73]
    v_pk_mul_f32 v[108:109], v[92:93], v[72:73]
    v_pk_mul_f32 v[110:111], v[94:95], v[72:73]
    v_pk_mul_f32 v[112:113], v[96:97], v[72:73]
    v_pk_mul_f32 v[114:115], v[98:99], v[72:73]
    v_pk_mul_f32 v[116:117], v[100:101], v[72:73]
    v_pk_fma_f32 v[102:103], v[84:85], v[74:75], v[102:103]
    v_pk_fma_f32 v[104:105], v[86:87], v[74:75], v[104:105]
    v_pk_fma_f32 v[106:107], v[88:89], v[74:75], v[106:107]
    v_pk_fma_f32 v[108:109], v[90:91], v[74:75], v[108:109]
    v_pk_fma_f32 v[110:111], v[92:93], v[74:75], v[110:111]
    v_pk_fma_f32 v[112:113], v[94:95], v[74:75], v[112:113]
    v_pk_fma_f32 v[114:115], v[96:97], v[74:75], v[114:115]
    v_pk_fma_f32 v[116:117], v[98:99], v[74:75], v[116:117]
    v_pk_fma_f32 v[102:103], v[82:83], v[76:77], v[102:103]
    v_pk_fma_f32 v[104:105], v[84:85], v[76:77], v[104:105]
    v_pk_fma_f32 v[106:107], v[86:87], v[76:77], v[106:107]
    v_pk_fma_f32 v[108:109], v[88:89], v[76:77], v[108:109]
    v_pk_fma_f32 v[110:111], v[90:91], v[76:77], v[110:111]
    v_pk_fma_f32 v[112:113], v[92:93], v[76:77], v[112:113]
    v_pk_fma_f32 v[114:115], v[94:95], v[76:77], v[114:115]
    v_pk_fma_f32 v[116:117], v[96:97], v[76:77], v[116:117]
    v_pk_fma_f32 v[102:103], v[80:81], v[78:79], v[102:103]
    v_pk_fma_f32 v[104:105], v[82:83], v[78:79], v[104:105]
    v_pk_fma_f32 v[106:107], v[84:85], v[78:79], v[106:107]
    v_pk_fma_f32 v[108:109], v[86:87], v[78:79], v[108:109]
    v_pk_fma_f32 v[110:111], v[88:89], v[78:79], v[110:111]
    v_pk_fma_f32 v[112:113], v[90:91], v[78:79], v[112:113]
    v_pk_fma_f32 v[114:115], v[92:93], v[78:79], v[114:115]
    v_pk_fma_f32 v[116:117], v[94:95], v[78:79], v[116:117]
    v_lshlrev_b32 v80, 16, v63
    v_and_b32 v81, s49, v63
    v_lshlrev_b32 v82, 16, v64
    v_and_b32 v83, s49, v64
    v_lshlrev_b32 v84, 16, v65
    v_and_b32 v85, s49, v65
    v_lshlrev_b32 v86, 16, v66
    v_and_b32 v87, s49, v66
    v_lshlrev_b32 v88, 16, v67
    v_and_b32 v89, s49, v67
    v_lshlrev_b32 v90, 16, v68
    v_and_b32 v91, s49, v68
    v_lshlrev_b32 v92, 16, v69
    v_and_b32 v93, s49, v69
    v_lshlrev_b32 v94, 16, v70
    v_and_b32 v95, s49, v70
    v_pk_mul_f32 v[102:103], v[102:103], v[80:81]
    v_pk_mul_f32 v[104:105], v[104:105], v[82:83]
    v_pk_mul_f32 v[106:107], v[106:107], v[84:85]
    v_pk_mul_f32 v[108:109], v[108:109], v[86:87]
    v_pk_mul_f32 v[110:111], v[110:111], v[88:89]
    v_pk_mul_f32 v[112:113], v[112:113], v[90:91]
    v_pk_mul_f32 v[114:115], v[114:115], v[92:93]
    v_pk_mul_f32 v[116:117], v[116:117], v[94:95]
    v_cvt_pk_bf16_f32 v118, v116, v114
    v_cvt_pk_bf16_f32 v119, v112, v110
    v_cvt_pk_bf16_f32 v120, v108, v106
    v_cvt_pk_bf16_f32 v121, v104, v102
    v_cvt_pk_bf16_f32 v122, v117, v115
    v_cvt_pk_bf16_f32 v123, v113, v111
    v_cvt_pk_bf16_f32 v124, v109, v107
    v_cvt_pk_bf16_f32 v125, v105, v103
    v_add_u32 v19, 4096, v16
    buffer_store_dwordx4 v[118:121], v16, s[28:31], 0 offen sc1
    buffer_store_dwordx4 v[122:125], v19, s[28:31], 0 offen sc1
    s_waitcnt vmcnt(0)
    s_barrier
    s_cmp_lg_u32 s3, 0
    s_cbranch_scc1 NOFLAG_14
    s_lshl_b32 s49, s2, 2
    s_add_u32 s49, s49, 0xb40000
    v_mov_b32 v130, s49
    v_mov_b32 v131, s44
    s_mov_b64 exec, 1
    buffer_store_dword v131, v130, s[28:31], 0 offen sc1
    s_mov_b64 exec, -1
NOFLAG_14:
    s_cmp_ge_u32 s65, 320
    s_cbranch_scc1 NOA2_15
    s_cmp_lg_u32 s3, 0
    s_cbranch_scc1 NOFLAG_16
    s_lshl_b32 s49, s65, 2
    s_add_u32 s49, s49, 0xb40000
    v_mov_b32 v130, s49
    v_mov_b32 v131, s44
    s_mov_b64 exec, 1
    buffer_store_dword v131, v130, s[28:31], 0 offen sc1
    s_mov_b64 exec, -1
NOFLAG_16:
NOA2_15:
    s_cmp_ge_u32 s2, 230
    s_cbranch_scc1 HELPEND_17
    s_sub_u32 s49, s2, 160
    s_lshl_b32 s49, s49, 2
    s_add_u32 s49, s49, s3
    s_mul_i32 s51, s49, 9363
    s_lshr_b32 s51, s51, 16
    s_mul_i32 s50, s51, 7
    s_sub_u32 s50, s49, s50
    s_mul_i32 s50, s50, 3
    s_cmp_eq_u32 s50, 18
    s_cselect_b32 s64, 0x7ff00000, 0
    s_cmp_ge_u32 s51, 30
    s_cbranch_scc1 CWO_19
    s_mov_b32 s40, s18
    s_mov_b32 s41, s19
    s_mov_b32 s42, 0x258000
    s_mov_b32 s43, 0x20000
    v_lshrrev_b32 v140, 3, v1
    v_and_b32 v141, 3, v140
    v_lshrrev_b32 v140, 2, v140
    v_lshl_add_u32 v141, v140, 4, v141
    s_lshl_b32 s52, s50, 5
    v_add_u32 v141, s52, v141
    v_mul_u32_u24 v141, 3840, v141
    v_and_b32 v140, 7, v1
    v_lshl_add_u32 v141, v140, 4, v141
    s_lshl_b32 s52, s51, 7
    v_add_u32 v145, s52, v141
    v_add_u32 v146, 0, v145
    v_add_u32 v147, 15360, v145
    v_add_u32 v148, 30720, v145
    v_add_u32 v149, 46080, v145
    s_lshl_b32 s52, s51, 4
    v_add_u32 v140, s52, v2
    s_mul_i32 s52, s50, 7680
    s_add_u32 s52, s52, 0xb00000
    v_lshl_add_u32 v139, v140, 4, s52
    s_mul_i32 s52, s50, 122880
    s_lshl_b32 s53, s51, 12
    s_add_u32 s52, s52, s53
    s_add_u32 s52, s52, 0x780000
    v_add_u32 v138, s52, v4
    s_mov_b32 s56, 122880
    s_mov_b32 s57, 7680
    v_add_u32 v152, 0, v146
    v_add_u32 v153, 0, v147
    v_add_u32 v154, 0, v148
    v_add_u32 v155, 0, v149
    v_add_u32 v156, 122880, v146
    v_add_u32 v157, 122880, v147
    v_add_u32 v158, 122880, v148
    v_add_u32 v159, 122880, v149
    v_add_u32 v160, 245760, v146
    v_add_u32 v161, 245760, v147
    v_add_u32 v162, 245760, v148
    v_add_u32 v163, 245760, v149
    s_branch CEND_20
CWO_19:
    s_sub_u32 s51, s51, 30
    s_mov_b32 s40, s20
    s_mov_b32 s41, s21
    s_mov_b32 s42, 0xc8000
    s_mov_b32 s43, 0x20000
    s_mul_i32 s52, s50, 40960
    s_lshl_b32 s53, s51, 12
    s_add_u32 s52, s52, s53
    s_add_u32 s52, s52, 0xa00000
    v_add_u32 v138, s52, v4
    v_mov_b32 v139, 0x7ff00000
    s_mov_b32 s56, 40960
    s_mov_b32 s57, 0
    v_lshrrev_b32 v145, 3, v1
    v_and_b32 v140, 3, v145
    v_lshrrev_b32 v145, 2, v145
    v_mul_u32_u24 v145, 20, v145
    v_add_u32 v145, v145, v140
    v_mul_u32_u24 v145, 1280, v145
    v_and_b32 v140, 7, v1
    v_lshl_add_u32 v145, v140, 4, v145
    s_lshl_b32 s52, s51, 7
    v_add_u32 v145, s52, v145
    s_add_u32 s52, s50, 0
    s_lshl_b32 s52, s52, 2
    s_add_u32 s52, s52, 0
    s_mul_i32 s54, s52, 205
    s_lshr_b32 s54, s54, 10
    s_mul_i32 s55, s54, 20
    s_lshl_b32 s52, s52, 2
    s_add_u32 s52, s52, s55
    s_mul_i32 s52, s52, 1280
    v_add_u32 v152, s52, v145
    s_add_u32 s52, s50, 0
    s_lshl_b32 s52, s52, 2
    s_add_u32 s52, s52, 1
    s_mul_i32 s54, s52, 205
    s_lshr_b32 s54, s54, 10
    s_mul_i32 s55, s54, 20
    s_lshl_b32 s52, s52, 2
    s_add_u32 s52, s52, s55
    s_mul_i32 s52, s52, 1280
    v_add_u32 v153, s52, v145
    s_add_u32 s52, s50, 0
    s_lshl_b32 s52, s52, 2
    s_add_u32 s52, s52, 2
    s_mul_i32 s54, s52, 205
    s_lshr_b32 s54, s54, 10
    s_mul_i32 s55, s54, 20
    s_lshl_b32 s52, s52, 2
    s_add_u32 s52, s52, s55
    s_mul_i32 s52, s52, 1280
    v_add_u32 v154, s52, v145
    s_add_u32 s52, s50, 0
    s_lshl_b32 s52, s52, 2
    s_add_u32 s52, s52, 3
    s_mul_i32 s54, s52, 205
    s_lshr_b32 s54, s54, 10
    s_mul_i32 s55, s54, 20
    s_lshl_b32 s52, s52, 2
    s_add_u32 s52, s52, s55
    s_mul_i32 s52, s52, 1280
    v_add_u32 v155, s52, v145
    s_add_u32 s52, s50, 1
    s_lshl_b32 s52, s52, 2
    s_add_u32 s52, s52, 0
    s_mul_i32 s54, s52, 205
    s_lshr_b32 s54, s54, 10
    s_mul_i32 s55, s54, 20
    s_lshl_b32 s52, s52, 2
    s_add_u32 s52, s52, s55
    s_mul_i32 s52, s52, 1280
    v_add_u32 v156, s52, v145
    s_add_u32 s52, s50, 1
    s_lshl_b32 s52, s52, 2
    s_add_u32 s52, s52, 1
    s_mul_i32 s54, s52, 205
    s_lshr_b32 s54, s54, 10
    s_mul_i32 s55, s54, 20
    s_lshl_b32 s52, s52, 2
    s_add_u32 s52, s52, s55
    s_mul_i32 s52, s52, 1280
    v_add_u32 v157, s52, v145
    s_add_u32 s52, s50, 1
    s_lshl_b32 s52, s52, 2
    s_add_u32 s52, s52, 2
    s_mul_i32 s54, s52, 205
    s_lshr_b32 s54, s54, 10
    s_mul_i32 s55, s54, 20
    s_lshl_b32 s52, s52, 2
    s_add_u32 s52, s52, s55
    s_mul_i32 s52, s52, 1280
    v_add_u32 v158, s52, v145
    s_add_u32 s52, s50, 1
    s_lshl_b32 s52, s52, 2
    s_add_u32 s52, s52, 3
    s_mul_i32 s54, s52, 205
    s_lshr_b32 s54, s54, 10
    s_mul_i32 s55, s54, 20
    s_lshl_b32 s52, s52, 2
    s_add_u32 s52, s52, s55
    s_mul_i32 s52, s52, 1280
    v_add_u32 v159, s52, v145
    s_add_u32 s52, s50, 2
    s_lshl_b32 s52, s52, 2
    s_add_u32 s52, s52, 0
    s_mul_i32 s54, s52, 205
    s_lshr_b32 s54, s54, 10
    s_mul_i32 s55, s54, 20
    s_lshl_b32 s52, s52, 2
    s_add_u32 s52, s52, s55
    s_mul_i32 s52, s52, 1280
    v_add_u32 v160, s52, v145
    s_add_u32 s52, s50, 2
    s_lshl_b32 s52, s52, 2
    s_add_u32 s52, s52, 1
    s_mul_i32 s54, s52, 205
    s_lshr_b32 s54, s54, 10
    s_mul_i32 s55, s54, 20
    s_lshl_b32 s52, s52, 2
    s_add_u32 s52, s52, s55
    s_mul_i32 s52, s52, 1280
    v_add_u32 v161, s52, v145
    s_add_u32 s52, s50, 2
    s_lshl_b32 s52, s52, 2
    s_add_u32 s52, s52, 2
    s_mul_i32 s54, s52, 205
    s_lshr_b32 s54, s54, 10
    s_mul_i32 s55, s54, 20
    s_lshl_b32 s52, s52, 2
    s_add_u32 s52, s52, s55
    s_mul_i32 s52, s52, 1280
    v_add_u32 v162, s52, v145
    s_add_u32 s52, s50, 2
    s_lshl_b32 s52, s52, 2
    s_add_u32 s52, s52, 3
    s_mul_i32 s54, s52, 205
    s_lshr_b32 s54, s54, 10
    s_mul_i32 s55, s54, 20
    s_lshl_b32 s52, s52, 2
    s_add_u32 s52, s52, s55
    s_mul_i32 s52, s52, 1280
    v_add_u32 v163, s52, v145
CEND_20:
    v_or_b32 v160, s64, v160
    v_or_b32 v161, s64, v161
    v_or_b32 v162, s64, v162
    v_or_b32 v163, s64, v163
    s_cmp_ge_u32 s2, 230
    s_cselect_b32 s52, 0x7ff00000, 0
    v_or_b32 v152, s52, v152
    v_or_b32 v153, s52, v153
    v_or_b32 v154, s52, v154
    v_or_b32 v155, s52, v155
    v_or_b32 v156, s52, v156
    v_or_b32 v157, s52, v157
    v_or_b32 v158, s52, v158
    v_or_b32 v159, s52, v159
    v_or_b32 v160, s52, v160
    v_or_b32 v161, s52, v161
    v_or_b32 v162, s52, v162
    v_or_b32 v163, s52, v163
    s_lshl_b32 s52, s3, 14
    s_add_u32 s52, s52, 40960
    s_add_u32 m0, s52, 0
    s_nop 0
    buffer_load_dwordx4 v152, s[40:43], 0 offen lds
    s_add_u32 m0, s52, 1024
    s_nop 0
    buffer_load_dwordx4 v153, s[40:43], 0 offen lds
    s_add_u32 m0, s52, 2048
    s_nop 0
    buffer_load_dwordx4 v154, s[40:43], 0 offen lds
    s_add_u32 m0, s52, 3072
    s_nop 0
    buffer_load_dwordx4 v155, s[40:43], 0 offen lds
    s_add_u32 m0, s52, 4096
    s_nop 0
    buffer_load_dwordx4 v156, s[40:43], 0 offen lds
    s_add_u32 m0, s52, 5120
    s_nop 0
    buffer_load_dwordx4 v157, s[40:43], 0 offen lds
    s_add_u32 m0, s52, 6144
    s_nop 0
    buffer_load_dwordx4 v158, s[40:43], 0 offen lds
    s_add_u32 m0, s52, 7168
    s_nop 0
    buffer_load_dwordx4 v159, s[40:43], 0 offen lds
    s_add_u32 m0, s52, 8192
    s_nop 0
    buffer_load_dwordx4 v160, s[40:43], 0 offen lds
    s_add_u32 m0, s52, 9216
    s_nop 0
    buffer_load_dwordx4 v161, s[40:43], 0 offen lds
    s_add_u32 m0, s52, 10240
    s_nop 0
    buffer_load_dwordx4 v162, s[40:43], 0 offen lds
    s_add_u32 m0, s52, 11264
    s_nop 0
    buffer_load_dwordx4 v163, s[40:43], 0 offen lds
    v_mov_b32 v144, 0x7ff00000
    v_cmp_eq_u32 vcc, 0, v3
    s_nop 1
    v_cndmask_b32 v139, v144, v139, vcc
    s_mov_b32 s54, 0x05040100
    s_mov_b32 s55, 0x07060302
    s_mov_b32 s60, 0x3f803f80
    s_mul_i32 s49, s3, 5120
    s_add_u32 s49, s49, 106496
    v_mul_u32_u24 v6, 80, v1
    v_add_u32 v6, s49, v6
    v_bfe_u32 v7, v1, 2, 2
    v_lshl_add_u32 v7, v7, 4, v3
    v_mul_u32_u24 v7, 80, v7
    v_and_b32 v10, 3, v1
    v_lshl_add_u32 v7, v10, 4, v7
    v_add_u32 v7, s49, v7
    s_lshl_b32 s49, s3, 14
    s_add_u32 s49, s49, 40960
    v_lshlrev_b32 v11, 10, v3
    v_lshl_add_u32 v11, v2, 3, v11
    v_add_u32 v11, s49, v11
    s_mov_b32 s62, 0
    s_mov_b32 s59, 0
    s_waitcnt vmcnt(8)
    ds_read_b64 v[48:49], v11 offset:0
    ds_read_b64 v[50:51], v11 offset:128
    ds_read_b64 v[52:53], v11 offset:256
    ds_read_b64 v[54:55], v11 offset:384
    ds_read_b64 v[56:57], v11 offset:512
    ds_read_b64 v[58:59], v11 offset:640
    ds_read_b64 v[60:61], v11 offset:768
    ds_read_b64 v[62:63], v11 offset:896
    s_waitcnt lgkmcnt(0)
    v_perm_b32 v64, v50, v48, s54
    v_perm_b32 v65, v54, v52, s54
    v_perm_b32 v66, v58, v56, s54
    v_perm_b32 v67, v62, v60, s54
    v_perm_b32 v68, v50, v48, s55
    v_perm_b32 v69, v54, v52, s55
    v_perm_b32 v70, v58, v56, s55
    v_perm_b32 v71, v62, v60, s55
    v_perm_b32 v72, v51, v49, s54
    v_perm_b32 v73, v55, v53, s54
    v_perm_b32 v74, v59, v57, s54
    v_perm_b32 v75, v63, v61, s54
    v_perm_b32 v76, v51, v49, s55
    v_perm_b32 v77, v55, v53, s55
    v_perm_b32 v78, v59, v57, s55
    v_perm_b32 v79, v63, v61, s55
    ds_write_b128 v6, v[64:67] offset:0
    ds_write_b128 v6, v[68:71] offset:16
    ds_write_b128 v6, v[72:75] offset:32
    ds_write_b128 v6, v[76:79] offset:48
    v_mov_b32 v80, 0
    v_mov_b32 v81, 0
    v_mov_b32 v82, 0
    v_mov_b32 v83, 0
    v_dot2_f32_bf16 v80, v64, s60, v80
    v_dot2_f32_bf16 v81, v68, s60, v81
    v_dot2_f32_bf16 v82, v72, s60, v82
    v_dot2_f32_bf16 v83, v76, s60, v83
    v_dot2_f32_bf16 v80, v65, s60, v80
    v_dot2_f32_bf16 v81, v69, s60, v81
    v_dot2_f32_bf16 v82, v73, s60, v82
    v_dot2_f32_bf16 v83, v77, s60, v83
    v_dot2_f32_bf16 v80, v66, s60, v80
    v_dot2_f32_bf16 v81, v70, s60, v81
    v_dot2_f32_bf16 v82, v74, s60, v82
    v_dot2_f32_bf16 v83, v78, s60, v83
    v_dot2_f32_bf16 v80, v67, s60, v80
    v_dot2_f32_bf16 v81, v71, s60, v81
    v_dot2_f32_bf16 v82, v75, s60, v82
    v_dot2_f32_bf16 v83, v79, s60, v83
    s_waitcnt lgkmcnt(0)
    ds_read_b128 v[96:99], v7 offset:0
    ds_read_b128 v[100:103], v7 offset:320
    ds_read_b128 v[104:107], v7 offset:640
    ds_read_b128 v[108:111], v7 offset:960
    v_mov_b32 v84, v80
    v_mov_b32 v85, v81
    v_mov_b32 v86, v82
    v_mov_b32 v87, v83
    v_permlane16_swap_b32 v80, v84
    v_permlane16_swap_b32 v81, v85
    v_permlane16_swap_b32 v82, v86
    v_permlane16_swap_b32 v83, v87
    v_add_f32 v80, v80, v84
    v_add_f32 v81, v81, v85
    v_add_f32 v82, v82, v86
    v_add_f32 v83, v83, v87
    v_mov_b32 v84, v80
    v_mov_b32 v85, v81
    v_mov_b32 v86, v82
    v_mov_b32 v87, v83
    v_permlane32_swap_b32 v80, v84
    v_permlane32_swap_b32 v81, v85
    v_permlane32_swap_b32 v82, v86
    v_permlane32_swap_b32 v83, v87
    v_add_f32 v80, v80, v84
    v_add_f32 v81, v81, v85
    v_add_f32 v82, v82, v86
    v_add_f32 v83, v83, v87
    buffer_store_dwordx4 v[80:83], v139, s[28:31], s59 offen sc1
    s_waitcnt lgkmcnt(0)
    buffer_store_dwordx4 v[96:99], v138, s[28:31], s62 offen offset:0 sc1
    buffer_store_dwordx4 v[100:103], v138, s[28:31], s62 offen offset:1024 sc1
    buffer_store_dwordx4 v[104:107], v138, s[28:31], s62 offen offset:2048 sc1
    buffer_store_dwordx4 v[108:111], v138, s[28:31], s62 offen offset:3072 sc1
    s_add_u32 s62, s62, s56
    s_add_u32 s59, s59, s57
    s_waitcnt vmcnt(9)
    ds_read_b64 v[48:49], v11 offset:4096
    ds_read_b64 v[50:51], v11 offset:4224
    ds_read_b64 v[52:53], v11 offset:4352
    ds_read_b64 v[54:55], v11 offset:4480
    ds_read_b64 v[56:57], v11 offset:4608
    ds_read_b64 v[58:59], v11 offset:4736
    ds_read_b64 v[60:61], v11 offset:4864
    ds_read_b64 v[62:63], v11 offset:4992
    s_waitcnt lgkmcnt(0)
    v_perm_b32 v64, v50, v48, s54
    v_perm_b32 v65, v54, v52, s54
    v_perm_b32 v66, v58, v56, s54
    v_perm_b32 v67, v62, v60, s54
    v_perm_b32 v68, v50, v48, s55
    v_perm_b32 v69, v54, v52, s55
    v_perm_b32 v70, v58, v56, s55
    v_perm_b32 v71, v62, v60, s55
    v_perm_b32 v72, v51, v49, s54
    v_perm_b32 v73, v55, v53, s54
    v_perm_b32 v74, v59, v57, s54
    v_perm_b32 v75, v63, v61, s54
    v_perm_b32 v76, v51, v49, s55
    v_perm_b32 v77, v55, v53, s55
    v_perm_b32 v78, v59, v57, s55
    v_perm_b32 v79, v63, v61, s55
    ds_write_b128 v6, v[64:67] offset:0
    ds_write_b128 v6, v[68:71] offset:16
    ds_write_b128 v6, v[72:75] offset:32
    ds_write_b128 v6, v[76:79] offset:48
    v_mov_b32 v80, 0
    v_mov_b32 v81, 0
    v_mov_b32 v82, 0
    v_mov_b32 v83, 0
    v_dot2_f32_bf16 v80, v64, s60, v80
    v_dot2_f32_bf16 v81, v68, s60, v81
    v_dot2_f32_bf16 v82, v72, s60, v82
    v_dot2_f32_bf16 v83, v76, s60, v83
    v_dot2_f32_bf16 v80, v65, s60, v80
    v_dot2_f32_bf16 v81, v69, s60, v81
    v_dot2_f32_bf16 v82, v73, s60, v82
    v_dot2_f32_bf16 v83, v77, s60, v83
    v_dot2_f32_bf16 v80, v66, s60, v80
    v_dot2_f32_bf16 v81, v70, s60, v81
    v_dot2_f32_bf16 v82, v74, s60, v82
    v_dot2_f32_bf16 v83, v78, s60, v83
    v_dot2_f32_bf16 v80, v67, s60, v80
    v_dot2_f32_bf16 v81, v71, s60, v81
    v_dot2_f32_bf16 v82, v75, s60, v82
    v_dot2_f32_bf16 v83, v79, s60, v83
    s_waitcnt lgkmcnt(0)
    ds_read_b128 v[96:99], v7 offset:0
    ds_read_b128 v[100:103], v7 offset:320
    ds_read_b128 v[104:107], v7 offset:640
    ds_read_b128 v[108:111], v7 offset:960
    v_mov_b32 v84, v80
    v_mov_b32 v85, v81
    v_mov_b32 v86, v82
    v_mov_b32 v87, v83
    v_permlane16_swap_b32 v80, v84
    v_permlane16_swap_b32 v81, v85
    v_permlane16_swap_b32 v82, v86
    v_permlane16_swap_b32 v83, v87
    v_add_f32 v80, v80, v84
    v_add_f32 v81, v81, v85
    v_add_f32 v82, v82, v86
    v_add_f32 v83, v83, v87
    v_mov_b32 v84, v80
    v_mov_b32 v85, v81
    v_mov_b32 v86, v82
    v_mov_b32 v87, v83
    v_permlane32_swap_b32 v80, v84
    v_permlane32_swap_b32 v81, v85
    v_permlane32_swap_b32 v82, v86
    v_permlane32_swap_b32 v83, v87
    v_add_f32 v80, v80, v84
    v_add_f32 v81, v81, v85
    v_add_f32 v82, v82, v86
    v_add_f32 v83, v83, v87
    buffer_store_dwordx4 v[80:83], v139, s[28:31], s59 offen sc1
    s_waitcnt lgkmcnt(0)
    buffer_store_dwordx4 v[96:99], v138, s[28:31], s62 offen offset:0 sc1
    buffer_store_dwordx4 v[100:103], v138, s[28:31], s62 offen offset:1024 sc1
    buffer_store_dwordx4 v[104:107], v138, s[28:31], s62 offen offset:2048 sc1
    buffer_store_dwordx4 v[108:111], v138, s[28:31], s62 offen offset:3072 sc1
    s_add_u32 s62, s62, s56
    s_add_u32 s59, s59, s57
    s_or_b32 s62, s62, s64
    s_or_b32 s59, s59, s64
    s_waitcnt vmcnt(10)
    ds_read_b64 v[48:49], v11 offset:8192
    ds_read_b64 v[50:51], v11 offset:8320
    ds_read_b64 v[52:53], v11 offset:8448
    ds_read_b64 v[54:55], v11 offset:8576
    ds_read_b64 v[56:57], v11 offset:8704
    ds_read_b64 v[58:59], v11 offset:8832
    ds_read_b64 v[60:61], v11 offset:8960
    ds_read_b64 v[62:63], v11 offset:9088
    s_waitcnt lgkmcnt(0)
    v_perm_b32 v64, v50, v48, s54
    v_perm_b32 v65, v54, v52, s54
    v_perm_b32 v66, v58, v56, s54
    v_perm_b32 v67, v62, v60, s54
    v_perm_b32 v68, v50, v48, s55
    v_perm_b32 v69, v54, v52, s55
    v_perm_b32 v70, v58, v56, s55
    v_perm_b32 v71, v62, v60, s55
    v_perm_b32 v72, v51, v49, s54
    v_perm_b32 v73, v55, v53, s54
    v_perm_b32 v74, v59, v57, s54
    v_perm_b32 v75, v63, v61, s54
    v_perm_b32 v76, v51, v49, s55
    v_perm_b32 v77, v55, v53, s55
    v_perm_b32 v78, v59, v57, s55
    v_perm_b32 v79, v63, v61, s55
    ds_write_b128 v6, v[64:67] offset:0
    ds_write_b128 v6, v[68:71] offset:16
    ds_write_b128 v6, v[72:75] offset:32
    ds_write_b128 v6, v[76:79] offset:48
    v_mov_b32 v80, 0
    v_mov_b32 v81, 0
    v_mov_b32 v82, 0
    v_mov_b32 v83, 0
    v_dot2_f32_bf16 v80, v64, s60, v80
    v_dot2_f32_bf16 v81, v68, s60, v81
    v_dot2_f32_bf16 v82, v72, s60, v82
    v_dot2_f32_bf16 v83, v76, s60, v83
    v_dot2_f32_bf16 v80, v65, s60, v80
    v_dot2_f32_bf16 v81, v69, s60, v81
    v_dot2_f32_bf16 v82, v73, s60, v82
    v_dot2_f32_bf16 v83, v77, s60, v83
    v_dot2_f32_bf16 v80, v66, s60, v80
    v_dot2_f32_bf16 v81, v70, s60, v81
    v_dot2_f32_bf16 v82, v74, s60, v82
    v_dot2_f32_bf16 v83, v78, s60, v83
    v_dot2_f32_bf16 v80, v67, s60, v80
    v_dot2_f32_bf16 v81, v71, s60, v81
    v_dot2_f32_bf16 v82, v75, s60, v82
    v_dot2_f32_bf16 v83, v79, s60, v83
    s_waitcnt lgkmcnt(0)
    ds_read_b128 v[96:99], v7 offset:0
    ds_read_b128 v[100:103], v7 offset:320
    ds_read_b128 v[104:107], v7 offset:640
    ds_read_b128 v[108:111], v7 offset:960
    v_mov_b32 v84, v80
    v_mov_b32 v85, v81
    v_mov_b32 v86, v82
    v_mov_b32 v87, v83
    v_permlane16_swap_b32 v80, v84
    v_permlane16_swap_b32 v81, v85
    v_permlane16_swap_b32 v82, v86
    v_permlane16_swap_b32 v83, v87
    v_add_f32 v80, v80, v84
    v_add_f32 v81, v81, v85
    v_add_f32 v82, v82, v86
    v_add_f32 v83, v83, v87
    v_mov_b32 v84, v80
    v_mov_b32 v85, v81
    v_mov_b32 v86, v82
    v_mov_b32 v87, v83
    v_permlane32_swap_b32 v80, v84
    v_permlane32_swap_b32 v81, v85
    v_permlane32_swap_b32 v82, v86
    v_permlane32_swap_b32 v83, v87
    v_add_f32 v80, v80, v84
    v_add_f32 v81, v81, v85
    v_add_f32 v82, v82, v86
    v_add_f32 v83, v83, v87
    buffer_store_dwordx4 v[80:83], v139, s[28:31], s59 offen sc1
    s_waitcnt lgkmcnt(0)
    buffer_store_dwordx4 v[96:99], v138, s[28:31], s62 offen offset:0 sc1
    buffer_store_dwordx4 v[100:103], v138, s[28:31], s62 offen offset:1024 sc1
    buffer_store_dwordx4 v[104:107], v138, s[28:31], s62 offen offset:2048 sc1
    buffer_store_dwordx4 v[108:111], v138, s[28:31], s62 offen offset:3072 sc1
    s_add_u32 s62, s62, s56
    s_add_u32 s59, s59, s57
    s_sub_u32 s58, s2, 160
    s_waitcnt vmcnt(0)
    s_barrier
    s_cmp_lg_u32 s3, 0
    s_cbranch_scc1 NOFLAG_21
    s_lshl_b32 s49, s58, 2
    s_add_u32 s49, s49, 0xb44200
    v_mul_u32_u24 v130, 2048, v1
    v_add_u32 v130, s49, v130
    v_mov_b32 v131, s44
    s_mov_b64 exec, 255
    buffer_store_dword v131, v130, s[28:31], 0 offen sc1
    s_mov_b64 exec, -1
NOFLAG_21:
HELPEND_17:
    s_cmp_lg_u32 s3, 0
    s_cbranch_scc1 POLLDONE_22
    s_mov_b32 s49, 0xb44200
    s_and_b32 s50, s2, 7
    s_mul_i32 s50, s50, 2048
    s_add_u32 s49, s49, s50
    v_add_u32 v200, 0, v1
    v_lshl_add_u32 v200, v200, 2, s49
    v_add_u32 v201, 64, v1
    v_min_u32 v201, 69, v201
    v_lshl_add_u32 v201, v201, 2, s49
    s_mov_b32 s51, 0x8000
POLL_23:
    buffer_load_dword v202, v200, s[28:31], 0 offen sc1
    buffer_load_dword v203, v201, s[28:31], 0 offen sc1
    s_waitcnt vmcnt(0)
    v_cmp_ne_u32 vcc, s44, v202
    v_cmp_ne_u32 s[52:53], s44, v203
    s_nop 1
    s_or_b64 vcc, vcc, s[52:53]
    s_cbranch_vccz POLLDONE_22
    s_sleep 8
    s_sub_u32 s51, s51, 1
    s_cmp_lg_u32 s51, 0
    s_cbranch_scc1 POLL_23
POLLDONE_22:
    s_barrier
    v_lshrrev_b32 v184, 2, v2
    s_mul_i32 s49, s3, 160
    s_cmp_eq_u32 s3, 3
    s_cselect_b32 s49, 325, s49
    v_add_u32 v185, s49, v184
    v_and_b32 v186, 1, v184
    v_mul_u32_u24 v186, 5, v186
    v_lshrrev_b32 v187, 1, v184
    v_mul_u32_u24 v187, 160, v187
    v_add3_u32 v186, v186, v187, 4
    s_cmp_eq_u32 s3, 2
    s_cselect_b64 s[52:53], -1, 0
    v_cndmask_b32 v250, v185, v186, s[52:53]
    s_mul_i32 s49, s3, 160
    s_add_u32 s50, s49, 5
    s_cmp_eq_u32 s3, 2
    s_cselect_b32 s49, s49, s50
    v_add_u32 v185, s49, v184
    v_mul_u32_u24 v186, 5, v184
    v_add_u32 v186, 324, v186
    s_cmp_eq_u32 s3, 3
    s_cselect_b64 s[52:53], -1, 0
    v_cndmask_b32 v251, v185, v186, s[52:53]
    s_mul_i32 s49, s46, 10
    v_lshlrev_b32 v184, 6, v3
    v_and_b32 v185, 3, v2
    v_lshl_add_u32 v184, v185, 4, v184
    v_add_u32 v184, 0x780000, v184
    v_add_u32 v250, s49, v250
    v_lshl_add_u32 v250, v250, 8, v184
    v_add_u32 v251, s49, v251
    v_lshl_add_u32 v251, v251, 8, v184
    v_cmp_le_u32 vcc, 8, v2
    s_nop 1
    s_and_b64 vcc, vcc, s[52:53]
    v_mov_b32 v187, 0x7ff00000
    v_cndmask_b32 v251, v251, v187, vcc
    s_mov_b32 s49, 0
    buffer_load_dwordx4 a[0:3], v250, s[28:31], s49 offen sc1
    buffer_load_dwordx4 a[4:7], v251, s[28:31], s49 offen sc1
    s_mov_b32 s49, 122880
    buffer_load_dwordx4 a[8:11], v250, s[28:31], s49 offen sc1
    buffer_load_dwordx4 a[12:15], v251, s[28:31], s49 offen sc1
    s_mov_b32 s49, 245760
    buffer_load_dwordx4 a[16:19], v250, s[28:31], s49 offen sc1
    buffer_load_dwordx4 a[20:23], v251, s[28:31], s49 offen sc1
    s_mov_b32 s49, 368640
    buffer_load_dwordx4 a[24:27], v250, s[28:31], s49 offen sc1
    buffer_load_dwordx4 a[28:31], v251, s[28:31], s49 offen sc1
    s_mov_b32 s49, 491520
    buffer_load_dwordx4 a[32:35], v250, s[28:31], s49 offen sc1
    buffer_load_dwordx4 a[36:39], v251, s[28:31], s49 offen sc1
    s_mov_b32 s49, 614400
    buffer_load_dwordx4 a[40:43], v250, s[28:31], s49 offen sc1
    buffer_load_dwordx4 a[44:47], v251, s[28:31], s49 offen sc1
    s_mov_b32 s49, 737280
    buffer_load_dwordx4 a[48:51], v250, s[28:31], s49 offen sc1
    buffer_load_dwordx4 a[52:55], v251, s[28:31], s49 offen sc1
    s_mov_b32 s49, 860160
    buffer_load_dwordx4 a[56:59], v250, s[28:31], s49 offen sc1
    buffer_load_dwordx4 a[60:63], v251, s[28:31], s49 offen sc1
    s_mov_b32 s49, 983040
    buffer_load_dwordx4 a[64:67], v250, s[28:31], s49 offen sc1
    buffer_load_dwordx4 a[68:71], v251, s[28:31], s49 offen sc1
    s_mov_b32 s49, 1105920
    buffer_load_dwordx4 a[72:75], v250, s[28:31], s49 offen sc1
    buffer_load_dwordx4 a[76:79], v251, s[28:31], s49 offen sc1
    s_mov_b32 s49, 1228800
    buffer_load_dwordx4 a[80:83], v250, s[28:31], s49 offen sc1
    buffer_load_dwordx4 a[84:87], v251, s[28:31], s49 offen sc1
    s_mov_b32 s49, 1351680
    buffer_load_dwordx4 a[88:91], v250, s[28:31], s49 offen sc1
    buffer_load_dwordx4 a[92:95], v251, s[28:31], s49 offen sc1
    s_mov_b32 s49, 1474560
    buffer_load_dwordx4 a[96:99], v250, s[28:31], s49 offen sc1
    buffer_load_dwordx4 a[100:103], v251, s[28:31], s49 offen sc1
    s_mov_b32 s49, 1597440
    buffer_load_dwordx4 a[104:107], v250, s[28:31], s49 offen sc1
    buffer_load_dwordx4 a[108:111], v251, s[28:31], s49 offen sc1
    s_lshr_b32 s49, s2, 3
    s_sub_u32 s49, s49, 20
    s_lshl_b32 s49, s49, 2
    s_add_u32 s49, s49, s3
    s_mul_i32 s50, s49, 21846
    s_lshr_b32 s50, s50, 16
    s_mul_i32 s51, s50, 3
    s_sub_u32 s51, s49, s51
    s_mul_i32 s50, s50, 122880
    s_mul_i32 s51, s51, 40960
    s_add_u32 s50, s50, s51
    s_add_u32 s50, s50, 0x787800
    s_cmp_ge_u32 s49, 42
    s_cselect_b32 s50, 0x7ff00000, s50
    v_lshl_add_u32 v8, v1, 7, s50
    buffer_load_dword v254, v8, s[28:31], 0 offen sc1
    v_and_b32 v9, 15, v1
    s_add_u32 s50, s50, 8192
    v_lshl_add_u32 v9, v9, 7, s50
    buffer_load_dword v254, v9, s[28:31], 0 offen sc1
MEGA_P3:
    v_and_b32 v8, 127, v0
    v_lshrrev_b32 v9, 7, v0
    v_lshrrev_b32 v10, 4, v8
    v_and_b32 v11, 15, v8
    v_and_b32 v12, 1, v10
    v_cmp_le_u32 vcc, 5, v10
    v_xor_b32 v13, 1, v12
    s_nop 0
    v_cndmask_b32 v12, v12, v13, vcc
    v_mov_b32 v13, 0
    v_cmp_le_u32 vcc, 2, v10
    v_mov_b32 v14, 640
    s_nop 0
    v_cndmask_b32 v13, v13, v14, vcc
    v_cmp_le_u32 vcc, 5, v10
    v_mov_b32 v14, 1280
    s_nop 0
    v_cndmask_b32 v13, v13, v14, vcc
    v_mul_u32_u24 v12, 20, v12
    v_add3_u32 v12, v12, v13, v11
    v_lshrrev_b32 v13, 3, v11
    v_mul_u32_u24 v13, 640, v13
    v_bfe_u32 v14, v11, 2, 1
    v_mul_u32_u24 v14, 20, v14
    v_and_b32 v15, 3, v11
    v_add3_u32 v13, v13, v14, v15
    v_add_u32 v13, 16, v13
    v_cmp_eq_u32 vcc, 4, v10
    s_nop 1
    v_cndmask_b32 v12, v12, v13, vcc
    v_lshrrev_b32 v13, 2, v11
    v_mul_u32_u24 v13, 20, v13
    v_add_u32 v13, v13, v15
    v_add_u32 v13, 1296, v13
    v_cmp_eq_u32 vcc, 7, v10
    s_nop 1
    v_cndmask_b32 v12, v12, v13, vcc
    s_mul_i32 s49, s46, 40
    v_add_u32 v12, s49, v12
    v_mul_u32_u24 v13, 76800, v9
    v_lshl_add_u32 v12, v12, 2, v13
    v_add_u32 v12, 0xb00000, v12
    v_cmp_le_u32 vcc, 120, v8
    v_mov_b32 v13, 0x7ff00000
    s_nop 0
    v_cndmask_b32 v12, v12, v13, vcc
    s_mov_b32 s49, 0
    buffer_load_dword v88, v12, s[28:31], s49 offen sc1
    s_mov_b32 s49, 7680
    buffer_load_dword v89, v12, s[28:31], s49 offen sc1
    s_mov_b32 s49, 15360
    buffer_load_dword v90, v12, s[28:31], s49 offen sc1
    s_mov_b32 s49, 23040
    buffer_load_dword v91, v12, s[28:31], s49 offen sc1
    s_mov_b32 s49, 30720
    buffer_load_dword v92, v12, s[28:31], s49 offen sc1
    s_mov_b32 s49, 38400
    buffer_load_dword v93, v12, s[28:31], s49 offen sc1
    s_mov_b32 s49, 46080
    buffer_load_dword v94, v12, s[28:31], s49 offen sc1
    s_mov_b32 s49, 53760
    buffer_load_dword v95, v12, s[28:31], s49 offen sc1
    s_mov_b32 s49, 61440
    buffer_load_dword v96, v12, s[28:31], s49 offen sc1
    s_mov_b32 s49, 69120
    buffer_load_dword v97, v12, s[28:31], s49 offen sc1
    s_lshl_b32 s58, s45, 3
    s_lshl_b32 s49, s3, 1
    s_add_u32 s49, s49, s58
    s_mul_i32 s59, s49, 20480
    s_add_u32 s49, s59, 0xe80000
    v_add_u32 v5, s49, v4
    v_add_u32 v6, 19456, v5
    s_mul_i32 s50, s3, 5120
    s_sub_u32 s49, s58, 1
    s_mul_i32 s49, s49, 20480
    s_add_u32 s49, s49, 0xe80000
    s_add_u32 s49, s49, s50
    s_cmp_eq_u32 s45, 0
    s_cselect_b32 s49, 0x7ff00000, s49
    v_add_u32 v7, s49, v4
    s_add_u32 s62, s50, 131072
    s_and_b32 s49, s46, 7
    s_add_u32 s60, s49, s58
    s_mul_i32 s49, s60, 20480
    s_add_u32 s49, s49, s50
    s_add_u32 s49, s49, 0xe80000
    v_add_u32 v8, s49, v4
    v_add_u32 v9, 4096, v8
    s_lshl_b32 s61, s3, 11
    v_lshlrev_b32 v12, 7, v3
    v_lshl_add_u32 v12, v2, 3, v12
    v_add_u32 v13, 65536, v12
    v_add_u32 v10, 131072, v12
    v_lshlrev_b32 v180, 2, v3
    v_sub_u32 v180, v2, v180
    v_mov_b32 v181, 0
    v_mov_b32 v182, 0xf149f2ca
    v_add_u32 v183, 0, v180
    v_and_b32 v183, 0xfffffff1, v183
    v_cmp_eq_u32 vcc, 0, v183
    s_nop 1
    v_cndmask_b32 v224, v182, v181, vcc
    v_add_u32 v183, 16, v180
    v_and_b32 v183, 0xfffffff1, v183
    v_cmp_eq_u32 vcc, 0, v183
    s_nop 1
    v_cndmask_b32 v228, v182, v181, vcc
    v_add_u32 v183, -1, v180
    v_and_b32 v183, 0xfffffff1, v183
    v_cmp_eq_u32 vcc, 0, v183
    s_nop 1
    v_cndmask_b32 v225, v182, v181, vcc
    v_add_u32 v183, 15, v180
    v_and_b32 v183, 0xfffffff1, v183
    v_cmp_eq_u32 vcc, 0, v183
    s_nop 1
    v_cndmask_b32 v229, v182, v181, vcc
    v_add_u32 v183, -2, v180
    v_and_b32 v183, 0xfffffff1, v183
    v_cmp_eq_u32 vcc, 0, v183
    s_nop 1
    v_cndmask_b32 v226, v182, v181, vcc
    v_add_u32 v183, 14, v180
    v_and_b32 v183, 0xfffffff1, v183
    v_cmp_eq_u32 vcc, 0, v183
    s_nop 1
    v_cndmask_b32 v230, v182, v181, vcc
    v_add_u32 v183, -3, v180
    v_and_b32 v183, 0xfffffff1, v183
    v_cmp_eq_u32 vcc, 0, v183
    s_nop 1
    v_cndmask_b32 v227, v182, v181, vcc
    v_add_u32 v183, 13, v180
    v_and_b32 v183, 0xfffffff1, v183
    v_cmp_eq_u32 vcc, 0, v183
    s_nop 1
    v_cndmask_b32 v231, v182, v181, vcc
    s_or_b32 s49, s45, s3
    s_cmp_eq_u32 s49, 0
    s_cselect_b64 s[52:53], -1, 0
    v_cndmask_b32 v232, v228, v182, s[52:53]
    v_cndmask_b32 v233, v229, v182, s[52:53]
    v_cndmask_b32 v234, v230, v182, s[52:53]
    v_cndmask_b32 v235, v231, v182, s[52:53]
    v_mul_u32_u24 v180, 272, v2
    s_lshl_b32 s49, s3, 6
    s_add_u32 s49, s49, 102400
    v_lshl_add_u32 v242, v3, 3, s49
    v_add_u32 v242, v242, v180
    s_mul_i32 s49, s3, 8704
    s_add_u32 s49, s49, 102400
    v_add_u32 v236, s49, v180
    v_lshl_add_u32 v237, v3, 3, v236
    v_cmp_eq_u32 s[56:57], 0, v3
    v_mov_b32 v238, 240
    v_mov_b32 v181, 128
    v_cndmask_b32 v238, v238, v181, s[56:57]
    v_add_u32 v238, v238, v236
    v_lshrrev_b32 v239, 2, v2
    v_lshl_add_u32 v239, v3, 2, v239
    v_mul_u32_u24 v239, 272, v239
    v_and_b32 v181, 3, v1
    v_lshl_add_u32 v239, v181, 3, v239
    v_add_u32 v239, s49, v239
    s_mul_i32 s49, s46, 1280
    s_add_u32 s49, s49, s59
    s_add_u32 s49, s49, 0x1100000
    v_lshlrev_b32 v181, 4, v2
    v_lshl_add_u32 v240, v3, 8, v181
    v_add_u32 v240, s49, v240
    s_add_u32 s49, s49, 1024
    v_add_u32 v241, s49, v181
    s_mul_i32 s63, s3, 25600
    s_mul_i32 s54, s48, 5120
    s_mul_i32 s55, s3, 204800
    s_add_u32 s54, s54, s55
    s_add_u32 s54, s54, 0xa00000
    v_lshrrev_b32 v243, 2, v2
    v_lshlrev_b32 v243, 8, v243
    v_lshl_add_u32 v243, v3, 6, v243
    v_and_b32 v181, 3, v2
    v_lshl_add_u32 v243, v181, 4, v243
    v_add_u32 v243, s54, v243
    s_cmp_lg_u32 s3, 0
    s_cbranch_scc1 POLLDONE_24
    s_mov_b32 s49, 0xb44400
    s_and_b32 s50, s2, 7
    s_mul_i32 s50, s50, 2048
    s_add_u32 s49, s49, s50
    v_add_u32 v200, 0, v1
    v_lshl_add_u32 v200, v200, 2, s49
    v_add_u32 v201, 64, v1
    v_lshl_add_u32 v201, v201, 2, s49
    v_add_u32 v202, 128, v1
    v_min_u32 v202, 159, v202
    v_lshl_add_u32 v202, v202, 2, s49
    s_mov_b32 s51, 0x8000
POLL_25:
    buffer_load_dword v203, v200, s[28:31], 0 offen sc1
    buffer_load_dword v204, v201, s[28:31], 0 offen sc1
    buffer_load_dword v205, v202, s[28:31], 0 offen sc1
    s_waitcnt vmcnt(0)
    v_cmp_ne_u32 vcc, s44, v203
    v_cmp_ne_u32 s[52:53], s44, v204
    s_nop 1
    s_or_b64 vcc, vcc, s[52:53]
    v_cmp_ne_u32 s[52:53], s44, v205
    s_nop 1
    s_or_b64 vcc, vcc, s[52:53]
    s_cbranch_vccz POLLDONE_24
    s_sleep 2
    s_sub_u32 s51, s51, 1
    s_cmp_lg_u32 s51, 0
    s_cbranch_scc1 POLL_25
POLLDONE_24:
    s_barrier
    buffer_load_dwordx4 v[144:147], v8, s[28:31], 0 offen offset:0 sc1
    buffer_load_dwordx4 v[148:151], v8, s[28:31], 0 offen offset:1024 sc1
    buffer_load_dwordx4 v[152:155], v8, s[28:31], 0 offen offset:2048 sc1
    buffer_load_dwordx4 v[156:159], v8, s[28:31], 0 offen offset:3072 sc1
    buffer_load_dwordx4 v[160:163], v9, s[28:31], 0 offen sc1
    s_add_u32 m0, s61, 0
    s_mov_b32 s64, 0
    buffer_load_dwordx4 v5, s[28:31], s64 offen sc1 lds
    buffer_load_dwordx4 v6, s[28:31], s64 offen offset:1024 sc1 lds
    s_add_u32 m0, s61, 8192
    s_mov_b32 s64, 1024
    buffer_load_dwordx4 v5, s[28:31], s64 offen sc1 lds
    buffer_load_dwordx4 v6, s[28:31], s64 offen offset:1024 sc1 lds
    s_add_u32 m0, s61, 16384
    s_mov_b32 s64, 2048
    buffer_load_dwordx4 v5, s[28:31], s64 offen sc1 lds
    buffer_load_dwordx4 v6, s[28:31], s64 offen offset:1024 sc1 lds
    s_add_u32 m0, s61, 24576
    s_mov_b32 s64, 3072
    buffer_load_dwordx4 v5, s[28:31], s64 offen sc1 lds
    buffer_load_dwordx4 v6, s[28:31], s64 offen offset:1024 sc1 lds
    s_add_u32 m0, s61, 32768
    s_mov_b32 s64, 4096
    buffer_load_dwordx4 v5, s[28:31], s64 offen sc1 lds
    buffer_load_dwordx4 v6, s[28:31], s64 offen offset:1024 sc1 lds
    s_add_u32 m0, s61, 40960
    s_mov_b32 s64, 5120
    buffer_load_dwordx4 v5, s[28:31], s64 offen sc1 lds
    buffer_load_dwordx4 v6, s[28:31], s64 offen offset:1024 sc1 lds
    s_add_u32 m0, s61, 49152
    s_mov_b32 s64, 6144
    buffer_load_dwordx4 v5, s[28:31], s64 offen sc1 lds
    buffer_load_dwordx4 v6, s[28:31], s64 offen offset:1024 sc1 lds
    s_waitcnt vmcnt(14)
    s_mov_b32 s55, 0x3f803f80
    v_mov_b32 v164, 0
    v_mov_b32 v165, 0
    v_mov_b32 v166, 0
    v_mov_b32 v167, 0
    v_dot2_f32_bf16 v164, v144, s55, v164
    v_dot2_f32_bf16 v165, v144, v144, v165
    v_dot2_f32_bf16 v166, v146, s55, v166
    v_dot2_f32_bf16 v167, v146, v146, v167
    v_dot2_f32_bf16 v164, v145, s55, v164
    v_dot2_f32_bf16 v165, v145, v145, v165
    v_dot2_f32_bf16 v166, v147, s55, v166
    v_dot2_f32_bf16 v167, v147, v147, v167
    v_dot2_f32_bf16 v164, v148, s55, v164
    v_dot2_f32_bf16 v165, v148, v148, v165
    v_dot2_f32_bf16 v166, v150, s55, v166
    v_dot2_f32_bf16 v167, v150, v150, v167
    v_dot2_f32_bf16 v164, v149, s55, v164
    v_dot2_f32_bf16 v165, v149, v149, v165
    v_dot2_f32_bf16 v166, v151, s55, v166
    v_dot2_f32_bf16 v167, v151, v151, v167
    v_dot2_f32_bf16 v164, v152, s55, v164
    v_dot2_f32_bf16 v165, v152, v152, v165
    v_dot2_f32_bf16 v166, v154, s55, v166
    v_dot2_f32_bf16 v167, v154, v154, v167
    v_dot2_f32_bf16 v164, v153, s55, v164
    v_dot2_f32_bf16 v165, v153, v153, v165
    v_dot2_f32_bf16 v166, v155, s55, v166
    v_dot2_f32_bf16 v167, v155, v155, v167
    v_dot2_f32_bf16 v164, v156, s55, v164
    v_dot2_f32_bf16 v165, v156, v156, v165
    v_dot2_f32_bf16 v166, v158, s55, v166
    v_dot2_f32_bf16 v167, v158, v158, v167
    v_dot2_f32_bf16 v164, v157, s55, v164
    v_dot2_f32_bf16 v165, v157, v157, v165
    v_dot2_f32_bf16 v166, v159, s55, v166
    v_dot2_f32_bf16 v167, v159, v159, v167
    v_dot2_f32_bf16 v164, v160, s55, v164
    v_dot2_f32_bf16 v165, v160, v160, v165
    v_dot2_f32_bf16 v166, v162, s55, v166
    v_dot2_f32_bf16 v167, v162, v162, v167
    v_dot2_f32_bf16 v164, v161, s55, v164
    v_dot2_f32_bf16 v165, v161, v161, v165
    v_dot2_f32_bf16 v166, v163, s55, v166
    v_dot2_f32_bf16 v167, v163, v163, v167
    v_add_f32_dpp v164, v164, v164 row_ror:8 row_mask:0xf bank_mask:0xf
    v_add_f32_dpp v165, v165, v165 row_ror:8 row_mask:0xf bank_mask:0xf
    v_add_f32_dpp v166, v166, v166 row_ror:8 row_mask:0xf bank_mask:0xf
    v_add_f32_dpp v167, v167, v167 row_ror:8 row_mask:0xf bank_mask:0xf
    v_mov_b32 v168, v164
    v_mov_b32 v169, v165
    v_mov_b32 v170, v166
    v_mov_b32 v171, v167
    v_permlane16_swap_b32 v164, v168
    v_permlane16_swap_b32 v165, v169
    v_permlane16_swap_b32 v166, v170
    v_permlane16_swap_b32 v167, v171
    v_add_f32 v164, v164, v168
    v_add_f32 v165, v165, v169
    v_add_f32 v166, v166, v170
    v_add_f32 v167, v167, v171
    v_mov_b32 v168, v164
    v_mov_b32 v169, v165
    v_mov_b32 v170, v166
    v_mov_b32 v171, v167
    v_permlane32_swap_b32 v164, v168
    v_permlane32_swap_b32 v165, v169
    v_permlane32_swap_b32 v166, v170
    v_permlane32_swap_b32 v167, v171
    v_add_f32 v164, v164, v168
    v_add_f32 v165, v165, v169
    v_add_f32 v166, v166, v170
    v_add_f32 v167, v167, v171
    s_lshl_b32 s55, s3, 7
    s_add_u32 s55, s55, 151552
    v_and_b32 v14, 7, v1
    v_lshl_add_u32 v15, v14, 4, s55
    s_mov_b64 exec, 0xff
    ds_write_b128 v15, v[164:167]
    s_mov_b64 exec, -1
    v_add_f32 v88, v88, v89
    v_add_f32 v88, v88, v90
    v_add_f32 v88, v88, v91
    v_add_f32 v88, v88, v92
    v_add_f32 v88, v88, v93
    v_add_f32 v88, v88, v94
    v_add_f32 v88, v88, v95
    v_add_f32 v88, v88, v96
    v_add_f32 v88, v88, v97
    v_lshlrev_b32 v15, 2, v0
    v_add_u32 v15, 152576, v15
    ds_write_b32 v15, v88
    s_waitcnt lgkmcnt(0)
    s_waitcnt vmcnt(12)
    s_barrier
    v_lshlrev_b32 v15, 4, v14
    v_add_u32 v15, 151552, v15
    ds_read_b128 v[144:147], v15 offset:0
    ds_read_b128 v[148:151], v15 offset:128
    ds_read_b128 v[152:155], v15 offset:256
    ds_read_b128 v[156:159], v15 offset:384
    s_lshl_b32 s55, s3, 7
    s_add_u32 s55, s55, 152576
    v_lshl_add_u32 v11, v3, 4, s55
    ds_read_b128 v[88:91], v11
    ds_read_b128 v[92:95], v11 offset:64
    ds_read_b128 v[96:99], v11 offset:512
    ds_read_b128 v[100:103], v11 offset:576
    ds_read_b64 a[160:161], v12 offset:0
    ds_read_b64 a[162:163], v12 offset:512
    ds_read_b64 a[164:165], v12 offset:1024
    ds_read_b64 a[166:167], v12 offset:1536
    ds_read_b64 a[168:169], v12 offset:2048
    ds_read_b64 a[170:171], v12 offset:2560
    ds_read_b64 a[172:173], v12 offset:3072
    ds_read_b64 a[174:175], v12 offset:3584
    ds_read_b64 a[176:177], v12 offset:4096
    ds_read_b64 a[178:179], v12 offset:4608
    ds_read_b64 a[180:181], v12 offset:5120
    ds_read_b64 a[182:183], v12 offset:5632
    ds_read_b64 a[184:185], v12 offset:6144
    ds_read_b64 a[186:187], v12 offset:6656
    ds_read_b64 a[188:189], v12 offset:7168
    ds_read_b64 a[190:191], v12 offset:7680
    s_waitcnt lgkmcnt(15)
    v_mov_b32 v176, 0x3727c5ac
    s_mov_b32 s55, 0x3acccccd
    s_mov_b32 s56, 0xbacccccd
    v_add_f32 v124, v88, v96
    v_add_f32 v125, v89, v97
    v_add_f32 v126, v90, v98
    v_add_f32 v127, v91, v99
    v_add_f32 v128, v92, v100
    v_add_f32 v129, v93, v101
    v_add_f32 v130, v94, v102
    v_add_f32 v131, v95, v103
    v_add_f32 v144, v144, v148
    v_add_f32 v152, v152, v156
    v_add_f32 v145, v145, v149
    v_add_f32 v153, v153, v157
    v_add_f32 v146, v146, v150
    v_add_f32 v154, v154, v158
    v_add_f32 v147, v147, v151
    v_add_f32 v155, v155, v159
    v_add_f32 v144, v144, v152
    v_add_f32 v145, v145, v153
    v_add_f32 v146, v146, v154
    v_add_f32 v147, v147, v155
    v_mul_f32 v168, s56, v144
    v_fma_f32 v169, v145, s55, v176
    v_fma_f32 v169, -v168, v168, v169
    v_max_f32 v169, v169, v176
    v_rsq_f32 v169, v169
    v_mov_b32 v170, s44
    v_mov_b32 v171, 0
    v_mul_f32 v172, s56, v146
    v_fma_f32 v173, v147, s55, v176
    v_fma_f32 v173, -v172, v172, v173
    v_max_f32 v173, v173, v176
    v_rsq_f32 v173, v173
    v_mov_b32 v174, s44
    v_mov_b32 v175, 0
    s_lshl_b32 s55, s60, 8
    s_add_u32 s55, s55, 0xb50000
    v_lshl_add_u32 v15, v14, 5, s55
    s_cmp_eq_u32 s3, 0
    s_cselect_b64 s[56:57], 0xff, 0
    v_mov_b32 v14, 0x7ff00000
    v_cndmask_b32 v15, v14, v15, s[56:57]
    buffer_store_dwordx4 v[168:171], v15, s[28:31], 0 offen sc1
    buffer_store_dwordx4 v[172:175], v15, s[28:31], 0 offen offset:16 sc1
    s_waitcnt lgkmcnt(0)
    v_mfma_f32_16x16x32_bf16 v[20:23], a[0:3], a[160:163], 0
    s_waitcnt vmcnt(10)
    s_barrier
    v_mfma_f32_16x16x32_bf16 v[56:59], a[4:7], a[160:163], 0
    ds_read_b64 a[192:193], v12 offset:8192
    s_add_u32 m0, s61, 57344
    v_mfma_f32_16x16x32_bf16 v[24:27], a[0:3], a[164:167], 0
    ds_read_b64 a[194:195], v12 offset:8704
    s_mov_b32 s64, 7168
    v_mfma_f32_16x16x32_bf16 v[60:63], a[4:7], a[164:167], 0
    buffer_load_dwordx4 v5, s[28:31], s64 offen sc1 lds
    v_mfma_f32_16x16x32_bf16 v[28:31], a[0:3], a[168:171], 0
    ds_read_b64 a[196:197], v12 offset:9216
    ds_read_b64 a[198:199], v12 offset:9728
    v_mfma_f32_16x16x32_bf16 v[64:67], a[4:7], a[168:171], 0
    buffer_load_dwordx4 v6, s[28:31], s64 offen offset:1024 sc1 lds
    v_mfma_f32_16x16x32_bf16 v[32:35], a[0:3], a[172:175], 0
    ds_read_b64 a[200:201], v12 offset:10240
    ds_read_b64 a[202:203], v12 offset:10752
    v_mfma_f32_16x16x32_bf16 v[68:71], a[4:7], a[172:175], 0
    ds_read_b64 a[204:205], v12 offset:11264
    v_mfma_f32_16x16x32_bf16 v[36:39], a[0:3], a[176:179], 0
    ds_read_b64 a[206:207], v12 offset:11776
    ds_read_b64 a[208:209], v12 offset:12288
    v_mfma_f32_16x16x32_bf16 v[72:75], a[4:7], a[176:179], 0
    ds_read_b64 a[210:211], v12 offset:12800
    ds_read_b64 a[212:213], v12 offset:13312
    v_mfma_f32_16x16x32_bf16 v[40:43], a[0:3], a[180:183], 0
    ds_read_b64 a[214:215], v12 offset:13824
    ds_read_b64 a[216:217], v12 offset:14336
    v_mfma_f32_16x16x32_bf16 v[76:79], a[4:7], a[180:183], 0
    ds_read_b64 a[218:219], v12 offset:14848
    ds_read_b64 a[220:221], v12 offset:15360
    s_add_u32 m0, s61, 65536
    v_mfma_f32_16x16x32_bf16 v[44:47], a[0:3], a[184:187], 0
    ds_read_b64 a[222:223], v12 offset:15872
    s_mov_b32 s64, 8192
    s_and_b32 s55, s2, 7
    v_mfma_f32_16x16x32_bf16 v[80:83], a[4:7], a[184:187], 0
    buffer_load_dwordx4 v5, s[28:31], s64 offen sc1 lds
    v_mfma_f32_16x16x32_bf16 v[48:51], a[0:3], a[188:191], 0
    buffer_load_dwordx4 v6, s[28:31], s64 offen offset:1024 sc1 lds
    v_mfma_f32_16x16x32_bf16 v[84:87], a[4:7], a[188:191], 0
    s_waitcnt lgkmcnt(8)
    v_mfma_f32_16x16x32_bf16 v[20:23], a[8:11], a[192:195], v[20:23]
    v_mfma_f32_16x16x32_bf16 v[56:59], a[12:15], a[192:195], v[56:59]
    ds_read_b64 a[160:161], v12 offset:16384
    s_add_u32 m0, s61, 73728
    v_mfma_f32_16x16x32_bf16 v[24:27], a[8:11], a[196:199], v[24:27]
    ds_read_b64 a[162:163], v12 offset:16896
    s_mov_b32 s64, 9216
    v_mfma_f32_16x16x32_bf16 v[60:63], a[12:15], a[196:199], v[60:63]
    buffer_load_dwordx4 v5, s[28:31], s64 offen sc1 lds
    v_mfma_f32_16x16x32_bf16 v[28:31], a[8:11], a[200:203], v[28:31]
    ds_read_b64 a[164:165], v12 offset:17408
    ds_read_b64 a[166:167], v12 offset:17920
    v_mfma_f32_16x16x32_bf16 v[64:67], a[12:15], a[200:203], v[64:67]
    buffer_load_dwordx4 v6, s[28:31], s64 offen offset:1024 sc1 lds
    v_mfma_f32_16x16x32_bf16 v[32:35], a[8:11], a[204:207], v[32:35]
    ds_read_b64 a[168:169], v12 offset:18432
    ds_read_b64 a[170:171], v12 offset:18944
    v_mfma_f32_16x16x32_bf16 v[68:71], a[12:15], a[204:207], v[68:71]
    ds_read_b64 a[172:173], v12 offset:19456
    s_waitcnt lgkmcnt(7)
    v_mfma_f32_16x16x32_bf16 v[36:39], a[8:11], a[208:211], v[36:39]
    ds_read_b64 a[174:175], v12 offset:19968
    ds_read_b64 a[176:177], v12 offset:20480
    v_mfma_f32_16x16x32_bf16 v[72:75], a[12:15], a[208:211], v[72:75]
    ds_read_b64 a[178:179], v12 offset:20992
    ds_read_b64 a[180:181], v12 offset:21504
    v_mfma_f32_16x16x32_bf16 v[40:43], a[8:11], a[212:215], v[40:43]
    ds_read_b64 a[182:183], v12 offset:22016
    ds_read_b64 a[184:185], v12 offset:22528
    v_mfma_f32_16x16x32_bf16 v[76:79], a[12:15], a[212:215], v[76:79]
    ds_read_b64 a[186:187], v12 offset:23040
    ds_read_b64 a[188:189], v12 offset:23552
    s_add_u32 m0, s61, 81920
    v_mfma_f32_16x16x32_bf16 v[44:47], a[8:11], a[216:219], v[44:47]
    ds_read_b64 a[190:191], v12 offset:24064
    s_mov_b32 s64, 10240
    s_lshl_b32 s55, s55, 8
    v_mfma_f32_16x16x32_bf16 v[80:83], a[12:15], a[216:219], v[80:83]
    buffer_load_dwordx4 v5, s[28:31], s64 offen sc1 lds
    v_mfma_f32_16x16x32_bf16 v[48:51], a[8:11], a[220:223], v[48:51]
    buffer_load_dwordx4 v6, s[28:31], s64 offen offset:1024 sc1 lds
    v_mfma_f32_16x16x32_bf16 v[84:87], a[12:15], a[220:223], v[84:87]
    s_waitcnt lgkmcnt(8)
    v_mfma_f32_16x16x32_bf16 v[20:23], a[16:19], a[160:163], v[20:23]
    s_waitcnt vmcnt(14)
    s_barrier
    v_mfma_f32_16x16x32_bf16 v[56:59], a[20:23], a[160:163], v[56:59]
    ds_read_b64 a[192:193], v12 offset:24576
    s_add_u32 m0, s61, 90112
    v_mfma_f32_16x16x32_bf16 v[24:27], a[16:19], a[164:167], v[24:27]
    ds_read_b64 a[194:195], v12 offset:25088
    s_mov_b32 s64, 11264
    v_mfma_f32_16x16x32_bf16 v[60:63], a[20:23], a[164:167], v[60:63]
    buffer_load_dwordx4 v5, s[28:31], s64 offen sc1 lds
    v_mfma_f32_16x16x32_bf16 v[28:31], a[16:19], a[168:171], v[28:31]
    ds_read_b64 a[196:197], v12 offset:25600
    ds_read_b64 a[198:199], v12 offset:26112
    v_mfma_f32_16x16x32_bf16 v[64:67], a[20:23], a[168:171], v[64:67]
    buffer_load_dwordx4 v6, s[28:31], s64 offen offset:1024 sc1 lds
    v_mfma_f32_16x16x32_bf16 v[32:35], a[16:19], a[172:175], v[32:35]
    ds_read_b64 a[200:201], v12 offset:26624
    ds_read_b64 a[202:203], v12 offset:27136
    v_mfma_f32_16x16x32_bf16 v[68:71], a[20:23], a[172:175], v[68:71]
    ds_read_b64 a[204:205], v12 offset:27648
    s_waitcnt lgkmcnt(7)
    v_mfma_f32_16x16x32_bf16 v[36:39], a[16:19], a[176:179], v[36:39]
    ds_read_b64 a[206:207], v12 offset:28160
    ds_read_b64 a[208:209], v12 offset:28672
    v_mfma_f32_16x16x32_bf16 v[72:75], a[20:23], a[176:179], v[72:75]
    ds_read_b64 a[210:211], v12 offset:29184
    ds_read_b64 a[212:213], v12 offset:29696
    v_mfma_f32_16x16x32_bf16 v[40:43], a[16:19], a[180:183], v[40:43]
    ds_read_b64 a[214:215], v12 offset:30208
    ds_read_b64 a[216:217], v12 offset:30720
    v_mfma_f32_16x16x32_bf16 v[76:79], a[20:23], a[180:183], v[76:79]
    ds_read_b64 a[218:219], v12 offset:31232
    ds_read_b64 a[220:221], v12 offset:31744
    s_add_u32 m0, s61, 98304
    v_mfma_f32_16x16x32_bf16 v[44:47], a[16:19], a[184:187], v[44:47]
    ds_read_b64 a[222:223], v12 offset:32256
    s_mov_b32 s64, 12288
    s_add_u32 s55, s55, 0xb78000
    v_mfma_f32_16x16x32_bf16 v[80:83], a[20:23], a[184:187], v[80:83]
    buffer_load_dwordx4 v5, s[28:31], s64 offen sc1 lds
    v_mfma_f32_16x16x32_bf16 v[48:51], a[16:19], a[188:191], v[48:51]
    buffer_load_dwordx4 v6, s[28:31], s64 offen offset:1024 sc1 lds
    v_mfma_f32_16x16x32_bf16 v[84:87], a[20:23], a[188:191], v[84:87]
    s_waitcnt lgkmcnt(8)
    v_mfma_f32_16x16x32_bf16 v[20:23], a[24:27], a[192:195], v[20:23]
    v_mfma_f32_16x16x32_bf16 v[56:59], a[28:31], a[192:195], v[56:59]
    ds_read_b64 a[160:161], v12 offset:32768
    s_add_u32 m0, s61, 106496
    v_mfma_f32_16x16x32_bf16 v[24:27], a[24:27], a[196:199], v[24:27]
    ds_read_b64 a[162:163], v12 offset:33280
    s_mov_b32 s64, 13312
    v_mfma_f32_16x16x32_bf16 v[60:63], a[28:31], a[196:199], v[60:63]
    buffer_load_dwordx4 v5, s[28:31], s64 offen sc1 lds
    v_mfma_f32_16x16x32_bf16 v[28:31], a[24:27], a[200:203], v[28:31]
    ds_read_b64 a[164:165], v12 offset:33792
    ds_read_b64 a[166:167], v12 offset:34304
    v_mfma_f32_16x16x32_bf16 v[64:67], a[28:31], a[200:203], v[64:67]
    buffer_load_dwordx4 v6, s[28:31], s64 offen offset:1024 sc1 lds
    v_mfma_f32_16x16x32_bf16 v[32:35], a[24:27], a[204:207], v[32:35]
    ds_read_b64 a[168:169], v12 offset:34816
    ds_read_b64 a[170:171], v12 offset:35328
    v_mfma_f32_16x16x32_bf16 v[68:71], a[28:31], a[204:207], v[68:71]
    ds_read_b64 a[172:173], v12 offset:35840
    s_waitcnt lgkmcnt(7)
    v_mfma_f32_16x16x32_bf16 v[36:39], a[24:27], a[208:211], v[36:39]
    ds_read_b64 a[174:175], v12 offset:36352
    ds_read_b64 a[176:177], v12 offset:36864
    v_mfma_f32_16x16x32_bf16 v[72:75], a[28:31], a[208:211], v[72:75]
    ds_read_b64 a[178:179], v12 offset:37376
    ds_read_b64 a[180:181], v12 offset:37888
    v_mfma_f32_16x16x32_bf16 v[40:43], a[24:27], a[212:215], v[40:43]
    ds_read_b64 a[182:183], v12 offset:38400
    ds_read_b64 a[184:185], v12 offset:38912
    v_mfma_f32_16x16x32_bf16 v[76:79], a[28:31], a[212:215], v[76:79]
    ds_read_b64 a[186:187], v12 offset:39424
    ds_read_b64 a[188:189], v12 offset:39936
    v_mfma_f32_16x16x32_bf16 v[44:47], a[24:27], a[216:219], v[44:47]
    ds_read_b64 a[190:191], v12 offset:40448
    v_and_b32 v244, 31, v1
    v_mfma_f32_16x16x32_bf16 v[80:83], a[28:31], a[216:219], v[80:83]
    v_lshl_add_u32 v244, v244, 3, s55
    buffer_load_dwordx2 v[246:247], v244, s[28:31], 0 offen sc1
    v_mfma_f32_16x16x32_bf16 v[48:51], a[24:27], a[220:223], v[48:51]
    v_mfma_f32_16x16x32_bf16 v[84:87], a[28:31], a[220:223], v[84:87]
    s_waitcnt lgkmcnt(8)
    v_mfma_f32_16x16x32_bf16 v[20:23], a[32:35], a[160:163], v[20:23]
    s_waitcnt vmcnt(17)
    s_barrier
    v_mfma_f32_16x16x32_bf16 v[56:59], a[36:39], a[160:163], v[56:59]
    ds_read_b64 a[192:193], v12 offset:40960
    s_add_u32 m0, s61, 114688
    v_mfma_f32_16x16x32_bf16 v[24:27], a[32:35], a[164:167], v[24:27]
    ds_read_b64 a[194:195], v12 offset:41472
    s_mov_b32 s64, 14336
    v_mfma_f32_16x16x32_bf16 v[60:63], a[36:39], a[164:167], v[60:63]
    buffer_load_dwordx4 v5, s[28:31], s64 offen sc1 lds
    v_mfma_f32_16x16x32_bf16 v[28:31], a[32:35], a[168:171], v[28:31]
    ds_read_b64 a[196:197], v12 offset:41984
    ds_read_b64 a[198:199], v12 offset:42496
    v_mfma_f32_16x16x32_bf16 v[64:67], a[36:39], a[168:171], v[64:67]
    buffer_load_dwordx4 v6, s[28:31], s64 offen offset:1024 sc1 lds
    v_mfma_f32_16x16x32_bf16 v[32:35], a[32:35], a[172:175], v[32:35]
    ds_read_b64 a[200:201], v12 offset:43008
    ds_read_b64 a[202:203], v12 offset:43520
    v_mfma_f32_16x16x32_bf16 v[68:71], a[36:39], a[172:175], v[68:71]
    ds_read_b64 a[204:205], v12 offset:44032
    s_add_u32 m0, s62, 0
    s_mov_b32 s66, 0
    s_waitcnt lgkmcnt(7)
    v_mfma_f32_16x16x32_bf16 v[36:39], a[32:35], a[176:179], v[36:39]
    ds_read_b64 a[206:207], v12 offset:44544
    ds_read_b64 a[208:209], v12 offset:45056
    buffer_load_dwordx4 v7, s[28:31], s66 offen sc1 lds
    v_mfma_f32_16x16x32_bf16 v[72:75], a[36:39], a[176:179], v[72:75]
    ds_read_b64 a[210:211], v12 offset:45568
    ds_read_b64 a[212:213], v12 offset:46080
    v_mfma_f32_16x16x32_bf16 v[40:43], a[32:35], a[180:183], v[40:43]
    ds_read_b64 a[214:215], v12 offset:46592
    ds_read_b64 a[216:217], v12 offset:47104
    v_mfma_f32_16x16x32_bf16 v[76:79], a[36:39], a[180:183], v[76:79]
    ds_read_b64 a[218:219], v12 offset:47616
    ds_read_b64 a[220:221], v12 offset:48128
    v_mfma_f32_16x16x32_bf16 v[44:47], a[32:35], a[184:187], v[44:47]
    ds_read_b64 a[222:223], v12 offset:48640
    s_mov_b32 s65, 1720320
    v_mfma_f32_16x16x32_bf16 v[80:83], a[36:39], a[184:187], v[80:83]
    buffer_load_dwordx4 a[112:115], v250, s[28:31], s65 offen sc1
    v_mfma_f32_16x16x32_bf16 v[48:51], a[32:35], a[188:191], v[48:51]
    buffer_load_dwordx4 a[116:119], v251, s[28:31], s65 offen sc1
    v_mfma_f32_16x16x32_bf16 v[84:87], a[36:39], a[188:191], v[84:87]
    s_waitcnt lgkmcnt(8)
    v_mfma_f32_16x16x32_bf16 v[20:23], a[40:43], a[192:195], v[20:23]
    v_mfma_f32_16x16x32_bf16 v[56:59], a[44:47], a[192:195], v[56:59]
    ds_read_b64 a[160:161], v12 offset:49152
    s_add_u32 m0, s61, 122880
    v_mfma_f32_16x16x32_bf16 v[24:27], a[40:43], a[196:199], v[24:27]
    ds_read_b64 a[162:163], v12 offset:49664
    s_mov_b32 s64, 15360
    v_mfma_f32_16x16x32_bf16 v[60:63], a[44:47], a[196:199], v[60:63]
    buffer_load_dwordx4 v5, s[28:31], s64 offen sc1 lds
    v_mfma_f32_16x16x32_bf16 v[28:31], a[40:43], a[200:203], v[28:31]
    ds_read_b64 a[164:165], v12 offset:50176
    ds_read_b64 a[166:167], v12 offset:50688
    v_mfma_f32_16x16x32_bf16 v[64:67], a[44:47], a[200:203], v[64:67]
    buffer_load_dwordx4 v6, s[28:31], s64 offen offset:1024 sc1 lds
    v_mfma_f32_16x16x32_bf16 v[32:35], a[40:43], a[204:207], v[32:35]
    ds_read_b64 a[168:169], v12 offset:51200
    ds_read_b64 a[170:171], v12 offset:51712
    v_mfma_f32_16x16x32_bf16 v[68:71], a[44:47], a[204:207], v[68:71]
    ds_read_b64 a[172:173], v12 offset:52224
    s_add_u32 m0, s62, 1024
    s_mov_b32 s66, 1024
    s_waitcnt lgkmcnt(7)
    v_mfma_f32_16x16x32_bf16 v[36:39], a[40:43], a[208:211], v[36:39]
    ds_read_b64 a[174:175], v12 offset:52736
    ds_read_b64 a[176:177], v12 offset:53248
    buffer_load_dwordx4 v7, s[28:31], s66 offen sc1 lds
    v_mfma_f32_16x16x32_bf16 v[72:75], a[44:47], a[208:211], v[72:75]
    ds_read_b64 a[178:179], v12 offset:53760
    ds_read_b64 a[180:181], v12 offset:54272
    v_mfma_f32_16x16x32_bf16 v[40:43], a[40:43], a[212:215], v[40:43]
    ds_read_b64 a[182:183], v12 offset:54784
    ds_read_b64 a[184:185], v12 offset:55296
    v_mfma_f32_16x16x32_bf16 v[76:79], a[44:47], a[212:215], v[76:79]
    ds_read_b64 a[186:187], v12 offset:55808
    ds_read_b64 a[188:189], v12 offset:56320
    v_mfma_f32_16x16x32_bf16 v[44:47], a[40:43], a[216:219], v[44:47]
    ds_read_b64 a[190:191], v12 offset:56832
    s_mov_b32 s65, 1843200
    v_mfma_f32_16x16x32_bf16 v[80:83], a[44:47], a[216:219], v[80:83]
    buffer_load_dwordx4 a[120:123], v250, s[28:31], s65 offen sc1
    v_mfma_f32_16x16x32_bf16 v[48:51], a[40:43], a[220:223], v[48:51]
    buffer_load_dwordx4 a[124:127], v251, s[28:31], s65 offen sc1
    v_mfma_f32_16x16x32_bf16 v[84:87], a[44:47], a[220:223], v[84:87]
    s_waitcnt lgkmcnt(8)
    v_mfma_f32_16x16x32_bf16 v[20:23], a[48:51], a[160:163], v[20:23]
    s_waitcnt vmcnt(21)
    s_barrier
    v_mfma_f32_16x16x32_bf16 v[56:59], a[52:55], a[160:163], v[56:59]
    ds_read_b64 a[192:193], v12 offset:57344
    s_add_u32 m0, s61, 0
    v_mfma_f32_16x16x32_bf16 v[24:27], a[48:51], a[164:167], v[24:27]
    ds_read_b64 a[194:195], v12 offset:57856
    s_mov_b32 s64, 16384
    v_mfma_f32_16x16x32_bf16 v[60:63], a[52:55], a[164:167], v[60:63]
    buffer_load_dwordx4 v5, s[28:31], s64 offen sc1 lds
    v_mfma_f32_16x16x32_bf16 v[28:31], a[48:51], a[168:171], v[28:31]
    ds_read_b64 a[196:197], v12 offset:58368
    ds_read_b64 a[198:199], v12 offset:58880
    v_mfma_f32_16x16x32_bf16 v[64:67], a[52:55], a[168:171], v[64:67]
    buffer_load_dwordx4 v6, s[28:31], s64 offen offset:1024 sc1 lds
    v_mfma_f32_16x16x32_bf16 v[32:35], a[48:51], a[172:175], v[32:35]
    ds_read_b64 a[200:201], v12 offset:59392
    ds_read_b64 a[202:203], v12 offset:59904
    v_mfma_f32_16x16x32_bf16 v[68:71], a[52:55], a[172:175], v[68:71]
    ds_read_b64 a[204:205], v12 offset:60416
    s_add_u32 m0, s62, 2048
    s_mov_b32 s66, 2048
    s_waitcnt lgkmcnt(7)
    v_mfma_f32_16x16x32_bf16 v[36:39], a[48:51], a[176:179], v[36:39]
    ds_read_b64 a[206:207], v12 offset:60928
    ds_read_b64 a[208:209], v12 offset:61440
    buffer_load_dwordx4 v7, s[28:31], s66 offen sc1 lds
    v_mfma_f32_16x16x32_bf16 v[72:75], a[52:55], a[176:179], v[72:75]
    ds_read_b64 a[210:211], v12 offset:61952
    ds_read_b64 a[212:213], v12 offset:62464
    v_mfma_f32_16x16x32_bf16 v[40:43], a[48:51], a[180:183], v[40:43]
    ds_read_b64 a[214:215], v12 offset:62976
    ds_read_b64 a[216:217], v12 offset:63488
    v_mfma_f32_16x16x32_bf16 v[76:79], a[52:55], a[180:183], v[76:79]
    ds_read_b64 a[218:219], v12 offset:64000
    ds_read_b64 a[220:221], v12 offset:64512
    v_mfma_f32_16x16x32_bf16 v[44:47], a[48:51], a[184:187], v[44:47]
    ds_read_b64 a[222:223], v12 offset:65024
    s_mov_b32 s65, 1966080
    s_waitcnt vmcnt(13)
    v_mfma_f32_16x16x32_bf16 v[80:83], a[52:55], a[184:187], v[80:83]
    buffer_load_dwordx4 a[128:131], v250, s[28:31], s65 offen sc1
    v_mfma_f32_16x16x32_bf16 v[48:51], a[48:51], a[188:191], v[48:51]
    buffer_load_dwordx4 a[132:135], v251, s[28:31], s65 offen sc1
    v_mfma_f32_16x16x32_bf16 v[84:87], a[52:55], a[188:191], v[84:87]
    s_waitcnt lgkmcnt(8)
    v_mfma_f32_16x16x32_bf16 v[20:23], a[56:59], a[192:195], v[20:23]
    v_mfma_f32_16x16x32_bf16 v[56:59], a[60:63], a[192:195], v[56:59]
    ds_read_b64 a[160:161], v13 offset:0
    s_add_u32 m0, s61, 8192
    v_mfma_f32_16x16x32_bf16 v[24:27], a[56:59], a[196:199], v[24:27]
    ds_read_b64 a[162:163], v13 offset:512
    s_mov_b32 s64, 17408
    v_mfma_f32_16x16x32_bf16 v[60:63], a[60:63], a[196:199], v[60:63]
    buffer_load_dwordx4 v5, s[28:31], s64 offen sc1 lds
    v_mfma_f32_16x16x32_bf16 v[28:31], a[56:59], a[200:203], v[28:31]
    ds_read_b64 a[164:165], v13 offset:1024
    ds_read_b64 a[166:167], v13 offset:1536
    v_mfma_f32_16x16x32_bf16 v[64:67], a[60:63], a[200:203], v[64:67]
    buffer_load_dwordx4 v6, s[28:31], s64 offen offset:1024 sc1 lds
    v_mfma_f32_16x16x32_bf16 v[32:35], a[56:59], a[204:207], v[32:35]
    ds_read_b64 a[168:169], v13 offset:2048
    ds_read_b64 a[170:171], v13 offset:2560
    v_mfma_f32_16x16x32_bf16 v[68:71], a[60:63], a[204:207], v[68:71]
    ds_read_b64 a[172:173], v13 offset:3072
    s_add_u32 m0, s62, 3072
    s_mov_b32 s66, 3072
    s_waitcnt lgkmcnt(7)
    v_mfma_f32_16x16x32_bf16 v[36:39], a[56:59], a[208:211], v[36:39]
    ds_read_b64 a[174:175], v13 offset:3584
    ds_read_b64 a[176:177], v13 offset:4096
    buffer_load_dwordx4 v7, s[28:31], s66 offen sc1 lds
    v_mfma_f32_16x16x32_bf16 v[72:75], a[60:63], a[208:211], v[72:75]
    ds_read_b64 a[178:179], v13 offset:4608
    ds_read_b64 a[180:181], v13 offset:5120
    v_mfma_f32_16x16x32_bf16 v[40:43], a[56:59], a[212:215], v[40:43]
    ds_read_b64 a[182:183], v13 offset:5632
    ds_read_b64 a[184:185], v13 offset:6144
    v_mfma_f32_16x16x32_bf16 v[76:79], a[60:63], a[212:215], v[76:79]
    ds_read_b64 a[186:187], v13 offset:6656
    ds_read_b64 a[188:189], v13 offset:7168
    v_mfma_f32_16x16x32_bf16 v[44:47], a[56:59], a[216:219], v[44:47]
    ds_read_b64 a[190:191], v13 offset:7680
    s_mov_b32 s65, 2088960
    s_getreg_b32 s55, hwreg(HW_REG_XCC_ID, 0, 4)
    v_mfma_f32_16x16x32_bf16 v[80:83], a[60:63], a[216:219], v[80:83]
    buffer_load_dwordx4 a[136:139], v250, s[28:31], s65 offen sc1
    v_mfma_f32_16x16x32_bf16 v[48:51], a[56:59], a[220:223], v[48:51]
    buffer_load_dwordx4 a[140:143], v251, s[28:31], s65 offen sc1
    v_mfma_f32_16x16x32_bf16 v[84:87], a[60:63], a[220:223], v[84:87]
    s_waitcnt lgkmcnt(8)
    v_mfma_f32_16x16x32_bf16 v[20:23], a[64:67], a[160:163], v[20:23]
    s_barrier
    v_mfma_f32_16x16x32_bf16 v[56:59], a[68:71], a[160:163], v[56:59]
    ds_read_b64 a[192:193], v13 offset:8192
    s_add_u32 m0, s61, 16384
    v_mfma_f32_16x16x32_bf16 v[24:27], a[64:67], a[164:167], v[24:27]
    ds_read_b64 a[194:195], v13 offset:8704
    s_mov_b32 s64, 18432
    v_mfma_f32_16x16x32_bf16 v[60:63], a[68:71], a[164:167], v[60:63]
    buffer_load_dwordx4 v5, s[28:31], s64 offen sc1 lds
    v_mfma_f32_16x16x32_bf16 v[28:31], a[64:67], a[168:171], v[28:31]
    ds_read_b64 a[196:197], v13 offset:9216
    ds_read_b64 a[198:199], v13 offset:9728
    v_mfma_f32_16x16x32_bf16 v[64:67], a[68:71], a[168:171], v[64:67]
    buffer_load_dwordx4 v6, s[28:31], s64 offen offset:1024 sc1 lds
    v_mfma_f32_16x16x32_bf16 v[32:35], a[64:67], a[172:175], v[32:35]
    ds_read_b64 a[200:201], v13 offset:10240
    ds_read_b64 a[202:203], v13 offset:10752
    v_mfma_f32_16x16x32_bf16 v[68:71], a[68:71], a[172:175], v[68:71]
    ds_read_b64 a[204:205], v13 offset:11264
    s_add_u32 m0, s62, 4096
    s_mov_b32 s66, 4096
    s_waitcnt lgkmcnt(7)
    v_mfma_f32_16x16x32_bf16 v[36:39], a[64:67], a[176:179], v[36:39]
    ds_read_b64 a[206:207], v13 offset:11776
    ds_read_b64 a[208:209], v13 offset:12288
    buffer_load_dwordx4 v7, s[28:31], s66 offen sc1 lds
    v_mfma_f32_16x16x32_bf16 v[72:75], a[68:71], a[176:179], v[72:75]
    ds_read_b64 a[210:211], v13 offset:12800
    ds_read_b64 a[212:213], v13 offset:13312
    v_mfma_f32_16x16x32_bf16 v[40:43], a[64:67], a[180:183], v[40:43]
    ds_read_b64 a[214:215], v13 offset:13824
    ds_read_b64 a[216:217], v13 offset:14336
    v_mfma_f32_16x16x32_bf16 v[76:79], a[68:71], a[180:183], v[76:79]
    ds_read_b64 a[218:219], v13 offset:14848
    ds_read_b64 a[220:221], v13 offset:15360
    v_mfma_f32_16x16x32_bf16 v[44:47], a[64:67], a[184:187], v[44:47]
    ds_read_b64 a[222:223], v13 offset:15872
    s_mov_b32 s65, 2211840
    v_cmp_ne_u32 vcc, s44, v246
    v_cmp_ne_u32 s[56:57], s55, v247
    s_nop 1
    s_or_b64 vcc, vcc, s[56:57]
    s_cmp_eq_u64 vcc, 0
    s_cselect_b32 s67, 1, 0
    v_mfma_f32_16x16x32_bf16 v[80:83], a[68:71], a[184:187], v[80:83]
    buffer_load_dwordx4 a[144:147], v250, s[28:31], s65 offen sc1
    v_mfma_f32_16x16x32_bf16 v[48:51], a[64:67], a[188:191], v[48:51]
    buffer_load_dwordx4 a[148:151], v251, s[28:31], s65 offen sc1
    v_mfma_f32_16x16x32_bf16 v[84:87], a[68:71], a[188:191], v[84:87]
    s_waitcnt lgkmcnt(8)
    v_mfma_f32_16x16x32_bf16 v[20:23], a[72:75], a[192:195], v[20:23]
    v_mfma_f32_16x16x32_bf16 v[56:59], a[76:79], a[192:195], v[56:59]
    ds_read_b64 a[160:161], v13 offset:16384
    s_add_u32 m0, s61, 24576
    v_mfma_f32_16x16x32_bf16 v[24:27], a[72:75], a[196:199], v[24:27]
    ds_read_b64 a[162:163], v13 offset:16896
    s_mov_b32 s64, 19456
    v_mfma_f32_16x16x32_bf16 v[60:63], a[76:79], a[196:199], v[60:63]
    buffer_load_dwordx4 v5, s[28:31], s64 offen sc1 lds
    v_mfma_f32_16x16x32_bf16 v[28:31], a[72:75], a[200:203], v[28:31]
    ds_read_b64 a[164:165], v13 offset:17408
    ds_read_b64 a[166:167], v13 offset:17920
    v_mfma_f32_16x16x32_bf16 v[64:67], a[76:79], a[200:203], v[64:67]
    buffer_load_dwordx4 v6, s[28:31], s64 offen offset:1024 sc1 lds
    v_mfma_f32_16x16x32_bf16 v[32:35], a[72:75], a[204:207], v[32:35]
    ds_read_b64 a[168:169], v13 offset:18432
    ds_read_b64 a[170:171], v13 offset:18944
    v_mfma_f32_16x16x32_bf16 v[68:71], a[76:79], a[204:207], v[68:71]
    ds_read_b64 a[172:173], v13 offset:19456
    s_waitcnt lgkmcnt(7)
    v_mfma_f32_16x16x32_bf16 v[36:39], a[72:75], a[208:211], v[36:39]
    ds_read_b64 a[174:175], v13 offset:19968
    ds_read_b64 a[176:177], v13 offset:20480
    v_mfma_f32_16x16x32_bf16 v[72:75], a[76:79], a[208:211], v[72:75]
    ds_read_b64 a[178:179], v13 offset:20992
    ds_read_b64 a[180:181], v13 offset:21504
    v_mfma_f32_16x16x32_bf16 v[40:43], a[72:75], a[212:215], v[40:43]
    ds_read_b64 a[182:183], v13 offset:22016
    ds_read_b64 a[184:185], v13 offset:22528
    v_mfma_f32_16x16x32_bf16 v[76:79], a[76:79], a[212:215], v[76:79]
    ds_read_b64 a[186:187], v13 offset:23040
    ds_read_b64 a[188:189], v13 offset:23552
    v_mfma_f32_16x16x32_bf16 v[44:47], a[72:75], a[216:219], v[44:47]
    ds_read_b64 a[190:191], v13 offset:24064
    s_mov_b32 s65, 2334720
    s_sub_u32 s55, s58, 1
    s_add_u32 s55, s55, s3
    v_mfma_f32_16x16x32_bf16 v[80:83], a[76:79], a[216:219], v[80:83]
    buffer_load_dwordx4 a[152:155], v250, s[28:31], s65 offen sc1
    v_mfma_f32_16x16x32_bf16 v[48:51], a[72:75], a[220:223], v[48:51]
    buffer_load_dwordx4 a[156:159], v251, s[28:31], s65 offen sc1
    v_mfma_f32_16x16x32_bf16 v[84:87], a[76:79], a[220:223], v[84:87]
    s_waitcnt lgkmcnt(8)
    v_mfma_f32_16x16x32_bf16 v[20:23], a[80:83], a[160:163], v[20:23]
    s_waitcnt vmcnt(6)
    s_barrier
    v_mfma_f32_16x16x32_bf16 v[56:59], a[84:87], a[160:163], v[56:59]
    ds_read_b64 a[192:193], v13 offset:24576
    v_mfma_f32_16x16x32_bf16 v[24:27], a[80:83], a[164:167], v[24:27]
    ds_read_b64 a[194:195], v13 offset:25088
    v_mfma_f32_16x16x32_bf16 v[60:63], a[84:87], a[164:167], v[60:63]
    v_mfma_f32_16x16x32_bf16 v[28:31], a[80:83], a[168:171], v[28:31]
    ds_read_b64 a[196:197], v13 offset:25600
    ds_read_b64 a[198:199], v13 offset:26112
    v_mfma_f32_16x16x32_bf16 v[64:67], a[84:87], a[168:171], v[64:67]
    v_mfma_f32_16x16x32_bf16 v[32:35], a[80:83], a[172:175], v[32:35]
    ds_read_b64 a[200:201], v13 offset:26624
    ds_read_b64 a[202:203], v13 offset:27136
    v_mfma_f32_16x16x32_bf16 v[68:71], a[84:87], a[172:175], v[68:71]
    ds_read_b64 a[204:205], v13 offset:27648
    s_waitcnt lgkmcnt(7)
    v_mfma_f32_16x16x32_bf16 v[36:39], a[80:83], a[176:179], v[36:39]
    ds_read_b64 a[206:207], v13 offset:28160
    ds_read_b64 a[208:209], v13 offset:28672
    v_mfma_f32_16x16x32_bf16 v[72:75], a[84:87], a[176:179], v[72:75]
    ds_read_b64 a[210:211], v13 offset:29184
    ds_read_b64 a[212:213], v13 offset:29696
    v_mfma_f32_16x16x32_bf16 v[40:43], a[80:83], a[180:183], v[40:43]
    ds_read_b64 a[214:215], v13 offset:30208
    ds_read_b64 a[216:217], v13 offset:30720
    v_mfma_f32_16x16x32_bf16 v[76:79], a[84:87], a[180:183], v[76:79]
    ds_read_b64 a[218:219], v13 offset:31232
    ds_read_b64 a[220:221], v13 offset:31744
    v_mfma_f32_16x16x32_bf16 v[44:47], a[80:83], a[184:187], v[44:47]
    ds_read_b64 a[222:223], v13 offset:32256
    s_lshl_b32 s55, s55, 8
    s_add_u32 s55, s55, 0xb50000
    v_mfma_f32_16x16x32_bf16 v[80:83], a[84:87], a[184:187], v[80:83]
    v_lshl_add_u32 v11, v2, 4, s55
    s_or_b32 s55, s45, s3
    s_cmp_eq_u32 s55, 0
    s_cselect_b32 s55, 256, 0
    v_mfma_f32_16x16x32_bf16 v[48:51], a[80:83], a[188:191], v[48:51]
    v_add_u32 v15, s55, v11
    v_mfma_f32_16x16x32_bf16 v[84:87], a[84:87], a[188:191], v[84:87]
    s_waitcnt lgkmcnt(8)
    v_mfma_f32_16x16x32_bf16 v[20:23], a[88:91], a[192:195], v[20:23]
    v_mfma_f32_16x16x32_bf16 v[56:59], a[92:95], a[192:195], v[56:59]
    ds_read_b64 a[160:161], v13 offset:32768
    v_mfma_f32_16x16x32_bf16 v[24:27], a[88:91], a[196:199], v[24:27]
    ds_read_b64 a[162:163], v13 offset:33280
    v_mfma_f32_16x16x32_bf16 v[60:63], a[92:95], a[196:199], v[60:63]
    v_mfma_f32_16x16x32_bf16 v[28:31], a[88:91], a[200:203], v[28:31]
    ds_read_b64 a[164:165], v13 offset:33792
    ds_read_b64 a[166:167], v13 offset:34304
    v_mfma_f32_16x16x32_bf16 v[64:67], a[92:95], a[200:203], v[64:67]
    v_mfma_f32_16x16x32_bf16 v[32:35], a[88:91], a[204:207], v[32:35]
    ds_read_b64 a[168:169], v13 offset:34816
    ds_read_b64 a[170:171], v13 offset:35328
    v_mfma_f32_16x16x32_bf16 v[68:71], a[92:95], a[204:207], v[68:71]
    ds_read_b64 a[172:173], v13 offset:35840
    s_waitcnt lgkmcnt(7)
    v_mfma_f32_16x16x32_bf16 v[36:39], a[88:91], a[208:211], v[36:39]
    ds_read_b64 a[174:175], v13 offset:36352
    ds_read_b64 a[176:177], v13 offset:36864
    v_mfma_f32_16x16x32_bf16 v[72:75], a[92:95], a[208:211], v[72:75]
    ds_read_b64 a[178:179], v13 offset:37376
    ds_read_b64 a[180:181], v13 offset:37888
    v_mfma_f32_16x16x32_bf16 v[40:43], a[88:91], a[212:215], v[40:43]
    ds_read_b64 a[182:183], v13 offset:38400
    ds_read_b64 a[184:185], v13 offset:38912
    v_mfma_f32_16x16x32_bf16 v[76:79], a[92:95], a[212:215], v[76:79]
    ds_read_b64 a[186:187], v13 offset:39424
    ds_read_b64 a[188:189], v13 offset:39936
    v_mfma_f32_16x16x32_bf16 v[44:47], a[88:91], a[216:219], v[44:47]
    ds_read_b64 a[190:191], v13 offset:40448
    s_movk_i32 s55, 1024
    s_cmp_eq_u32 s3, 0
    s_cselect_b32 s55, 2048, s55
    v_mfma_f32_16x16x32_bf16 v[80:83], a[92:95], a[216:219], v[80:83]
    v_add_u32 v14, s55, v11
    buffer_load_dwordx3 v[88:90], v15, s[28:31], 0 offen sc1
    buffer_load_dwordx3 v[92:94], v11, s[28:31], 0 offen offset:1024 sc1
    buffer_load_dwordx3 v[96:98], v14, s[28:31], 0 offen sc1
    v_mfma_f32_16x16x32_bf16 v[48:51], a[88:91], a[220:223], v[48:51]
    ds_read_b64 v[144:145], v10 offset:0
    v_mfma_f32_16x16x32_bf16 v[84:87], a[92:95], a[220:223], v[84:87]
    s_waitcnt lgkmcnt(9)
    v_mfma_f32_16x16x32_bf16 v[20:23], a[96:99], a[160:163], v[20:23]
    s_barrier
    v_mfma_f32_16x16x32_bf16 v[56:59], a[100:103], a[160:163], v[56:59]
    ds_read_b64 a[192:193], v13 offset:40960
    v_mfma_f32_16x16x32_bf16 v[24:27], a[96:99], a[164:167], v[24:27]
    ds_read_b64 a[194:195], v13 offset:41472
    v_mfma_f32_16x16x32_bf16 v[60:63], a[100:103], a[164:167], v[60:63]
    v_mfma_f32_16x16x32_bf16 v[28:31], a[96:99], a[168:171], v[28:31]
    ds_read_b64 a[196:197], v13 offset:41984
    ds_read_b64 a[198:199], v13 offset:42496
    v_mfma_f32_16x16x32_bf16 v[64:67], a[100:103], a[168:171], v[64:67]
    v_mfma_f32_16x16x32_bf16 v[32:35], a[96:99], a[172:175], v[32:35]
    ds_read_b64 a[200:201], v13 offset:43008
    ds_read_b64 a[202:203], v13 offset:43520
    v_mfma_f32_16x16x32_bf16 v[68:71], a[100:103], a[172:175], v[68:71]
    ds_read_b64 a[204:205], v13 offset:44032
    s_waitcnt lgkmcnt(8)
    v_mfma_f32_16x16x32_bf16 v[36:39], a[96:99], a[176:179], v[36:39]
    ds_read_b64 a[206:207], v13 offset:44544
    ds_read_b64 a[208:209], v13 offset:45056
    v_mfma_f32_16x16x32_bf16 v[72:75], a[100:103], a[176:179], v[72:75]
    ds_read_b64 a[210:211], v13 offset:45568
    ds_read_b64 a[212:213], v13 offset:46080
    v_mfma_f32_16x16x32_bf16 v[40:43], a[96:99], a[180:183], v[40:43]
    ds_read_b64 a[214:215], v13 offset:46592
    ds_read_b64 a[216:217], v13 offset:47104
    v_mfma_f32_16x16x32_bf16 v[76:79], a[100:103], a[180:183], v[76:79]
    ds_read_b64 a[218:219], v13 offset:47616
    ds_read_b64 a[220:221], v13 offset:48128
    v_mfma_f32_16x16x32_bf16 v[44:47], a[96:99], a[184:187], v[44:47]
    ds_read_b64 a[222:223], v13 offset:48640
    ds_read_b64 v[146:147], v10 offset:512
    v_mfma_f32_16x16x32_bf16 v[80:83], a[100:103], a[184:187], v[80:83]
    ds_read_b64 v[148:149], v10 offset:1024
    ds_read_b64 v[150:151], v10 offset:1536
    v_mfma_f32_16x16x32_bf16 v[48:51], a[96:99], a[188:191], v[48:51]
    ds_read_b64 v[152:153], v10 offset:2048
    v_mfma_f32_16x16x32_bf16 v[84:87], a[100:103], a[188:191], v[84:87]
    s_waitcnt lgkmcnt(12)
    v_mfma_f32_16x16x32_bf16 v[20:23], a[104:107], a[192:195], v[20:23]
    v_mfma_f32_16x16x32_bf16 v[56:59], a[108:111], a[192:195], v[56:59]
    ds_read_b64 a[160:161], v13 offset:49152
    v_mfma_f32_16x16x32_bf16 v[24:27], a[104:107], a[196:199], v[24:27]
    ds_read_b64 a[162:163], v13 offset:49664
    v_mfma_f32_16x16x32_bf16 v[60:63], a[108:111], a[196:199], v[60:63]
    v_mfma_f32_16x16x32_bf16 v[28:31], a[104:107], a[200:203], v[28:31]
    ds_read_b64 a[164:165], v13 offset:50176
    ds_read_b64 a[166:167], v13 offset:50688
    v_mfma_f32_16x16x32_bf16 v[64:67], a[108:111], a[200:203], v[64:67]
    v_mfma_f32_16x16x32_bf16 v[32:35], a[104:107], a[204:207], v[32:35]
    ds_read_b64 a[168:169], v13 offset:51200
    ds_read_b64 a[170:171], v13 offset:51712
    v_mfma_f32_16x16x32_bf16 v[68:71], a[108:111], a[204:207], v[68:71]
    ds_read_b64 a[172:173], v13 offset:52224
    s_waitcnt lgkmcnt(11)
    v_mfma_f32_16x16x32_bf16 v[36:39], a[104:107], a[208:211], v[36:39]
    ds_read_b64 a[174:175], v13 offset:52736
    ds_read_b64 a[176:177], v13 offset:53248
    v_mfma_f32_16x16x32_bf16 v[72:75], a[108:111], a[208:211], v[72:75]
    ds_read_b64 a[178:179], v13 offset:53760
    ds_read_b64 a[180:181], v13 offset:54272
    v_mfma_f32_16x16x32_bf16 v[40:43], a[104:107], a[212:215], v[40:43]
    ds_read_b64 a[182:183], v13 offset:54784
    ds_read_b64 a[184:185], v13 offset:55296
    v_mfma_f32_16x16x32_bf16 v[76:79], a[108:111], a[212:215], v[76:79]
    ds_read_b64 a[186:187], v13 offset:55808
    ds_read_b64 a[188:189], v13 offset:56320
    v_mfma_f32_16x16x32_bf16 v[44:47], a[104:107], a[216:219], v[44:47]
    ds_read_b64 a[190:191], v13 offset:56832
    ds_read_b64 v[154:155], v10 offset:2560
    v_mfma_f32_16x16x32_bf16 v[80:83], a[108:111], a[216:219], v[80:83]
    ds_read_b64 v[156:157], v10 offset:3072
    ds_read_b64 v[158:159], v10 offset:3584
    v_mfma_f32_16x16x32_bf16 v[48:51], a[104:107], a[220:223], v[48:51]
    ds_read_b64 v[160:161], v10 offset:4096
    v_mfma_f32_16x16x32_bf16 v[84:87], a[108:111], a[220:223], v[84:87]
    s_waitcnt lgkmcnt(12)
    v_mfma_f32_16x16x32_bf16 v[20:23], a[112:115], a[160:163], v[20:23]
    s_barrier
    v_mfma_f32_16x16x32_bf16 v[56:59], a[116:119], a[160:163], v[56:59]
    ds_read_b64 a[192:193], v13 offset:57344
    v_mfma_f32_16x16x32_bf16 v[24:27], a[112:115], a[164:167], v[24:27]
    ds_read_b64 a[194:195], v13 offset:57856
    v_mfma_f32_16x16x32_bf16 v[60:63], a[116:119], a[164:167], v[60:63]
    v_mfma_f32_16x16x32_bf16 v[28:31], a[112:115], a[168:171], v[28:31]
    ds_read_b64 a[196:197], v13 offset:58368
    ds_read_b64 a[198:199], v13 offset:58880
    v_mfma_f32_16x16x32_bf16 v[64:67], a[116:119], a[168:171], v[64:67]
    v_mfma_f32_16x16x32_bf16 v[32:35], a[112:115], a[172:175], v[32:35]
    ds_read_b64 a[200:201], v13 offset:59392
    ds_read_b64 a[202:203], v13 offset:59904
    v_mfma_f32_16x16x32_bf16 v[68:71], a[116:119], a[172:175], v[68:71]
    ds_read_b64 a[204:205], v13 offset:60416
    s_waitcnt lgkmcnt(11)
    v_mfma_f32_16x16x32_bf16 v[36:39], a[112:115], a[176:179], v[36:39]
    ds_read_b64 a[206:207], v13 offset:60928
    ds_read_b64 a[208:209], v13 offset:61440
    v_mfma_f32_16x16x32_bf16 v[72:75], a[116:119], a[176:179], v[72:75]
    ds_read_b64 a[210:211], v13 offset:61952
    ds_read_b64 a[212:213], v13 offset:62464
    v_mfma_f32_16x16x32_bf16 v[40:43], a[112:115], a[180:183], v[40:43]
    ds_read_b64 a[214:215], v13 offset:62976
    ds_read_b64 a[216:217], v13 offset:63488
    v_mfma_f32_16x16x32_bf16 v[76:79], a[116:119], a[180:183], v[76:79]
    ds_read_b64 a[218:219], v13 offset:64000
    ds_read_b64 a[220:221], v13 offset:64512
    v_mfma_f32_16x16x32_bf16 v[44:47], a[112:115], a[184:187], v[44:47]
    ds_read_b64 a[222:223], v13 offset:65024
    ds_read_b64 v[162:163], v10 offset:4608
    v_mfma_f32_16x16x32_bf16 v[80:83], a[116:119], a[184:187], v[80:83]
    ds_read_b64 v[164:165], v10 offset:5120
    ds_read_b64 v[166:167], v10 offset:5632
    v_mfma_f32_16x16x32_bf16 v[48:51], a[112:115], a[188:191], v[48:51]
    ds_read_b64 v[168:169], v10 offset:6144
    v_mfma_f32_16x16x32_bf16 v[84:87], a[116:119], a[188:191], v[84:87]
    s_waitcnt lgkmcnt(12)
    v_mfma_f32_16x16x32_bf16 v[20:23], a[120:123], a[192:195], v[20:23]
    v_mfma_f32_16x16x32_bf16 v[56:59], a[124:127], a[192:195], v[56:59]
    ds_read_b64 a[160:161], v12 offset:0
    v_mfma_f32_16x16x32_bf16 v[24:27], a[120:123], a[196:199], v[24:27]
    ds_read_b64 a[162:163], v12 offset:512
    v_mfma_f32_16x16x32_bf16 v[60:63], a[124:127], a[196:199], v[60:63]
    v_mfma_f32_16x16x32_bf16 v[28:31], a[120:123], a[200:203], v[28:31]
    ds_read_b64 a[164:165], v12 offset:1024
    ds_read_b64 a[166:167], v12 offset:1536
    v_mfma_f32_16x16x32_bf16 v[64:67], a[124:127], a[200:203], v[64:67]
    v_mfma_f32_16x16x32_bf16 v[32:35], a[120:123], a[204:207], v[32:35]
    ds_read_b64 a[168:169], v12 offset:2048
    ds_read_b64 a[170:171], v12 offset:2560
    v_mfma_f32_16x16x32_bf16 v[68:71], a[124:127], a[204:207], v[68:71]
    ds_read_b64 a[172:173], v12 offset:3072
    s_waitcnt lgkmcnt(11)
    v_mfma_f32_16x16x32_bf16 v[36:39], a[120:123], a[208:211], v[36:39]
    ds_read_b64 a[174:175], v12 offset:3584
    ds_read_b64 a[176:177], v12 offset:4096
    v_mfma_f32_16x16x32_bf16 v[72:75], a[124:127], a[208:211], v[72:75]
    ds_read_b64 a[178:179], v12 offset:4608
    ds_read_b64 a[180:181], v12 offset:5120
    v_mfma_f32_16x16x32_bf16 v[40:43], a[120:123], a[212:215], v[40:43]
    ds_read_b64 a[182:183], v12 offset:5632
    ds_read_b64 a[184:185], v12 offset:6144
    v_mfma_f32_16x16x32_bf16 v[76:79], a[124:127], a[212:215], v[76:79]
    ds_read_b64 a[186:187], v12 offset:6656
    ds_read_b64 a[188:189], v12 offset:7168
    v_mfma_f32_16x16x32_bf16 v[44:47], a[120:123], a[216:219], v[44:47]
    ds_read_b64 a[190:191], v12 offset:7680
    ds_read_b64 v[170:171], v10 offset:6656
    v_mfma_f32_16x16x32_bf16 v[80:83], a[124:127], a[216:219], v[80:83]
    ds_read_b64 v[172:173], v10 offset:7168
    ds_read_b64 v[174:175], v10 offset:7680
    v_mfma_f32_16x16x32_bf16 v[48:51], a[120:123], a[220:223], v[48:51]
    ds_read_b64 v[176:177], v10 offset:8192
    v_mfma_f32_16x16x32_bf16 v[84:87], a[124:127], a[220:223], v[84:87]
    s_waitcnt lgkmcnt(12)
    v_mfma_f32_16x16x32_bf16 v[20:23], a[128:131], a[160:163], v[20:23]
    s_waitcnt vmcnt(7)
    s_barrier
    v_mfma_f32_16x16x32_bf16 v[56:59], a[132:135], a[160:163], v[56:59]
    ds_read_b64 a[192:193], v12 offset:8192
    v_mfma_f32_16x16x32_bf16 v[24:27], a[128:131], a[164:167], v[24:27]
    ds_read_b64 a[194:195], v12 offset:8704
    v_mfma_f32_16x16x32_bf16 v[60:63], a[132:135], a[164:167], v[60:63]
    v_mfma_f32_16x16x32_bf16 v[28:31], a[128:131], a[168:171], v[28:31]
    ds_read_b64 a[196:197], v12 offset:9216
    ds_read_b64 a[198:199], v12 offset:9728
    v_mfma_f32_16x16x32_bf16 v[64:67], a[132:135], a[168:171], v[64:67]
    v_mfma_f32_16x16x32_bf16 v[32:35], a[128:131], a[172:175], v[32:35]
    ds_read_b64 a[200:201], v12 offset:10240
    ds_read_b64 a[202:203], v12 offset:10752
    v_mfma_f32_16x16x32_bf16 v[68:71], a[132:135], a[172:175], v[68:71]
    ds_read_b64 a[204:205], v12 offset:11264
    s_waitcnt lgkmcnt(11)
    v_mfma_f32_16x16x32_bf16 v[36:39], a[128:131], a[176:179], v[36:39]
    ds_read_b64 a[206:207], v12 offset:11776
    ds_read_b64 a[208:209], v12 offset:12288
    v_mfma_f32_16x16x32_bf16 v[72:75], a[132:135], a[176:179], v[72:75]
    ds_read_b64 a[210:211], v12 offset:12800
    ds_read_b64 a[212:213], v12 offset:13312
    v_mfma_f32_16x16x32_bf16 v[40:43], a[128:131], a[180:183], v[40:43]
    ds_read_b64 a[214:215], v12 offset:13824
    ds_read_b64 a[216:217], v12 offset:14336
    v_mfma_f32_16x16x32_bf16 v[76:79], a[132:135], a[180:183], v[76:79]
    ds_read_b64 a[218:219], v12 offset:14848
    ds_read_b64 a[220:221], v12 offset:15360
    v_mfma_f32_16x16x32_bf16 v[44:47], a[128:131], a[184:187], v[44:47]
    ds_read_b64 a[222:223], v12 offset:15872
    ds_read_b64 v[178:179], v10 offset:8704
    v_mfma_f32_16x16x32_bf16 v[80:83], a[132:135], a[184:187], v[80:83]
    ds_read_b64 v[180:181], v10 offset:9216
    ds_read_b64 v[182:183], v10 offset:9728
    v_mfma_f32_16x16x32_bf16 v[48:51], a[128:131], a[188:191], v[48:51]
    ds_read_b64 v[184:185], v10 offset:10240
    v_mfma_f32_16x16x32_bf16 v[84:87], a[132:135], a[188:191], v[84:87]
    s_waitcnt lgkmcnt(12)
    v_mfma_f32_16x16x32_bf16 v[20:23], a[136:139], a[192:195], v[20:23]
    v_mfma_f32_16x16x32_bf16 v[56:59], a[140:143], a[192:195], v[56:59]
    ds_read_b64 a[160:161], v12 offset:16384
    v_mfma_f32_16x16x32_bf16 v[24:27], a[136:139], a[196:199], v[24:27]
    ds_read_b64 a[162:163], v12 offset:16896
    v_mfma_f32_16x16x32_bf16 v[60:63], a[140:143], a[196:199], v[60:63]
    v_mfma_f32_16x16x32_bf16 v[28:31], a[136:139], a[200:203], v[28:31]
    ds_read_b64 a[164:165], v12 offset:17408
    ds_read_b64 a[166:167], v12 offset:17920
    v_mfma_f32_16x16x32_bf16 v[64:67], a[140:143], a[200:203], v[64:67]
    v_mfma_f32_16x16x32_bf16 v[32:35], a[136:139], a[204:207], v[32:35]
    ds_read_b64 a[168:169], v12 offset:18432
    ds_read_b64 a[170:171], v12 offset:18944
    v_mfma_f32_16x16x32_bf16 v[68:71], a[140:143], a[204:207], v[68:71]
    ds_read_b64 a[172:173], v12 offset:19456
    s_waitcnt lgkmcnt(11)
    v_mfma_f32_16x16x32_bf16 v[36:39], a[136:139], a[208:211], v[36:39]
    ds_read_b64 a[174:175], v12 offset:19968
    ds_read_b64 a[176:177], v12 offset:20480
    v_mfma_f32_16x16x32_bf16 v[72:75], a[140:143], a[208:211], v[72:75]
    ds_read_b64 a[178:179], v12 offset:20992
    ds_read_b64 a[180:181], v12 offset:21504
    v_mfma_f32_16x16x32_bf16 v[40:43], a[136:139], a[212:215], v[40:43]
    ds_read_b64 a[182:183], v12 offset:22016
    ds_read_b64 a[184:185], v12 offset:22528
    v_mfma_f32_16x16x32_bf16 v[76:79], a[140:143], a[212:215], v[76:79]
    ds_read_b64 a[186:187], v12 offset:23040
    ds_read_b64 a[188:189], v12 offset:23552
    v_mfma_f32_16x16x32_bf16 v[44:47], a[136:139], a[216:219], v[44:47]
    ds_read_b64 a[190:191], v12 offset:24064
    ds_read_b64 v[186:187], v10 offset:10752
    v_mfma_f32_16x16x32_bf16 v[80:83], a[140:143], a[216:219], v[80:83]
    ds_read_b64 v[188:189], v10 offset:11264
    ds_read_b64 v[190:191], v10 offset:11776
    v_mfma_f32_16x16x32_bf16 v[48:51], a[136:139], a[220:223], v[48:51]
    ds_read_b64 v[192:193], v10 offset:12288
    v_mfma_f32_16x16x32_bf16 v[84:87], a[140:143], a[220:223], v[84:87]
    s_waitcnt lgkmcnt(12)
    v_mfma_f32_16x16x32_bf16 v[20:23], a[144:147], a[160:163], v[20:23]
    s_waitcnt vmcnt(3)
    s_barrier
    v_mfma_f32_16x16x32_bf16 v[56:59], a[148:151], a[160:163], v[56:59]
    ds_read_b64 a[192:193], v12 offset:24576
    v_mfma_f32_16x16x32_bf16 v[24:27], a[144:147], a[164:167], v[24:27]
    ds_read_b64 a[194:195], v12 offset:25088
    v_mfma_f32_16x16x32_bf16 v[60:63], a[148:151], a[164:167], v[60:63]
    v_mfma_f32_16x16x32_bf16 v[28:31], a[144:147], a[168:171], v[28:31]
    ds_read_b64 a[196:197], v12 offset:25600
    ds_read_b64 a[198:199], v12 offset:26112
    v_mfma_f32_16x16x32_bf16 v[64:67], a[148:151], a[168:171], v[64:67]
    v_mfma_f32_16x16x32_bf16 v[32:35], a[144:147], a[172:175], v[32:35]
    ds_read_b64 a[200:201], v12 offset:26624
    ds_read_b64 a[202:203], v12 offset:27136
    v_mfma_f32_16x16x32_bf16 v[68:71], a[148:151], a[172:175], v[68:71]
    ds_read_b64 a[204:205], v12 offset:27648
    s_waitcnt lgkmcnt(11)
    v_mfma_f32_16x16x32_bf16 v[36:39], a[144:147], a[176:179], v[36:39]
    ds_read_b64 a[206:207], v12 offset:28160
    ds_read_b64 a[208:209], v12 offset:28672
    v_mfma_f32_16x16x32_bf16 v[72:75], a[148:151], a[176:179], v[72:75]
    ds_read_b64 a[210:211], v12 offset:29184
    ds_read_b64 a[212:213], v12 offset:29696
    v_mfma_f32_16x16x32_bf16 v[40:43], a[144:147], a[180:183], v[40:43]
    ds_read_b64 a[214:215], v12 offset:30208
    ds_read_b64 a[216:217], v12 offset:30720
    v_mfma_f32_16x16x32_bf16 v[76:79], a[148:151], a[180:183], v[76:79]
    ds_read_b64 a[218:219], v12 offset:31232
    ds_read_b64 a[220:221], v12 offset:31744
    v_mfma_f32_16x16x32_bf16 v[44:47], a[144:147], a[184:187], v[44:47]
    ds_read_b64 a[222:223], v12 offset:32256
    ds_read_b64 v[194:195], v10 offset:12800
    v_mfma_f32_16x16x32_bf16 v[80:83], a[148:151], a[184:187], v[80:83]
    ds_read_b64 v[196:197], v10 offset:13312
    ds_read_b64 v[198:199], v10 offset:13824
    v_mfma_f32_16x16x32_bf16 v[48:51], a[144:147], a[188:191], v[48:51]
    ds_read_b64 v[200:201], v10 offset:14336
    v_mfma_f32_16x16x32_bf16 v[84:87], a[148:151], a[188:191], v[84:87]
    s_waitcnt lgkmcnt(12)
    v_mfma_f32_16x16x32_bf16 v[20:23], a[152:155], a[192:195], v[20:23]
    v_mfma_f32_16x16x32_bf16 v[56:59], a[156:159], a[192:195], v[56:59]
    v_mfma_f32_16x16x32_bf16 v[24:27], a[152:155], a[196:199], v[24:27]
    v_mfma_f32_16x16x32_bf16 v[60:63], a[156:159], a[196:199], v[60:63]
    v_mfma_f32_16x16x32_bf16 v[28:31], a[152:155], a[200:203], v[28:31]
    v_mfma_f32_16x16x32_bf16 v[64:67], a[156:159], a[200:203], v[64:67]
    v_mfma_f32_16x16x32_bf16 v[32:35], a[152:155], a[204:207], v[32:35]
    v_mfma_f32_16x16x32_bf16 v[68:71], a[156:159], a[204:207], v[68:71]
    s_waitcnt lgkmcnt(4)
    v_mfma_f32_16x16x32_bf16 v[36:39], a[152:155], a[208:211], v[36:39]
    v_mfma_f32_16x16x32_bf16 v[72:75], a[156:159], a[208:211], v[72:75]
    v_mfma_f32_16x16x32_bf16 v[40:43], a[152:155], a[212:215], v[40:43]
    v_mfma_f32_16x16x32_bf16 v[76:79], a[156:159], a[212:215], v[76:79]
    v_mfma_f32_16x16x32_bf16 v[44:47], a[152:155], a[216:219], v[44:47]
    ds_read_b64 v[202:203], v10 offset:14848
    v_mfma_f32_16x16x32_bf16 v[80:83], a[156:159], a[216:219], v[80:83]
    ds_read_b64 v[204:205], v10 offset:15360
    ds_read_b64 v[206:207], v10 offset:15872
    v_mfma_f32_16x16x32_bf16 v[48:51], a[152:155], a[220:223], v[48:51]
    ds_read_b64 v[208:209], v10 offset:16384
    v_mfma_f32_16x16x32_bf16 v[84:87], a[156:159], a[220:223], v[84:87]
    ds_read_b64 v[210:211], v10 offset:16896
    ds_read_b64 v[212:213], v10 offset:17408
    ds_read_b64 v[214:215], v10 offset:17920
    ds_read_b64 v[216:217], v10 offset:18432
    ds_read_b64 v[218:219], v10 offset:18944
    ds_read_b64 v[220:221], v10 offset:19456
    ds_read_b64 v[222:223], v10 offset:19968
    s_waitcnt lgkmcnt(0)
    s_waitcnt vmcnt(0)
    s_mov_b32 s54, 0x4000
STCHK_26:
    v_cmp_ne_u32 vcc, s44, v90
    v_cmp_ne_u32 s[52:53], s44, v94
    s_nop 1
    s_or_b64 vcc, vcc, s[52:53]
    v_cmp_ne_u32 s[52:53], s44, v98
    s_nop 1
    s_or_b64 vcc, vcc, s[52:53]
    s_cbranch_vccz STOK_27
    buffer_load_dwordx3 v[88:90], v15, s[28:31], 0 offen sc1
    buffer_load_dwordx3 v[92:94], v11, s[28:31], 0 offen offset:1024 sc1
    buffer_load_dwordx3 v[96:98], v14, s[28:31], 0 offen sc1
    s_waitcnt vmcnt(0)
    s_sub_u32 s54, s54, 1
    s_cmp_lg_u32 s54, 0
    s_cbranch_scc1 STCHK_26
STOK_27:
    s_lshl_b32 s55, s3, 7
    s_add_u32 s55, s55, 153600
    v_lshl_add_u32 v11, v2, 3, s55
    s_movk_i32 s55, 512
    s_cmp_eq_u32 s3, 0
    s_cselect_b32 s55, 1024, s55
    v_add_u32 v14, s55, v11
    s_mov_b64 exec, 0xffff
    ds_write_b64 v11, v[88:89]
    ds_write_b64 v11, v[92:93] offset:512
    ds_write_b64 v14, v[96:97]
    s_mov_b64 exec, -1
    s_waitcnt lgkmcnt(0)
    s_barrier
    v_lshlrev_b32 v11, 3, v2
    v_add_u32 v11, 153600, v11
    ds_read_b64 v[92:93], v11 offset:128
    ds_read_b64 v[96:97], v11 offset:256
    ds_read_b64 v[100:101], v11 offset:384
    ds_read_b64 v[104:105], v11 offset:512
    ds_read_b64 v[108:109], v11 offset:640
    ds_read_b64 v[112:113], v11 offset:768
    ds_read_b64 v[116:117], v11 offset:896
    ds_read_b64 v[120:121], v11 offset:1024
    ds_read_b64 v[88:89], v11 offset:0
    v_mfma_f32_16x16x32_bf16 v[16:19], a[0:3], v[144:147], 0
    s_waitcnt lgkmcnt(8)
    v_fmac_f32 v20, v124, v92
    v_mfma_f32_16x16x32_bf16 v[52:55], a[4:7], v[144:147], 0
    v_fmac_f32 v21, v125, v92
    v_fmac_f32 v22, v126, v92
    v_mfma_f32_16x16x32_bf16 v[16:19], a[8:11], v[148:151], v[16:19]
    v_fmac_f32 v23, v127, v92
    v_mul_f32 v20, v20, v93
    v_mfma_f32_16x16x32_bf16 v[52:55], a[12:15], v[148:151], v[52:55]
    v_mul_f32 v21, v21, v93
    v_mul_f32 v22, v22, v93
    v_mfma_f32_16x16x32_bf16 v[16:19], a[16:19], v[152:155], v[16:19]
    v_mul_f32 v23, v23, v93
    v_cvt_pk_bf16_f32 v20, v20, v21
    v_mfma_f32_16x16x32_bf16 v[52:55], a[20:23], v[152:155], v[52:55]
    v_cvt_pk_bf16_f32 v21, v22, v23
    ds_write_b64 v242, v[20:21] offset:4352
    v_mfma_f32_16x16x32_bf16 v[16:19], a[24:27], v[156:159], v[16:19]
    v_fmac_f32 v56, v128, v92
    v_fmac_f32 v57, v129, v92
    v_mfma_f32_16x16x32_bf16 v[52:55], a[28:31], v[156:159], v[52:55]
    v_fmac_f32 v58, v130, v92
    v_fmac_f32 v59, v131, v92
    v_mfma_f32_16x16x32_bf16 v[16:19], a[32:35], v[160:163], v[16:19]
    v_mul_f32 v56, v56, v93
    v_mul_f32 v57, v57, v93
    v_mfma_f32_16x16x32_bf16 v[52:55], a[36:39], v[160:163], v[52:55]
    v_mul_f32 v58, v58, v93
    v_mul_f32 v59, v59, v93
    v_mfma_f32_16x16x32_bf16 v[16:19], a[40:43], v[164:167], v[16:19]
    v_cvt_pk_bf16_f32 v56, v56, v57
    v_cvt_pk_bf16_f32 v57, v58, v59
    v_mfma_f32_16x16x32_bf16 v[52:55], a[44:47], v[164:167], v[52:55]
    ds_write_b64 v242, v[56:57] offset:4384
    s_waitcnt lgkmcnt(9)
    v_mfma_f32_16x16x32_bf16 v[16:19], a[48:51], v[168:171], v[16:19]
    v_fmac_f32 v24, v124, v96
    v_fmac_f32 v25, v125, v96
    v_mfma_f32_16x16x32_bf16 v[52:55], a[52:55], v[168:171], v[52:55]
    v_fmac_f32 v26, v126, v96
    v_fmac_f32 v27, v127, v96
    v_mfma_f32_16x16x32_bf16 v[16:19], a[56:59], v[172:175], v[16:19]
    v_mul_f32 v24, v24, v97
    v_mul_f32 v25, v25, v97
    v_mfma_f32_16x16x32_bf16 v[52:55], a[60:63], v[172:175], v[52:55]
    v_mul_f32 v26, v26, v97
    v_mul_f32 v27, v27, v97
    v_mfma_f32_16x16x32_bf16 v[16:19], a[64:67], v[176:179], v[16:19]
    v_cvt_pk_bf16_f32 v24, v24, v25
    v_cvt_pk_bf16_f32 v25, v26, v27
    v_mfma_f32_16x16x32_bf16 v[52:55], a[68:71], v[176:179], v[52:55]
    ds_write_b64 v242, v[24:25] offset:8704
    v_fmac_f32 v60, v128, v96
    v_mfma_f32_16x16x32_bf16 v[16:19], a[72:75], v[180:183], v[16:19]
    v_fmac_f32 v61, v129, v96
    v_fmac_f32 v62, v130, v96
    v_mfma_f32_16x16x32_bf16 v[52:55], a[76:79], v[180:183], v[52:55]
    v_fmac_f32 v63, v131, v96
    v_mul_f32 v60, v60, v97
    v_mfma_f32_16x16x32_bf16 v[16:19], a[80:83], v[184:187], v[16:19]
    v_mul_f32 v61, v61, v97
    v_mul_f32 v62, v62, v97
    v_mfma_f32_16x16x32_bf16 v[52:55], a[84:87], v[184:187], v[52:55]
    v_mul_f32 v63, v63, v97
    v_cvt_pk_bf16_f32 v60, v60, v61
    v_mfma_f32_16x16x32_bf16 v[16:19], a[88:91], v[188:191], v[16:19]
    v_cvt_pk_bf16_f32 v61, v62, v63
    ds_write_b64 v242, v[60:61] offset:8736
    v_mfma_f32_16x16x32_bf16 v[52:55], a[92:95], v[188:191], v[52:55]
    s_waitcnt lgkmcnt(10)
    v_fmac_f32 v28, v124, v100
    v_mfma_f32_16x16x32_bf16 v[16:19], a[96:99], v[192:195], v[16:19]
    v_fmac_f32 v29, v125, v100
    v_fmac_f32 v30, v126, v100
    v_mfma_f32_16x16x32_bf16 v[52:55], a[100:103], v[192:195], v[52:55]
    v_fmac_f32 v31, v127, v100
    v_mul_f32 v28, v28, v101
    v_mfma_f32_16x16x32_bf16 v[16:19], a[104:107], v[196:199], v[16:19]
    v_mul_f32 v29, v29, v101
    v_mul_f32 v30, v30, v101
    v_mfma_f32_16x16x32_bf16 v[52:55], a[108:111], v[196:199], v[52:55]
    v_mul_f32 v31, v31, v101
    v_cvt_pk_bf16_f32 v28, v28, v29
    v_mfma_f32_16x16x32_bf16 v[16:19], a[112:115], v[200:203], v[16:19]
    v_cvt_pk_bf16_f32 v29, v30, v31
    ds_write_b64 v242, v[28:29] offset:13056
    v_mfma_f32_16x16x32_bf16 v[52:55], a[116:119], v[200:203], v[52:55]
    v_fmac_f32 v64, v128, v100
    v_fmac_f32 v65, v129, v100
    v_mfma_f32_16x16x32_bf16 v[16:19], a[120:123], v[204:207], v[16:19]
    v_fmac_f32 v66, v130, v100
    v_fmac_f32 v67, v131, v100
    v_mfma_f32_16x16x32_bf16 v[52:55], a[124:127], v[204:207], v[52:55]
    v_mul_f32 v64, v64, v101
    v_mul_f32 v65, v65, v101
    v_mfma_f32_16x16x32_bf16 v[16:19], a[128:131], v[208:211], v[16:19]
    v_mul_f32 v66, v66, v101
    v_mul_f32 v67, v67, v101
    v_mfma_f32_16x16x32_bf16 v[52:55], a[132:135], v[208:211], v[52:55]
    v_cvt_pk_bf16_f32 v64, v64, v65
    v_cvt_pk_bf16_f32 v65, v66, v67
    v_mfma_f32_16x16x32_bf16 v[16:19], a[136:139], v[212:215], v[16:19]
    ds_write_b64 v242, v[64:65] offset:13088
    s_waitcnt lgkmcnt(11)
    v_mfma_f32_16x16x32_bf16 v[52:55], a[140:143], v[212:215], v[52:55]
    v_fmac_f32 v32, v124, v104
    v_fmac_f32 v33, v125, v104
    v_mfma_f32_16x16x32_bf16 v[16:19], a[144:147], v[216:219], v[16:19]
    v_fmac_f32 v34, v126, v104
    v_fmac_f32 v35, v127, v104
    v_mfma_f32_16x16x32_bf16 v[52:55], a[148:151], v[216:219], v[52:55]
    v_mul_f32 v32, v32, v105
    v_mul_f32 v33, v33, v105
    v_mfma_f32_16x16x32_bf16 v[16:19], a[152:155], v[220:223], v[16:19]
    v_mul_f32 v34, v34, v105
    v_mul_f32 v35, v35, v105
    v_mfma_f32_16x16x32_bf16 v[52:55], a[156:159], v[220:223], v[52:55]
    v_cvt_pk_bf16_f32 v32, v32, v33
    v_cvt_pk_bf16_f32 v33, v34, v35
    ds_write_b64 v242, v[32:33] offset:17408
    v_fmac_f32 v68, v128, v104
    v_fmac_f32 v69, v129, v104
    v_fmac_f32 v70, v130, v104
    v_fmac_f32 v71, v131, v104
    v_mul_f32 v68, v68, v105
    v_mul_f32 v69, v69, v105
    v_mul_f32 v70, v70, v105
    v_mul_f32 v71, v71, v105
    v_cvt_pk_bf16_f32 v68, v68, v69
    v_cvt_pk_bf16_f32 v69, v70, v71
    ds_write_b64 v242, v[68:69] offset:17440
    s_waitcnt lgkmcnt(12)
    v_fmac_f32 v36, v124, v108
    v_fmac_f32 v37, v125, v108
    v_fmac_f32 v38, v126, v108
    v_fmac_f32 v39, v127, v108
    v_mul_f32 v36, v36, v109
    v_mul_f32 v37, v37, v109
    v_mul_f32 v38, v38, v109
    v_mul_f32 v39, v39, v109
    v_cvt_pk_bf16_f32 v36, v36, v37
    v_cvt_pk_bf16_f32 v37, v38, v39
    ds_write_b64 v242, v[36:37] offset:21760
    v_fmac_f32 v72, v128, v108
    v_fmac_f32 v73, v129, v108
    v_fmac_f32 v74, v130, v108
    v_fmac_f32 v75, v131, v108
    v_mul_f32 v72, v72, v109
    v_mul_f32 v73, v73, v109
    v_mul_f32 v74, v74, v109
    v_mul_f32 v75, v75, v109
    v_cvt_pk_bf16_f32 v72, v72, v73
    v_cvt_pk_bf16_f32 v73, v74, v75
    ds_write_b64 v242, v[72:73] offset:21792
    s_waitcnt lgkmcnt(13)
    v_pk_fma_f32 v[40:41], v[124:125], v[112:113], v[40:41] op_sel:[0,0,0] op_sel_hi:[1,0,1]
    v_pk_fma_f32 v[42:43], v[126:127], v[112:113], v[42:43] op_sel:[0,0,0] op_sel_hi:[1,0,1]
    v_pk_mul_f32 v[40:41], v[40:41], v[112:113] op_sel:[0,1] op_sel_hi:[1,1]
    v_pk_mul_f32 v[42:43], v[42:43], v[112:113] op_sel:[0,1] op_sel_hi:[1,1]
    v_cvt_pk_bf16_f32 v40, v40, v41
    v_cvt_pk_bf16_f32 v41, v42, v43
    ds_write_b64 v242, v[40:41] offset:26112
    s_mov_b32 s55, 0
    s_add_u32 m0, s63, 0
    s_nop 0
    buffer_load_dwordx4 v243, s[28:31], s55 offen offset:0 sc1 lds
    v_pk_fma_f32 v[76:77], v[128:129], v[112:113], v[76:77] op_sel:[0,0,0] op_sel_hi:[1,0,1]
    v_pk_fma_f32 v[78:79], v[130:131], v[112:113], v[78:79] op_sel:[0,0,0] op_sel_hi:[1,0,1]
    v_pk_mul_f32 v[76:77], v[76:77], v[112:113] op_sel:[0,1] op_sel_hi:[1,1]
    v_pk_mul_f32 v[78:79], v[78:79], v[112:113] op_sel:[0,1] op_sel_hi:[1,1]
    v_cvt_pk_bf16_f32 v76, v76, v77
    v_cvt_pk_bf16_f32 v77, v78, v79
    ds_write_b64 v242, v[76:77] offset:26144
    buffer_load_dwordx4 v243, s[28:31], s55 offen offset:1024 sc1 lds
    s_waitcnt lgkmcnt(14)
    v_pk_fma_f32 v[44:45], v[124:125], v[116:117], v[44:45] op_sel:[0,0,0] op_sel_hi:[1,0,1]
    v_pk_fma_f32 v[46:47], v[126:127], v[116:117], v[46:47] op_sel:[0,0,0] op_sel_hi:[1,0,1]
    v_pk_mul_f32 v[44:45], v[44:45], v[116:117] op_sel:[0,1] op_sel_hi:[1,1]
    v_pk_mul_f32 v[46:47], v[46:47], v[116:117] op_sel:[0,1] op_sel_hi:[1,1]
    v_cvt_pk_bf16_f32 v44, v44, v45
    v_cvt_pk_bf16_f32 v45, v46, v47
    ds_write_b64 v242, v[44:45] offset:30464
    buffer_load_dwordx4 v243, s[28:31], s55 offen offset:2048 sc1 lds
    v_pk_fma_f32 v[80:81], v[128:129], v[116:117], v[80:81] op_sel:[0,0,0] op_sel_hi:[1,0,1]
    v_pk_fma_f32 v[82:83], v[130:131], v[116:117], v[82:83] op_sel:[0,0,0] op_sel_hi:[1,0,1]
    v_pk_mul_f32 v[80:81], v[80:81], v[116:117] op_sel:[0,1] op_sel_hi:[1,1]
    v_pk_mul_f32 v[82:83], v[82:83], v[116:117] op_sel:[0,1] op_sel_hi:[1,1]
    v_cvt_pk_bf16_f32 v80, v80, v81
    v_cvt_pk_bf16_f32 v81, v82, v83
    ds_write_b64 v242, v[80:81] offset:30496
    buffer_load_dwordx4 v243, s[28:31], s55 offen offset:3072 sc1 lds
    s_waitcnt lgkmcnt(15)
    v_pk_fma_f32 v[48:49], v[124:125], v[120:121], v[48:49] op_sel:[0,0,0] op_sel_hi:[1,0,1]
    v_pk_fma_f32 v[50:51], v[126:127], v[120:121], v[50:51] op_sel:[0,0,0] op_sel_hi:[1,0,1]
    v_pk_mul_f32 v[48:49], v[48:49], v[120:121] op_sel:[0,1] op_sel_hi:[1,1]
    v_pk_mul_f32 v[50:51], v[50:51], v[120:121] op_sel:[0,1] op_sel_hi:[1,1]
    v_cvt_pk_bf16_f32 v48, v48, v49
    v_cvt_pk_bf16_f32 v49, v50, v51
    ds_write_b64 v242, v[48:49] offset:34816
    s_mov_b32 s55, 4096
    s_add_u32 m0, s63, 4096
    s_nop 0
    buffer_load_dwordx4 v243, s[28:31], s55 offen offset:0 sc1 lds
    v_pk_fma_f32 v[84:85], v[128:129], v[120:121], v[84:85] op_sel:[0,0,0] op_sel_hi:[1,0,1]
    v_pk_fma_f32 v[86:87], v[130:131], v[120:121], v[86:87] op_sel:[0,0,0] op_sel_hi:[1,0,1]
    v_pk_mul_f32 v[84:85], v[84:85], v[120:121] op_sel:[0,1] op_sel_hi:[1,1]
    v_pk_mul_f32 v[86:87], v[86:87], v[120:121] op_sel:[0,1] op_sel_hi:[1,1]
    v_cvt_pk_bf16_f32 v84, v84, v85
    v_cvt_pk_bf16_f32 v85, v86, v87
    ds_write_b64 v242, v[84:85] offset:34848
    s_mov_b32 s55, 40960
    s_add_u32 m0, s63, 5120
    s_nop 0
    buffer_load_dwordx4 v243, s[28:31], s55 offen offset:0 sc1 lds
    s_waitcnt lgkmcnt(15)
    v_pk_fma_f32 v[16:17], v[124:125], v[88:89], v[16:17] op_sel:[0,0,0] op_sel_hi:[1,0,1]
    v_pk_fma_f32 v[18:19], v[126:127], v[88:89], v[18:19] op_sel:[0,0,0] op_sel_hi:[1,0,1]
    v_pk_mul_f32 v[16:17], v[16:17], v[88:89] op_sel:[0,1] op_sel_hi:[1,1]
    v_pk_mul_f32 v[18:19], v[18:19], v[88:89] op_sel:[0,1] op_sel_hi:[1,1]
    v_cvt_pk_bf16_f32 v16, v16, v17
    v_cvt_pk_bf16_f32 v17, v18, v19
    ds_write_b64 v242, v[16:17] offset:0
    buffer_load_dwordx4 v243, s[28:31], s55 offen offset:1024 sc1 lds
    v_pk_fma_f32 v[52:53], v[128:129], v[88:89], v[52:53] op_sel:[0,0,0] op_sel_hi:[1,0,1]
    v_pk_fma_f32 v[54:55], v[130:131], v[88:89], v[54:55] op_sel:[0,0,0] op_sel_hi:[1,0,1]
    v_pk_mul_f32 v[52:53], v[52:53], v[88:89] op_sel:[0,1] op_sel_hi:[1,1]
    v_pk_mul_f32 v[54:55], v[54:55], v[88:89] op_sel:[0,1] op_sel_hi:[1,1]
    v_cvt_pk_bf16_f32 v52, v52, v53
    v_cvt_pk_bf16_f32 v53, v54, v55
    ds_write_b64 v242, v[52:53] offset:32
    buffer_load_dwordx4 v243, s[28:31], s55 offen offset:2048 sc1 lds
    s_waitcnt lgkmcnt(0)
    s_barrier
    ds_read_b64 v[164:165], v237 offset:64
    ds_read_b64 v[166:167], v236 offset:144
    ds_read_b64 v[168:169], v237 offset:96
    ds_read_b64 v[170:171], v236 offset:152
    ds_read_b64 v[172:173], v237 offset:4416
    ds_read_b64 v[174:175], v236 offset:4496
    ds_read_b64 v[176:177], v237 offset:4448
    ds_read_b64 v[178:179], v236 offset:4504
    ds_read_b64 v[180:181], v237 offset:8768
    ds_read_b64 v[182:183], v236 offset:8848
    ds_read_b64 v[184:185], v237 offset:8800
    ds_read_b64 v[186:187], v236 offset:8856
    ds_read_b64 v[188:189], v237 offset:4352
    ds_read_b64 v[190:191], v238 offset:4352
    ds_read_b64 v[192:193], v237 offset:4384
    ds_read_b64 v[194:195], v238 offset:4360
    ds_read_b64 v[196:197], v237 offset:8704
    ds_read_b64 v[198:199], v238 offset:8704
    ds_read_b64 v[200:201], v237 offset:8736
    ds_read_b64 v[202:203], v238 offset:8712
    ds_read_b64_tr_b16 v[204:205], v239 offset:160
    ds_read_b64_tr_b16 v[210:211], v239 offset:192
    ds_read_b64_tr_b16 v[216:217], v239 offset:224
    ds_read_b64_tr_b16 v[206:207], v239 offset:4512
    ds_read_b64_tr_b16 v[212:213], v239 offset:4544
    ds_read_b64_tr_b16 v[218:219], v239 offset:4576
    ds_read_b64_tr_b16 v[208:209], v239 offset:8864
    ds_read_b64_tr_b16 v[214:215], v239 offset:8896
    ds_read_b64_tr_b16 v[220:221], v239 offset:8928
    s_waitcnt lgkmcnt(9)
    v_mfma_f32_16x16x32_bf16 v[16:19], v[164:167], v[188:191], v[232:235]
    v_mfma_f32_16x16x32_bf16 v[20:23], v[172:175], v[188:191], v[224:227]
    v_mfma_f32_16x16x32_bf16 v[24:27], v[168:171], v[192:195], v[232:235]
    v_mfma_f32_16x16x32_bf16 v[28:31], v[176:179], v[192:195], v[224:227]
    v_mfma_f32_16x16x32_bf16 v[32:35], v[172:175], v[196:199], v[228:231]
    v_mfma_f32_16x16x32_bf16 v[36:39], v[180:183], v[196:199], v[224:227]
    v_mfma_f32_16x16x32_bf16 v[40:43], v[176:179], v[200:203], v[228:231]
    v_mfma_f32_16x16x32_bf16 v[44:47], v[184:187], v[200:203], v[224:227]
    s_nop 0
    v_max3_f32 v48, v16, v17, v18
    v_max3_f32 v48, v48, v19, v20
    v_max3_f32 v48, v48, v21, v22
    v_max_f32 v48, v48, v23
    buffer_load_dwordx4 v243, s[28:31], s55 offen offset:3072 sc1 lds
    v_max3_f32 v52, v24, v25, v26
    v_max3_f32 v52, v52, v27, v28
    v_max3_f32 v52, v52, v29, v30
    v_max_f32 v52, v52, v31
    s_mov_b32 s55, 45056
    s_add_u32 m0, s63, 9216
    s_nop 0
    buffer_load_dwordx4 v243, s[28:31], s55 offen offset:0 sc1 lds
    v_max3_f32 v56, v32, v33, v34
    v_max3_f32 v56, v56, v35, v36
    v_max3_f32 v56, v56, v37, v38
    v_max_f32 v56, v56, v39
    s_mov_b32 s55, 81920
    s_add_u32 m0, s63, 10240
    s_nop 0
    buffer_load_dwordx4 v243, s[28:31], s55 offen offset:0 sc1 lds
    v_max3_f32 v60, v40, v41, v42
    v_max3_f32 v60, v60, v43, v44
    v_max3_f32 v60, v60, v45, v46
    v_max_f32 v60, v60, v47
    buffer_load_dwordx4 v243, s[28:31], s55 offen offset:1024 sc1 lds
    v_mov_b32 v49, v48
    v_mov_b32 v53, v52
    v_mov_b32 v57, v56
    v_mov_b32 v61, v60
    v_permlane16_swap_b32 v48, v49
    v_permlane16_swap_b32 v52, v53
    v_permlane16_swap_b32 v56, v57
    v_permlane16_swap_b32 v60, v61
    v_max_f32 v48, v48, v49
    v_max_f32 v52, v52, v53
    v_max_f32 v56, v56, v57
    v_max_f32 v60, v60, v61
    v_mov_b32 v49, v48
    v_mov_b32 v53, v52
    v_mov_b32 v57, v56
    v_mov_b32 v61, v60
    v_permlane32_swap_b32 v48, v49
    v_permlane32_swap_b32 v52, v53
    v_permlane32_swap_b32 v56, v57
    v_permlane32_swap_b32 v60, v61
    v_max_f32 v48, v48, v49
    v_max_f32 v52, v52, v53
    v_max_f32 v56, v56, v57
    v_max_f32 v60, v60, v61
    s_mov_b32 s50, 0x3ea52b5c
    v_mov_b32 v64, s50
    v_mul_f32 v48, s50, v48
    v_mul_f32 v52, s50, v52
    v_mul_f32 v56, s50, v56
    v_mul_f32 v60, s50, v60
    v_pk_fma_f32 v[16:17], v[16:17], v[64:65], v[48:49] op_sel_hi:[1,0,0] neg_lo:[0,0,1] neg_hi:[0,0,1]
    v_pk_fma_f32 v[18:19], v[18:19], v[64:65], v[48:49] op_sel_hi:[1,0,0] neg_lo:[0,0,1] neg_hi:[0,0,1]
    v_pk_fma_f32 v[20:21], v[20:21], v[64:65], v[48:49] op_sel_hi:[1,0,0] neg_lo:[0,0,1] neg_hi:[0,0,1]
    v_pk_fma_f32 v[22:23], v[22:23], v[64:65], v[48:49] op_sel_hi:[1,0,0] neg_lo:[0,0,1] neg_hi:[0,0,1]
    v_pk_fma_f32 v[24:25], v[24:25], v[64:65], v[52:53] op_sel_hi:[1,0,0] neg_lo:[0,0,1] neg_hi:[0,0,1]
    v_pk_fma_f32 v[26:27], v[26:27], v[64:65], v[52:53] op_sel_hi:[1,0,0] neg_lo:[0,0,1] neg_hi:[0,0,1]
    v_pk_fma_f32 v[28:29], v[28:29], v[64:65], v[52:53] op_sel_hi:[1,0,0] neg_lo:[0,0,1] neg_hi:[0,0,1]
    v_pk_fma_f32 v[30:31], v[30:31], v[64:65], v[52:53] op_sel_hi:[1,0,0] neg_lo:[0,0,1] neg_hi:[0,0,1]
    v_pk_fma_f32 v[32:33], v[32:33], v[64:65], v[56:57] op_sel_hi:[1,0,0] neg_lo:[0,0,1] neg_hi:[0,0,1]
    v_pk_fma_f32 v[34:35], v[34:35], v[64:65], v[56:57] op_sel_hi:[1,0,0] neg_lo:[0,0,1] neg_hi:[0,0,1]
    v_pk_fma_f32 v[36:37], v[36:37], v[64:65], v[56:57] op_sel_hi:[1,0,0] neg_lo:[0,0,1] neg_hi:[0,0,1]
    v_pk_fma_f32 v[38:39], v[38:39], v[64:65], v[56:57] op_sel_hi:[1,0,0] neg_lo:[0,0,1] neg_hi:[0,0,1]
    v_pk_fma_f32 v[40:41], v[40:41], v[64:65], v[60:61] op_sel_hi:[1,0,0] neg_lo:[0,0,1] neg_hi:[0,0,1]
    v_pk_fma_f32 v[42:43], v[42:43], v[64:65], v[60:61] op_sel_hi:[1,0,0] neg_lo:[0,0,1] neg_hi:[0,0,1]
    v_pk_fma_f32 v[44:45], v[44:45], v[64:65], v[60:61] op_sel_hi:[1,0,0] neg_lo:[0,0,1] neg_hi:[0,0,1]
    v_pk_fma_f32 v[46:47], v[46:47], v[64:65], v[60:61] op_sel_hi:[1,0,0] neg_lo:[0,0,1] neg_hi:[0,0,1]
    v_exp_f32 v16, v16
    v_exp_f32 v17, v17
    v_exp_f32 v18, v18
    v_exp_f32 v19, v19
    v_exp_f32 v20, v20
    v_exp_f32 v21, v21
    v_exp_f32 v22, v22
    v_exp_f32 v23, v23
    buffer_load_dwordx4 v243, s[28:31], s55 offen offset:2048 sc1 lds
    v_exp_f32 v24, v24
    v_exp_f32 v25, v25
    v_exp_f32 v26, v26
    v_exp_f32 v27, v27
    v_exp_f32 v28, v28
    v_exp_f32 v29, v29
    v_exp_f32 v30, v30
    v_exp_f32 v31, v31
    buffer_load_dwordx4 v243, s[28:31], s55 offen offset:3072 sc1 lds
    v_exp_f32 v32, v32
    v_exp_f32 v33, v33
    v_exp_f32 v34, v34
    v_exp_f32 v35, v35
    v_exp_f32 v36, v36
    v_exp_f32 v37, v37
    v_exp_f32 v38, v38
    v_exp_f32 v39, v39
    s_mov_b32 s55, 86016
    s_add_u32 m0, s63, 14336
    s_nop 0
    buffer_load_dwordx4 v243, s[28:31], s55 offen offset:0 sc1 lds
    v_exp_f32 v40, v40
    v_exp_f32 v41, v41
    v_exp_f32 v42, v42
    v_exp_f32 v43, v43
    v_exp_f32 v44, v44
    v_exp_f32 v45, v45
    v_exp_f32 v46, v46
    v_exp_f32 v47, v47
    s_mov_b32 s55, 122880
    s_add_u32 m0, s63, 15360
    s_nop 0
    buffer_load_dwordx4 v243, s[28:31], s55 offen offset:0 sc1 lds
    v_cvt_pk_bf16_f32 v68, v16, v17
    v_cvt_pk_bf16_f32 v69, v18, v19
    v_cvt_pk_bf16_f32 v70, v20, v21
    v_cvt_pk_bf16_f32 v71, v22, v23
    v_pk_add_f32 v[16:17], v[16:17], v[18:19]
    v_pk_add_f32 v[20:21], v[20:21], v[22:23]
    v_pk_add_f32 v[16:17], v[16:17], v[20:21]
    v_add_f32 v50, v16, v17
    buffer_load_dwordx4 v243, s[28:31], s55 offen offset:1024 sc1 lds
    v_cvt_pk_bf16_f32 v72, v24, v25
    v_cvt_pk_bf16_f32 v73, v26, v27
    v_cvt_pk_bf16_f32 v74, v28, v29
    v_cvt_pk_bf16_f32 v75, v30, v31
    v_pk_add_f32 v[24:25], v[24:25], v[26:27]
    v_pk_add_f32 v[28:29], v[28:29], v[30:31]
    v_pk_add_f32 v[24:25], v[24:25], v[28:29]
    v_add_f32 v54, v24, v25
    buffer_load_dwordx4 v243, s[28:31], s55 offen offset:2048 sc1 lds
    v_cvt_pk_bf16_f32 v76, v32, v33
    v_cvt_pk_bf16_f32 v77, v34, v35
    v_cvt_pk_bf16_f32 v78, v36, v37
    v_cvt_pk_bf16_f32 v79, v38, v39
    v_pk_add_f32 v[32:33], v[32:33], v[34:35]
    v_pk_add_f32 v[36:37], v[36:37], v[38:39]
    v_pk_add_f32 v[32:33], v[32:33], v[36:37]
    v_add_f32 v58, v32, v33
    buffer_load_dwordx4 v243, s[28:31], s55 offen offset:3072 sc1 lds
    v_cvt_pk_bf16_f32 v80, v40, v41
    v_cvt_pk_bf16_f32 v81, v42, v43
    v_cvt_pk_bf16_f32 v82, v44, v45
    v_cvt_pk_bf16_f32 v83, v46, v47
    v_pk_add_f32 v[40:41], v[40:41], v[42:43]
    v_pk_add_f32 v[44:45], v[44:45], v[46:47]
    v_pk_add_f32 v[40:41], v[40:41], v[44:45]
    v_add_f32 v62, v40, v41
    s_mov_b32 s55, 126976
    s_add_u32 m0, s63, 19456
    s_nop 0
    buffer_load_dwordx4 v243, s[28:31], s55 offen offset:0 sc1 lds
    s_waitcnt lgkmcnt(0)
    v_mfma_f32_16x16x32_bf16 v[88:91], v[204:207], v[68:71], 0
    v_mfma_f32_16x16x32_bf16 v[92:95], v[216:219], v[68:71], 0
    v_mfma_f32_16x16x32_bf16 v[96:99], v[210:213], v[72:75], 0
    v_mfma_f32_16x16x32_bf16 v[100:103], v[216:219], v[72:75], 0
    v_mfma_f32_16x16x32_bf16 v[104:107], v[206:209], v[76:79], 0
    v_mfma_f32_16x16x32_bf16 v[108:111], v[218:221], v[76:79], 0
    v_mfma_f32_16x16x32_bf16 v[112:115], v[212:215], v[80:83], 0
    v_mfma_f32_16x16x32_bf16 v[116:119], v[218:221], v[80:83], 0
    v_mov_b32 v51, v50
    v_mov_b32 v55, v54
    v_mov_b32 v59, v58
    v_mov_b32 v63, v62
    v_permlane16_swap_b32 v50, v51
    v_permlane16_swap_b32 v54, v55
    v_permlane16_swap_b32 v58, v59
    v_permlane16_swap_b32 v62, v63
    v_add_f32 v50, v50, v51
    v_add_f32 v54, v54, v55
    v_add_f32 v58, v58, v59
    v_add_f32 v62, v62, v63
    v_mov_b32 v51, v50
    v_mov_b32 v55, v54
    v_mov_b32 v59, v58
    v_mov_b32 v63, v62
    v_permlane32_swap_b32 v50, v51
    v_permlane32_swap_b32 v54, v55
    v_permlane32_swap_b32 v58, v59
    v_permlane32_swap_b32 v62, v63
    v_add_f32 v50, v50, v51
    v_add_f32 v54, v54, v55
    v_add_f32 v58, v58, v59
    v_add_f32 v62, v62, v63
    v_rcp_f32 v50, v50
    v_rcp_f32 v54, v54
    v_rcp_f32 v58, v58
    v_rcp_f32 v62, v62
    v_pk_mul_f32 v[88:89], v[88:89], v[50:51] op_sel_hi:[1,0]
    v_pk_mul_f32 v[90:91], v[90:91], v[50:51] op_sel_hi:[1,0]
    v_pk_mul_f32 v[92:93], v[92:93], v[50:51] op_sel_hi:[1,0]
    v_pk_mul_f32 v[94:95], v[94:95], v[50:51] op_sel_hi:[1,0]
    v_pk_mul_f32 v[96:97], v[96:97], v[54:55] op_sel_hi:[1,0]
    v_pk_mul_f32 v[98:99], v[98:99], v[54:55] op_sel_hi:[1,0]
    v_pk_mul_f32 v[100:101], v[100:101], v[54:55] op_sel_hi:[1,0]
    v_pk_mul_f32 v[102:103], v[102:103], v[54:55] op_sel_hi:[1,0]
    v_pk_mul_f32 v[104:105], v[104:105], v[58:59] op_sel_hi:[1,0]
    v_pk_mul_f32 v[106:107], v[106:107], v[58:59] op_sel_hi:[1,0]
    v_pk_mul_f32 v[108:109], v[108:109], v[58:59] op_sel_hi:[1,0]
    v_pk_mul_f32 v[110:111], v[110:111], v[58:59] op_sel_hi:[1,0]
    v_pk_mul_f32 v[112:113], v[112:113], v[62:63] op_sel_hi:[1,0]
    v_pk_mul_f32 v[114:115], v[114:115], v[62:63] op_sel_hi:[1,0]
    v_pk_mul_f32 v[116:117], v[116:117], v[62:63] op_sel_hi:[1,0]
    v_pk_mul_f32 v[118:119], v[118:119], v[62:63] op_sel_hi:[1,0]
    v_cvt_pk_bf16_f32 v16, v88, v89
    v_cvt_pk_bf16_f32 v17, v90, v91
    v_cvt_pk_bf16_f32 v18, v96, v97
    v_cvt_pk_bf16_f32 v19, v98, v99
    v_cvt_pk_bf16_f32 v20, v92, v93
    v_cvt_pk_bf16_f32 v21, v94, v95
    v_cvt_pk_bf16_f32 v24, v100, v101
    v_cvt_pk_bf16_f32 v25, v102, v103
    s_nop 0
    v_permlane16_swap_b32 v24, v22
    v_permlane16_swap_b32 v25, v23
    v_cvt_pk_bf16_f32 v28, v104, v105
    v_cvt_pk_bf16_f32 v29, v106, v107
    v_cvt_pk_bf16_f32 v30, v112, v113
    v_cvt_pk_bf16_f32 v31, v114, v115
    v_cvt_pk_bf16_f32 v32, v108, v109
    v_cvt_pk_bf16_f32 v33, v110, v111
    v_cvt_pk_bf16_f32 v36, v116, v117
    v_cvt_pk_bf16_f32 v37, v118, v119
    s_nop 0
    v_permlane16_swap_b32 v36, v34
    v_permlane16_swap_b32 v37, v35
    s_mov_b32 s55, 163840
    s_add_u32 m0, s63, 20480
    s_nop 0
    buffer_load_dwordx4 v243, s[28:31], s55 offen offset:0 sc1 lds
    buffer_load_dwordx4 v243, s[28:31], s55 offen offset:1024 sc1 lds
    buffer_load_dwordx4 v243, s[28:31], s55 offen offset:2048 sc1 lds
    buffer_load_dwordx4 v243, s[28:31], s55 offen offset:3072 sc1 lds
    s_mov_b32 s55, 167936
    s_add_u32 m0, s63, 24576
    s_nop 0
    buffer_load_dwordx4 v243, s[28:31], s55 offen offset:0 sc1 lds
    s_movk_i32 s55, 20480
    buffer_store_dwordx4 v[16:19], v240, s[28:31], 0 offen sc1
    buffer_store_dwordx4 v[28:31], v240, s[28:31], s55 offen sc1
    s_mov_b64 exec, 0xffff
    buffer_store_dwordx4 v[20:23], v241, s[28:31], 0 offen sc1
    buffer_store_dwordx4 v[32:35], v241, s[28:31], s55 offen sc1
    s_mov_b64 exec, -1
    s_lshl_b32 s58, s45, 4
    s_add_u32 s58, s58, s46
    s_mov_b32 s60, s58
    s_lshl_b32 s58, s47, 2
    s_add_u32 s58, s58, s3
    s_mul_i32 s59, s58, 20480
    s_mul_i32 s49, s48, 2560
    s_add_u32 s49, s49, s59
    v_lshlrev_b32 v84, 7, v3
    v_lshl_add_u32 v84, v2, 3, v84
    v_add_u32 v84, s49, v84
    s_mov_b32 s58, s60
    s_mov_b32 s55, 0xe80000
    s_mov_b32 s56, 0xc00000
    buffer_load_dwordx2 v[64:65], v84, s[28:31], s55 offen offset:0 sc1
    buffer_load_dwordx2 v[66:67], v84, s[28:31], s55 offen offset:512 sc1
    buffer_load_dwordx2 v[68:69], v84, s[28:31], s55 offen offset:1024 sc1
    buffer_load_dwordx2 v[70:71], v84, s[28:31], s55 offen offset:1536 sc1
    buffer_load_dwordx2 v[72:73], v84, s[28:31], s55 offen offset:2048 sc1
    buffer_load_dwordx2 v[74:75], v84, s[28:31], s56 offen offset:0 sc1
    buffer_load_dwordx2 v[76:77], v84, s[28:31], s56 offen offset:512 sc1
    buffer_load_dwordx2 v[78:79], v84, s[28:31], s56 offen offset:1024 sc1
    buffer_load_dwordx2 v[80:81], v84, s[28:31], s56 offen offset:1536 sc1
    buffer_load_dwordx2 v[82:83], v84, s[28:31], s56 offen offset:2048 sc1
    s_waitcnt vmcnt(10)
    s_barrier
    s_cmp_lg_u32 s3, 0
    s_cbranch_scc1 NOFLAG_28
    s_lshl_b32 s49, s58, 2
    s_add_u32 s49, s49, 0xb40800
    v_mov_b32 v8, s49
    v_mov_b32 v9, s44
    s_mov_b64 exec, 1
    s_cmp_eq_u32 s67, 0
    s_cbranch_scc1 STG_30
    buffer_store_dword v9, v8, s[28:31], 0 offen
    s_branch STE_31
STG_30:
    buffer_store_dword v9, v8, s[28:31], 0 offen sc1
STE_31:
    s_mov_b64 exec, -1
    s_branch FLAGEND_29
NOFLAG_28:
    s_movk_i32 s57, 20480
    buffer_load_dword v252, v240, s[28:31], 0 offen sc1
    buffer_load_dword v252, v241, s[28:31], 0 offen sc1
    buffer_load_dword v252, v240, s[28:31], s57 offen sc1
    buffer_load_dword v252, v241, s[28:31], s57 offen sc1
    s_cmp_lg_u32 s3, 1
    s_cbranch_scc1 RBX_32
    v_subrev_u32 v253, 40960, v240
    v_subrev_u32 v254, 40960, v241
    buffer_load_dword v252, v253, s[28:31], 0 offen sc1
    buffer_load_dword v252, v254, s[28:31], 0 offen sc1
    buffer_load_dword v252, v253, s[28:31], s57 offen sc1
    buffer_load_dword v252, v254, s[28:31], s57 offen sc1
RBX_32:
FLAGEND_29:
    s_lshl_b32 s58, s47, 2
    s_add_u32 s58, s58, s3
    s_mul_i32 s59, s58, 20480
    s_mul_i32 s49, s48, 2560
    s_add_u32 s49, s49, s59
    v_lshlrev_b32 v8, 7, v3
    v_lshl_add_u32 v8, v2, 3, v8
    v_add_u32 v8, s49, v8
    s_add_u32 s49, s59, 0x1100000
    v_add_u32 v6, s49, v4
    v_mov_b32 v10, v4
    v_add_u32 v11, 61440, v4
    ds_read_b128 v[144:147], v10 offset:0
    ds_read_b128 v[148:151], v10 offset:1024
    ds_read_b128 v[152:155], v10 offset:2048
    ds_read_b128 v[156:159], v10 offset:3072
    ds_read_b128 v[160:163], v10 offset:4096
    ds_read_b128 v[164:167], v10 offset:5120
    ds_read_b128 v[168:171], v10 offset:6144
    ds_read_b128 v[172:175], v10 offset:7168
    ds_read_b128 v[176:179], v10 offset:8192
    ds_read_b128 v[180:183], v10 offset:9216
    s_mov_b32 s60, 0
    s_mov_b32 s61, 4096
    s_mov_b32 s62, 8192
    s_mov_b32 s63, 12288
    s_mov_b32 s64, 16384
    s_mov_b32 s52, 0xffff0000
    s_waitcnt vmcnt(0)
    v_lshlrev_b32 v40, 16, v64
    v_and_b32 v41, s52, v64
    v_lshlrev_b32 v42, 16, v65
    v_and_b32 v43, s52, v65
    v_lshlrev_b32 v44, 16, v66
    v_and_b32 v45, s52, v66
    v_lshlrev_b32 v46, 16, v67
    v_and_b32 v47, s52, v67
    v_lshlrev_b32 v48, 16, v68
    v_and_b32 v49, s52, v68
    v_lshlrev_b32 v50, 16, v69
    v_and_b32 v51, s52, v69
    v_lshlrev_b32 v52, 16, v70
    v_and_b32 v53, s52, v70
    v_lshlrev_b32 v54, 16, v71
    v_and_b32 v55, s52, v71
    v_lshlrev_b32 v56, 16, v72
    v_and_b32 v57, s52, v72
    v_lshlrev_b32 v58, 16, v73
    v_and_b32 v59, s52, v73
    v_lshlrev_b32 v88, 16, v74
    v_and_b32 v89, s52, v74
    v_lshlrev_b32 v90, 16, v75
    v_and_b32 v91, s52, v75
    v_lshlrev_b32 v92, 16, v76
    v_and_b32 v93, s52, v76
    v_lshlrev_b32 v94, 16, v77
    v_and_b32 v95, s52, v77
    v_lshlrev_b32 v96, 16, v78
    v_and_b32 v97, s52, v78
    v_lshlrev_b32 v98, 16, v79
    v_and_b32 v99, s52, v79
    v_lshlrev_b32 v100, 16, v80
    v_and_b32 v101, s52, v80
    v_lshlrev_b32 v102, 16, v81
    v_and_b32 v103, s52, v81
    v_lshlrev_b32 v104, 16, v82
    v_and_b32 v105, s52, v82
    v_lshlrev_b32 v106, 16, v83
    v_and_b32 v107, s52, v83
    s_lshl_b32 s57, s58, 11
    s_add_u32 s57, s57, 0xb80000
    s_lshl_b32 s49, s48, 8
    s_add_u32 s49, s49, s57
    v_lshl_add_u32 v12, v2, 4, s49
    v_lshlrev_b32 v13, 9, v3
    v_lshl_add_u32 v13, v2, 4, v13
    v_add_u32 v13, s57, v13
    s_mul_i32 s54, s48, 5
    s_lshr_b32 s54, s54, 1
    s_lshl_b32 s54, s54, 10
    s_add_u32 s54, s54, s59
    v_add_u32 v14, s54, v4
    s_lshr_b32 s54, s47, 1
    s_lshl_b32 s54, s54, 4
    s_cmp_lg_u32 s3, 0
    s_cbranch_scc1 POLLDONE_33
    s_lshl_b32 s49, s54, 2
    s_add_u32 s49, s49, 0xb40800
    v_add_u32 v240, 0, v1
    v_min_u32 v240, 15, v240
    v_lshl_add_u32 v240, v240, 2, s49
    s_mov_b32 s51, 0x8000
POLL_34:
    buffer_load_dword v241, v240, s[28:31], 0 offen sc1
    s_waitcnt vmcnt(0)
    v_cmp_ne_u32 vcc, s44, v241
    s_nop 1
    s_cbranch_vccz POLLDONE_33
    s_sleep 2
    s_sub_u32 s51, s51, 1
    s_cmp_lg_u32 s51, 0
    s_cbranch_scc1 POLL_34
POLLDONE_33:
    s_barrier
    buffer_load_dwordx4 a[160:163], v6, s[28:31], s60 offen offset:0 sc1
    buffer_load_dwordx4 a[164:167], v6, s[28:31], s60 offen offset:1024 sc1
    buffer_load_dwordx4 a[168:171], v6, s[28:31], s60 offen offset:2048 sc1
    buffer_load_dwordx4 a[172:175], v6, s[28:31], s60 offen offset:3072 sc1
    buffer_load_dwordx4 a[176:179], v6, s[28:31], s61 offen offset:0 sc1
    buffer_load_dwordx4 a[180:183], v6, s[28:31], s61 offen offset:1024 sc1
    buffer_load_dwordx4 a[184:187], v6, s[28:31], s61 offen offset:2048 sc1
    buffer_load_dwordx4 a[188:191], v6, s[28:31], s61 offen offset:3072 sc1
    buffer_load_dwordx4 a[192:195], v6, s[28:31], s62 offen offset:0 sc1
    buffer_load_dwordx4 a[196:199], v6, s[28:31], s62 offen offset:1024 sc1
    buffer_load_dwordx4 a[200:203], v6, s[28:31], s62 offen offset:2048 sc1
    buffer_load_dwordx4 a[204:207], v6, s[28:31], s62 offen offset:3072 sc1
    buffer_load_dwordx4 a[208:211], v6, s[28:31], s63 offen offset:0 sc1
    buffer_load_dwordx4 a[212:215], v6, s[28:31], s63 offen offset:1024 sc1
    buffer_load_dwordx4 a[216:219], v6, s[28:31], s63 offen offset:2048 sc1
    buffer_load_dwordx4 a[220:223], v6, s[28:31], s63 offen offset:3072 sc1
    buffer_load_dwordx4 a[224:227], v6, s[28:31], s64 offen offset:0 sc1
    buffer_load_dwordx4 a[228:231], v6, s[28:31], s64 offen offset:1024 sc1
    buffer_load_dwordx4 a[232:235], v6, s[28:31], s64 offen offset:2048 sc1
    buffer_load_dwordx4 a[236:239], v6, s[28:31], s64 offen offset:3072 sc1
    s_waitcnt lgkmcnt(0)
    s_waitcnt vmcnt(18)
    v_mfma_f32_16x16x32_bf16 v[40:43], v[144:147], a[160:163], v[40:43]
    ds_read_b128 v[184:187], v10 offset:10240
    v_mfma_f32_16x16x32_bf16 v[44:47], v[148:151], a[160:163], v[44:47]
    ds_read_b128 v[188:191], v10 offset:11264
    v_mfma_f32_16x16x32_bf16 v[48:51], v[152:155], a[160:163], v[48:51]
    ds_read_b128 v[192:195], v10 offset:12288
    v_mfma_f32_16x16x32_bf16 v[52:55], v[156:159], a[160:163], v[52:55]
    ds_read_b128 v[196:199], v10 offset:13312
    v_mfma_f32_16x16x32_bf16 v[56:59], v[160:163], a[160:163], v[56:59]
    ds_read_b128 v[200:203], v10 offset:14336
    v_mfma_f32_16x16x32_bf16 v[40:43], v[164:167], a[164:167], v[40:43]
    ds_read_b128 v[204:207], v10 offset:15360
    v_mfma_f32_16x16x32_bf16 v[44:47], v[168:171], a[164:167], v[44:47]
    ds_read_b128 v[208:211], v10 offset:16384
    v_mfma_f32_16x16x32_bf16 v[48:51], v[172:175], a[164:167], v[48:51]
    ds_read_b128 v[212:215], v10 offset:17408
    v_mfma_f32_16x16x32_bf16 v[52:55], v[176:179], a[164:167], v[52:55]
    ds_read_b128 v[216:219], v10 offset:18432
    v_mfma_f32_16x16x32_bf16 v[56:59], v[180:183], a[164:167], v[56:59]
    ds_read_b128 v[220:223], v10 offset:19456
    s_waitcnt lgkmcnt(0)
    s_waitcnt vmcnt(16)
    v_mfma_f32_16x16x32_bf16 v[40:43], v[184:187], a[168:171], v[40:43]
    ds_read_b128 v[144:147], v10 offset:20480
    v_mfma_f32_16x16x32_bf16 v[44:47], v[188:191], a[168:171], v[44:47]
    ds_read_b128 v[148:151], v10 offset:21504
    v_mfma_f32_16x16x32_bf16 v[48:51], v[192:195], a[168:171], v[48:51]
    ds_read_b128 v[152:155], v10 offset:22528
    v_mfma_f32_16x16x32_bf16 v[52:55], v[196:199], a[168:171], v[52:55]
    ds_read_b128 v[156:159], v10 offset:23552
    v_mfma_f32_16x16x32_bf16 v[56:59], v[200:203], a[168:171], v[56:59]
    ds_read_b128 v[160:163], v10 offset:24576
    v_mfma_f32_16x16x32_bf16 v[40:43], v[204:207], a[172:175], v[40:43]
    ds_read_b128 v[164:167], v10 offset:25600
    v_mfma_f32_16x16x32_bf16 v[44:47], v[208:211], a[172:175], v[44:47]
    ds_read_b128 v[168:171], v10 offset:26624
    v_mfma_f32_16x16x32_bf16 v[48:51], v[212:215], a[172:175], v[48:51]
    ds_read_b128 v[172:175], v10 offset:27648
    v_mfma_f32_16x16x32_bf16 v[52:55], v[216:219], a[172:175], v[52:55]
    ds_read_b128 v[176:179], v10 offset:28672
    v_mfma_f32_16x16x32_bf16 v[56:59], v[220:223], a[172:175], v[56:59]
    ds_read_b128 v[180:183], v10 offset:29696
    s_waitcnt lgkmcnt(0)
    s_waitcnt vmcnt(14)
    v_mfma_f32_16x16x32_bf16 v[40:43], v[144:147], a[176:179], v[40:43]
    ds_read_b128 v[184:187], v10 offset:30720
    v_mfma_f32_16x16x32_bf16 v[44:47], v[148:151], a[176:179], v[44:47]
    ds_read_b128 v[188:191], v10 offset:31744
    v_mfma_f32_16x16x32_bf16 v[48:51], v[152:155], a[176:179], v[48:51]
    ds_read_b128 v[192:195], v10 offset:32768
    v_mfma_f32_16x16x32_bf16 v[52:55], v[156:159], a[176:179], v[52:55]
    ds_read_b128 v[196:199], v10 offset:33792
    v_mfma_f32_16x16x32_bf16 v[56:59], v[160:163], a[176:179], v[56:59]
    ds_read_b128 v[200:203], v10 offset:34816
    v_mfma_f32_16x16x32_bf16 v[40:43], v[164:167], a[180:183], v[40:43]
    ds_read_b128 v[204:207], v10 offset:35840
    v_mfma_f32_16x16x32_bf16 v[44:47], v[168:171], a[180:183], v[44:47]
    ds_read_b128 v[208:211], v10 offset:36864
    v_mfma_f32_16x16x32_bf16 v[48:51], v[172:175], a[180:183], v[48:51]
    ds_read_b128 v[212:215], v10 offset:37888
    v_mfma_f32_16x16x32_bf16 v[52:55], v[176:179], a[180:183], v[52:55]
    ds_read_b128 v[216:219], v10 offset:38912
    v_mfma_f32_16x16x32_bf16 v[56:59], v[180:183], a[180:183], v[56:59]
    ds_read_b128 v[220:223], v10 offset:39936
    s_waitcnt lgkmcnt(0)
    s_waitcnt vmcnt(12)
    v_mfma_f32_16x16x32_bf16 v[40:43], v[184:187], a[184:187], v[40:43]
    ds_read_b128 v[144:147], v10 offset:40960
    v_mfma_f32_16x16x32_bf16 v[44:47], v[188:191], a[184:187], v[44:47]
    ds_read_b128 v[148:151], v10 offset:41984
    v_mfma_f32_16x16x32_bf16 v[48:51], v[192:195], a[184:187], v[48:51]
    ds_read_b128 v[152:155], v10 offset:43008
    v_mfma_f32_16x16x32_bf16 v[52:55], v[196:199], a[184:187], v[52:55]
    ds_read_b128 v[156:159], v10 offset:44032
    v_mfma_f32_16x16x32_bf16 v[56:59], v[200:203], a[184:187], v[56:59]
    ds_read_b128 v[160:163], v10 offset:45056
    v_mfma_f32_16x16x32_bf16 v[40:43], v[204:207], a[188:191], v[40:43]
    ds_read_b128 v[164:167], v10 offset:46080
    v_mfma_f32_16x16x32_bf16 v[44:47], v[208:211], a[188:191], v[44:47]
    ds_read_b128 v[168:171], v10 offset:47104
    v_mfma_f32_16x16x32_bf16 v[48:51], v[212:215], a[188:191], v[48:51]
    ds_read_b128 v[172:175], v10 offset:48128
    v_mfma_f32_16x16x32_bf16 v[52:55], v[216:219], a[188:191], v[52:55]
    ds_read_b128 v[176:179], v10 offset:49152
    v_mfma_f32_16x16x32_bf16 v[56:59], v[220:223], a[188:191], v[56:59]
    ds_read_b128 v[180:183], v10 offset:50176
    s_waitcnt lgkmcnt(0)
    s_waitcnt vmcnt(10)
    v_mfma_f32_16x16x32_bf16 v[40:43], v[144:147], a[192:195], v[40:43]
    ds_read_b128 v[184:187], v10 offset:51200
    v_mfma_f32_16x16x32_bf16 v[44:47], v[148:151], a[192:195], v[44:47]
    ds_read_b128 v[188:191], v10 offset:52224
    v_mfma_f32_16x16x32_bf16 v[48:51], v[152:155], a[192:195], v[48:51]
    ds_read_b128 v[192:195], v10 offset:53248
    v_mfma_f32_16x16x32_bf16 v[52:55], v[156:159], a[192:195], v[52:55]
    ds_read_b128 v[196:199], v10 offset:54272
    v_mfma_f32_16x16x32_bf16 v[56:59], v[160:163], a[192:195], v[56:59]
    ds_read_b128 v[200:203], v10 offset:55296
    v_mfma_f32_16x16x32_bf16 v[40:43], v[164:167], a[196:199], v[40:43]
    ds_read_b128 v[204:207], v10 offset:56320
    v_mfma_f32_16x16x32_bf16 v[44:47], v[168:171], a[196:199], v[44:47]
    ds_read_b128 v[208:211], v10 offset:57344
    v_mfma_f32_16x16x32_bf16 v[48:51], v[172:175], a[196:199], v[48:51]
    ds_read_b128 v[212:215], v10 offset:58368
    v_mfma_f32_16x16x32_bf16 v[52:55], v[176:179], a[196:199], v[52:55]
    ds_read_b128 v[216:219], v10 offset:59392
    v_mfma_f32_16x16x32_bf16 v[56:59], v[180:183], a[196:199], v[56:59]
    ds_read_b128 v[220:223], v10 offset:60416
    s_waitcnt lgkmcnt(0)
    s_waitcnt vmcnt(8)
    v_mfma_f32_16x16x32_bf16 v[40:43], v[184:187], a[200:203], v[40:43]
    ds_read_b128 v[144:147], v11 offset:0
    v_mfma_f32_16x16x32_bf16 v[44:47], v[188:191], a[200:203], v[44:47]
    ds_read_b128 v[148:151], v11 offset:1024
    v_mfma_f32_16x16x32_bf16 v[48:51], v[192:195], a[200:203], v[48:51]
    ds_read_b128 v[152:155], v11 offset:2048
    v_mfma_f32_16x16x32_bf16 v[52:55], v[196:199], a[200:203], v[52:55]
    ds_read_b128 v[156:159], v11 offset:3072
    v_mfma_f32_16x16x32_bf16 v[56:59], v[200:203], a[200:203], v[56:59]
    ds_read_b128 v[160:163], v11 offset:4096
    v_mfma_f32_16x16x32_bf16 v[40:43], v[204:207], a[204:207], v[40:43]
    ds_read_b128 v[164:167], v11 offset:5120
    v_mfma_f32_16x16x32_bf16 v[44:47], v[208:211], a[204:207], v[44:47]
    ds_read_b128 v[168:171], v11 offset:6144
    v_mfma_f32_16x16x32_bf16 v[48:51], v[212:215], a[204:207], v[48:51]
    ds_read_b128 v[172:175], v11 offset:7168
    v_mfma_f32_16x16x32_bf16 v[52:55], v[216:219], a[204:207], v[52:55]
    ds_read_b128 v[176:179], v11 offset:8192
    v_mfma_f32_16x16x32_bf16 v[56:59], v[220:223], a[204:207], v[56:59]
    ds_read_b128 v[180:183], v11 offset:9216
    s_waitcnt lgkmcnt(0)
    s_waitcnt vmcnt(6)
    v_mfma_f32_16x16x32_bf16 v[40:43], v[144:147], a[208:211], v[40:43]
    ds_read_b128 v[184:187], v11 offset:10240
    v_mfma_f32_16x16x32_bf16 v[44:47], v[148:151], a[208:211], v[44:47]
    ds_read_b128 v[188:191], v11 offset:11264
    v_mfma_f32_16x16x32_bf16 v[48:51], v[152:155], a[208:211], v[48:51]
    ds_read_b128 v[192:195], v11 offset:12288
    v_mfma_f32_16x16x32_bf16 v[52:55], v[156:159], a[208:211], v[52:55]
    ds_read_b128 v[196:199], v11 offset:13312
    v_mfma_f32_16x16x32_bf16 v[56:59], v[160:163], a[208:211], v[56:59]
    ds_read_b128 v[200:203], v11 offset:14336
    v_mfma_f32_16x16x32_bf16 v[40:43], v[164:167], a[212:215], v[40:43]
    ds_read_b128 v[204:207], v11 offset:15360
    v_mfma_f32_16x16x32_bf16 v[44:47], v[168:171], a[212:215], v[44:47]
    ds_read_b128 v[208:211], v11 offset:16384
    v_mfma_f32_16x16x32_bf16 v[48:51], v[172:175], a[212:215], v[48:51]
    ds_read_b128 v[212:215], v11 offset:17408
    v_mfma_f32_16x16x32_bf16 v[52:55], v[176:179], a[212:215], v[52:55]
    ds_read_b128 v[216:219], v11 offset:18432
    v_mfma_f32_16x16x32_bf16 v[56:59], v[180:183], a[212:215], v[56:59]
    ds_read_b128 v[220:223], v11 offset:19456
    s_waitcnt lgkmcnt(0)
    s_waitcnt vmcnt(4)
    v_mfma_f32_16x16x32_bf16 v[40:43], v[184:187], a[216:219], v[40:43]
    ds_read_b128 v[144:147], v11 offset:20480
    v_mfma_f32_16x16x32_bf16 v[44:47], v[188:191], a[216:219], v[44:47]
    ds_read_b128 v[148:151], v11 offset:21504
    v_mfma_f32_16x16x32_bf16 v[48:51], v[192:195], a[216:219], v[48:51]
    ds_read_b128 v[152:155], v11 offset:22528
    v_mfma_f32_16x16x32_bf16 v[52:55], v[196:199], a[216:219], v[52:55]
    ds_read_b128 v[156:159], v11 offset:23552
    v_mfma_f32_16x16x32_bf16 v[56:59], v[200:203], a[216:219], v[56:59]
    ds_read_b128 v[160:163], v11 offset:24576
    v_mfma_f32_16x16x32_bf16 v[40:43], v[204:207], a[220:223], v[40:43]
    ds_read_b128 v[164:167], v11 offset:25600
    v_mfma_f32_16x16x32_bf16 v[44:47], v[208:211], a[220:223], v[44:47]
    ds_read_b128 v[168:171], v11 offset:26624
    v_mfma_f32_16x16x32_bf16 v[48:51], v[212:215], a[220:223], v[48:51]
    ds_read_b128 v[172:175], v11 offset:27648
    v_mfma_f32_16x16x32_bf16 v[52:55], v[216:219], a[220:223], v[52:55]
    ds_read_b128 v[176:179], v11 offset:28672
    v_mfma_f32_16x16x32_bf16 v[56:59], v[220:223], a[220:223], v[56:59]
    ds_read_b128 v[180:183], v11 offset:29696
    s_waitcnt lgkmcnt(0)
    s_waitcnt vmcnt(2)
    v_mfma_f32_16x16x32_bf16 v[40:43], v[144:147], a[224:227], v[40:43]
    ds_read_b128 v[184:187], v11 offset:30720
    v_mfma_f32_16x16x32_bf16 v[44:47], v[148:151], a[224:227], v[44:47]
    ds_read_b128 v[188:191], v11 offset:31744
    v_mfma_f32_16x16x32_bf16 v[48:51], v[152:155], a[224:227], v[48:51]
    ds_read_b128 v[192:195], v11 offset:32768
    v_mfma_f32_16x16x32_bf16 v[52:55], v[156:159], a[224:227], v[52:55]
    ds_read_b128 v[196:199], v11 offset:33792
    v_mfma_f32_16x16x32_bf16 v[56:59], v[160:163], a[224:227], v[56:59]
    ds_read_b128 v[200:203], v11 offset:34816
    v_mfma_f32_16x16x32_bf16 v[40:43], v[164:167], a[228:231], v[40:43]
    ds_read_b128 v[204:207], v11 offset:35840
    v_mfma_f32_16x16x32_bf16 v[44:47], v[168:171], a[228:231], v[44:47]
    ds_read_b128 v[208:211], v11 offset:36864
    v_mfma_f32_16x16x32_bf16 v[48:51], v[172:175], a[228:231], v[48:51]
    ds_read_b128 v[212:215], v11 offset:37888
    v_mfma_f32_16x16x32_bf16 v[52:55], v[176:179], a[228:231], v[52:55]
    ds_read_b128 v[216:219], v11 offset:38912
    v_mfma_f32_16x16x32_bf16 v[56:59], v[180:183], a[228:231], v[56:59]
    ds_read_b128 v[220:223], v11 offset:39936
    s_waitcnt lgkmcnt(0)
    s_waitcnt vmcnt(0)
    v_mfma_f32_16x16x32_bf16 v[40:43], v[184:187], a[232:235], v[40:43]
    v_mfma_f32_16x16x32_bf16 v[44:47], v[188:191], a[232:235], v[44:47]
    v_mfma_f32_16x16x32_bf16 v[48:51], v[192:195], a[232:235], v[48:51]
    v_mfma_f32_16x16x32_bf16 v[52:55], v[196:199], a[232:235], v[52:55]
    v_mfma_f32_16x16x32_bf16 v[56:59], v[200:203], a[232:235], v[56:59]
    v_mfma_f32_16x16x32_bf16 v[40:43], v[204:207], a[236:239], v[40:43]
    v_mfma_f32_16x16x32_bf16 v[44:47], v[208:211], a[236:239], v[44:47]
    v_mfma_f32_16x16x32_bf16 v[48:51], v[212:215], a[236:239], v[48:51]
    v_mfma_f32_16x16x32_bf16 v[52:55], v[216:219], a[236:239], v[52:55]
    v_mfma_f32_16x16x32_bf16 v[56:59], v[220:223], a[236:239], v[56:59]
    s_nop 3
    v_pk_add_f32 v[84:85], v[40:41], v[42:43]
    v_pk_mul_f32 v[86:87], v[40:41], v[40:41]
    v_pk_fma_f32 v[86:87], v[42:43], v[42:43], v[86:87]
    v_pk_add_f32 v[84:85], v[84:85], v[44:45]
    v_pk_fma_f32 v[86:87], v[44:45], v[44:45], v[86:87]
    v_pk_add_f32 v[84:85], v[84:85], v[46:47]
    v_pk_fma_f32 v[86:87], v[46:47], v[46:47], v[86:87]
    v_pk_add_f32 v[84:85], v[84:85], v[48:49]
    v_pk_fma_f32 v[86:87], v[48:49], v[48:49], v[86:87]
    v_pk_add_f32 v[84:85], v[84:85], v[50:51]
    v_pk_fma_f32 v[86:87], v[50:51], v[50:51], v[86:87]
    v_pk_add_f32 v[84:85], v[84:85], v[52:53]
    v_pk_fma_f32 v[86:87], v[52:53], v[52:53], v[86:87]
    v_pk_add_f32 v[84:85], v[84:85], v[54:55]
    v_pk_fma_f32 v[86:87], v[54:55], v[54:55], v[86:87]
    v_pk_add_f32 v[84:85], v[84:85], v[56:57]
    v_pk_fma_f32 v[86:87], v[56:57], v[56:57], v[86:87]
    v_pk_add_f32 v[84:85], v[84:85], v[58:59]
    v_pk_fma_f32 v[86:87], v[58:59], v[58:59], v[86:87]
    v_add_f32 v84, v84, v85
    v_add_f32 v85, v86, v87
    v_mov_b32 v86, s44
    v_mov_b32 v87, 0
    v_mov_b32 v120, v84
    v_mov_b32 v121, v85
    s_nop 0
    v_permlane16_swap_b32 v84, v120
    v_permlane16_swap_b32 v85, v121
    v_add_f32 v84, v84, v120
    v_add_f32 v85, v85, v121
    v_mov_b32 v120, v84
    v_mov_b32 v121, v85
    s_nop 0
    v_permlane32_swap_b32 v84, v120
    v_permlane32_swap_b32 v85, v121
    v_add_f32 v84, v84, v120
    v_add_f32 v85, v85, v121
    s_mov_b64 exec, 0xffff
    s_cmp_eq_u32 s67, 0
    s_cbranch_scc1 STG_35
    buffer_store_dwordx4 v[84:87], v12, s[28:31], 0 offen
    s_branch STE_36
STG_35:
    buffer_store_dwordx4 v[84:87], v12, s[28:31], 0 offen sc1
STE_36:
    s_mov_b64 exec, -1
    s_mov_b32 s54, 0x8000
EXPOLL_37:
    buffer_load_dwordx3 v[108:110], v13, s[28:31], 0 offen sc1
    buffer_load_dwordx3 v[112:114], v13, s[28:31], 0 offen offset:256 sc1
    s_waitcnt vmcnt(0)
    v_cmp_ne_u32 vcc, s44, v110
    v_cmp_ne_u32 s[56:57], s44, v114
    s_nop 1
    s_or_b64 vcc, vcc, s[56:57]
    s_cbranch_vccz EXGOT_38
    s_sub_u32 s54, s54, 1
    s_cmp_lg_u32 s54, 0
    s_cbranch_scc1 EXPOLL_37
EXGOT_38:
    v_add_f32 v84, v108, v112
    v_add_f32 v85, v109, v113
    v_mov_b32 v120, v84
    v_mov_b32 v121, v85
    s_nop 0
    v_permlane16_swap_b32 v84, v120
    v_permlane16_swap_b32 v85, v121
    v_add_f32 v84, v84, v120
    v_add_f32 v85, v85, v121
    v_mov_b32 v120, v84
    v_mov_b32 v121, v85
    s_nop 0
    v_permlane32_swap_b32 v84, v120
    v_permlane32_swap_b32 v85, v121
    v_add_f32 v84, v84, v120
    v_add_f32 v85, v85, v121
    v_mul_f32 v84, 0xbacccccd, v84
    v_mov_b32 v86, 0x3727c5ac
    v_fmac_f32 v86, 0x3acccccd, v85
    v_fma_f32 v86, -v84, v84, v86
    v_max_f32 v86, 0x3727c5ac, v86
    v_rsq_f32 v86, v86
    v_pk_add_f32 v[64:65], v[40:41], v[84:85] op_sel_hi:[1,0]
    v_pk_add_f32 v[66:67], v[42:43], v[84:85] op_sel_hi:[1,0]
    v_pk_add_f32 v[68:69], v[44:45], v[84:85] op_sel_hi:[1,0]
    v_pk_add_f32 v[70:71], v[46:47], v[84:85] op_sel_hi:[1,0]
    v_pk_add_f32 v[72:73], v[48:49], v[84:85] op_sel_hi:[1,0]
    v_pk_add_f32 v[74:75], v[50:51], v[84:85] op_sel_hi:[1,0]
    v_pk_add_f32 v[76:77], v[52:53], v[84:85] op_sel_hi:[1,0]
    v_pk_add_f32 v[78:79], v[54:55], v[84:85] op_sel_hi:[1,0]
    v_pk_add_f32 v[80:81], v[56:57], v[84:85] op_sel_hi:[1,0]
    v_pk_add_f32 v[82:83], v[58:59], v[84:85] op_sel_hi:[1,0]
    v_pk_mul_f32 v[88:89], v[88:89], v[86:87] op_sel_hi:[1,0]
    v_pk_mul_f32 v[90:91], v[90:91], v[86:87] op_sel_hi:[1,0]
    v_pk_mul_f32 v[92:93], v[92:93], v[86:87] op_sel_hi:[1,0]
    v_pk_mul_f32 v[94:95], v[94:95], v[86:87] op_sel_hi:[1,0]
    v_pk_mul_f32 v[96:97], v[96:97], v[86:87] op_sel_hi:[1,0]
    v_pk_mul_f32 v[98:99], v[98:99], v[86:87] op_sel_hi:[1,0]
    v_pk_mul_f32 v[100:101], v[100:101], v[86:87] op_sel_hi:[1,0]
    v_pk_mul_f32 v[102:103], v[102:103], v[86:87] op_sel_hi:[1,0]
    v_pk_mul_f32 v[104:105], v[104:105], v[86:87] op_sel_hi:[1,0]
    v_pk_mul_f32 v[106:107], v[106:107], v[86:87] op_sel_hi:[1,0]
    v_pk_fma_f32 v[40:41], v[64:65], v[88:89], v[40:41]
    v_pk_fma_f32 v[42:43], v[66:67], v[90:91], v[42:43]
    v_pk_fma_f32 v[44:45], v[68:69], v[92:93], v[44:45]
    v_pk_fma_f32 v[46:47], v[70:71], v[94:95], v[46:47]
    v_pk_fma_f32 v[48:49], v[72:73], v[96:97], v[48:49]
    v_pk_fma_f32 v[50:51], v[74:75], v[98:99], v[50:51]
    v_pk_fma_f32 v[52:53], v[76:77], v[100:101], v[52:53]
    v_pk_fma_f32 v[54:55], v[78:79], v[102:103], v[54:55]
    v_pk_fma_f32 v[56:57], v[80:81], v[104:105], v[56:57]
    v_pk_fma_f32 v[58:59], v[82:83], v[106:107], v[58:59]
    v_cvt_pk_bf16_f32 v132, v40, v41
    v_cvt_pk_bf16_f32 v133, v42, v43
    v_cvt_pk_bf16_f32 v134, v44, v45
    v_cvt_pk_bf16_f32 v135, v46, v47
    v_cvt_pk_bf16_f32 v136, v48, v49
    v_cvt_pk_bf16_f32 v137, v50, v51
    v_cvt_pk_bf16_f32 v138, v52, v53
    v_cvt_pk_bf16_f32 v139, v54, v55
    v_cvt_pk_bf16_f32 v140, v56, v57
    v_cvt_pk_bf16_f32 v141, v58, v59
    s_mov_b32 s55, 0x1380000
    s_bitcmp1_b32 s48, 0
    s_cbranch_scc1 X3ODD_39
    s_cmp_eq_u32 s67, 0
    s_cbranch_scc1 STG_41
    buffer_store_dwordx4 v[132:135], v14, s[28:31], s55 offen
    buffer_store_dwordx4 v[136:139], v14, s[28:31], s55 offen offset:1024
    buffer_store_dwordx2 v[140:141], v14, s[28:31], s55 offen offset:2048
    s_branch STE_42
STG_41:
    buffer_store_dwordx4 v[132:135], v14, s[28:31], s55 offen sc1
    buffer_store_dwordx4 v[136:139], v14, s[28:31], s55 offen offset:1024 sc1
    buffer_store_dwordx2 v[140:141], v14, s[28:31], s55 offen offset:2048 sc1
STE_42:
    s_branch X3END_40
X3ODD_39:
    s_cmp_eq_u32 s67, 0
    s_cbranch_scc1 STG_43
    buffer_store_dwordx2 v[132:133], v14, s[28:31], s55 offen offset:8
    buffer_store_dwordx4 v[134:137], v14, s[28:31], s55 offen offset:1024
    buffer_store_dwordx4 v[138:141], v14, s[28:31], s55 offen offset:2048
    s_branch STE_44
STG_43:
    buffer_store_dwordx2 v[132:133], v14, s[28:31], s55 offen offset:8 sc1
    buffer_store_dwordx4 v[134:137], v14, s[28:31], s55 offen offset:1024 sc1
    buffer_store_dwordx4 v[138:141], v14, s[28:31], s55 offen offset:2048 sc1
STE_44:
X3END_40:
    s_mov_b32 s56, 0
    s_and_b32 s49, s58, 7
    s_cmp_lg_u32 s49, 7
    s_cbranch_scc1 NOHALO_45
    s_lshr_b32 s50, s58, 3
    s_add_u32 s50, s50, 1
    s_mul_i32 s51, s50, 20480
    s_add_u32 s51, s51, 0x1880000
    s_sub_u32 s51, s51, s59
    s_bitcmp1_b32 s48, 0
    s_cbranch_scc1 X3ODD_46
    buffer_store_dwordx4 v[132:135], v14, s[28:31], s51 offen sc1
    buffer_store_dwordx4 v[136:139], v14, s[28:31], s51 offen offset:1024 sc1
    buffer_store_dwordx2 v[140:141], v14, s[28:31], s51 offen offset:2048 sc1
    s_branch X3END_47
X3ODD_46:
    buffer_store_dwordx2 v[132:133], v14, s[28:31], s51 offen offset:8 sc1
    buffer_store_dwordx4 v[134:137], v14, s[28:31], s51 offen offset:1024 sc1
    buffer_store_dwordx4 v[138:141], v14, s[28:31], s51 offen offset:2048 sc1
X3END_47:
    s_mov_b32 s56, 1
NOHALO_45:
    s_cmp_eq_u32 s56, 1
    s_cbranch_scc1 W3_48
    s_waitcnt vmcnt(0)
    s_branch W0_49
W3_48:
    s_waitcnt vmcnt(3)
W0_49:
    s_barrier
    s_lshl_b32 s58, s47, 3
    s_add_u32 s58, s58, s48
    s_cmp_lg_u32 s3, 0
    s_cbranch_scc1 NOFLAG_50
    s_lshl_b32 s49, s58, 2
    s_add_u32 s49, s49, 0xb40c00
    v_mov_b32 v8, s49
    v_mov_b32 v9, s44
    s_mov_b64 exec, 1
    s_cmp_eq_u32 s67, 0
    s_cbranch_scc1 STG_51
    buffer_store_dword v9, v8, s[28:31], 0 offen
    s_branch STE_52
STG_51:
    buffer_store_dword v9, v8, s[28:31], 0 offen sc1
STE_52:
    s_mov_b64 exec, -1
NOFLAG_50:
    s_cmp_lg_u32 s56, 1
    s_cbranch_scc1 NOHFLAG_54
    s_waitcnt vmcnt(0)
    s_lshl_b32 s50, s50, 3
    s_add_u32 s50, s50, s48
    s_lshl_b32 s50, s50, 2
    s_add_u32 s50, s50, 0xb41400
    v_mov_b32 v9, s50
    v_mov_b32 v10, s44
    s_mov_b64 exec, 1
    buffer_store_dword v10, v9, s[28:31], 0 offen sc1
    s_mov_b64 exec, -1
NOHFLAG_54:
    s_lshl_b32 s58, s45, 3
    s_lshl_b32 s49, s3, 1
    s_add_u32 s49, s49, s58
    s_mul_i32 s59, s49, 20480
    s_add_u32 s49, s59, 0x1380000
    v_add_u32 v5, s49, v4
    v_add_u32 v6, 19456, v5
    s_mul_i32 s50, s3, 5120
    s_mul_i32 s49, s45, 20480
    s_add_u32 s49, s49, 0x1880000
    s_add_u32 s49, s49, s50
    s_cmp_eq_u32 s45, 0
    s_cselect_b32 s49, 0x7ff00000, s49
    v_add_u32 v7, s49, v4
    s_add_u32 s62, s50, 131072
    s_and_b32 s49, s46, 7
    s_add_u32 s60, s49, s58
    s_mul_i32 s49, s60, 20480
    s_add_u32 s49, s49, s50
    s_add_u32 s49, s49, 0x1380000
    v_add_u32 v8, s49, v4
    v_add_u32 v9, 4096, v8
    s_lshl_b32 s61, s3, 11
    v_mov_b32 v12, v4
    v_add_u32 v13, 65536, v12
    v_add_u32 v10, 131072, v12
    v_lshlrev_b32 v180, 2, v3
    v_sub_u32 v180, v2, v180
    v_mov_b32 v181, 0
    v_mov_b32 v182, 0xf149f2ca
    v_add_u32 v183, 0, v180
    v_and_b32 v183, 0xfffffff1, v183
    v_cmp_eq_u32 vcc, 0, v183
    s_nop 1
    v_cndmask_b32 v224, v182, v181, vcc
    v_add_u32 v183, 16, v180
    v_and_b32 v183, 0xfffffff1, v183
    v_cmp_eq_u32 vcc, 0, v183
    s_nop 1
    v_cndmask_b32 v228, v182, v181, vcc
    v_add_u32 v183, -1, v180
    v_and_b32 v183, 0xfffffff1, v183
    v_cmp_eq_u32 vcc, 0, v183
    s_nop 1
    v_cndmask_b32 v225, v182, v181, vcc
    v_add_u32 v183, 15, v180
    v_and_b32 v183, 0xfffffff1, v183
    v_cmp_eq_u32 vcc, 0, v183
    s_nop 1
    v_cndmask_b32 v229, v182, v181, vcc
    v_add_u32 v183, -2, v180
    v_and_b32 v183, 0xfffffff1, v183
    v_cmp_eq_u32 vcc, 0, v183
    s_nop 1
    v_cndmask_b32 v226, v182, v181, vcc
    v_add_u32 v183, 14, v180
    v_and_b32 v183, 0xfffffff1, v183
    v_cmp_eq_u32 vcc, 0, v183
    s_nop 1
    v_cndmask_b32 v230, v182, v181, vcc
    v_add_u32 v183, -3, v180
    v_and_b32 v183, 0xfffffff1, v183
    v_cmp_eq_u32 vcc, 0, v183
    s_nop 1
    v_cndmask_b32 v227, v182, v181, vcc
    v_add_u32 v183, 13, v180
    v_and_b32 v183, 0xfffffff1, v183
    v_cmp_eq_u32 vcc, 0, v183
    s_nop 1
    v_cndmask_b32 v231, v182, v181, vcc
    s_or_b32 s49, s45, s3
    s_cmp_eq_u32 s49, 0
    s_cselect_b64 s[52:53], -1, 0
    v_cndmask_b32 v232, v228, v182, s[52:53]
    v_cndmask_b32 v233, v229, v182, s[52:53]
    v_cndmask_b32 v234, v230, v182, s[52:53]
    v_cndmask_b32 v235, v231, v182, s[52:53]
    v_mul_u32_u24 v180, 272, v2
    s_lshl_b32 s49, s3, 6
    s_add_u32 s49, s49, 102400
    v_lshl_add_u32 v242, v3, 3, s49
    v_add_u32 v242, v242, v180
    s_mul_i32 s49, s3, 8704
    s_add_u32 s49, s49, 102400
    v_add_u32 v236, s49, v180
    v_lshl_add_u32 v237, v3, 3, v236
    v_cmp_eq_u32 s[56:57], 0, v3
    v_mov_b32 v238, 240
    v_mov_b32 v181, 128
    v_cndmask_b32 v238, v238, v181, s[56:57]
    v_add_u32 v238, v238, v236
    v_lshrrev_b32 v239, 2, v2
    v_lshl_add_u32 v239, v3, 2, v239
    v_mul_u32_u24 v239, 272, v239
    v_and_b32 v181, 3, v1
    v_lshl_add_u32 v239, v181, 3, v239
    v_add_u32 v239, s49, v239
    s_mul_i32 s49, s46, 1280
    s_add_u32 s49, s49, s59
    s_add_u32 s49, s49, 0x1600000
    v_lshlrev_b32 v181, 4, v2
    v_lshl_add_u32 v240, v3, 8, v181
    v_add_u32 v240, s49, v240
    s_add_u32 s49, s49, 1024
    v_add_u32 v241, s49, v181
    s_mul_i32 s63, s3, 25600
    s_mul_i32 s54, s48, 5120
    s_mul_i32 s55, s3, 204800
    s_add_u32 s54, s54, s55
    s_add_u32 s54, s54, 0xa00000
    v_lshrrev_b32 v243, 2, v2
    v_lshlrev_b32 v243, 8, v243
    v_lshl_add_u32 v243, v3, 6, v243
    v_and_b32 v181, 3, v2
    v_lshl_add_u32 v243, v181, 4, v243
    v_add_u32 v243, s54, v243
    s_lshl_b32 s54, s45, 4
    s_cmp_lg_u32 s3, 0
    s_cbranch_scc1 POLLDONE_55
    s_lshl_b32 s49, s54, 2
    s_add_u32 s49, s49, 0xb40c00
    v_add_u32 v200, 0, v1
    v_min_u32 v200, 15, v200
    v_lshl_add_u32 v200, v200, 2, s49
    s_mov_b32 s51, 0x8000
POLL_56:
    buffer_load_dword v201, v200, s[28:31], 0 offen sc1
    s_waitcnt vmcnt(0)
    v_cmp_ne_u32 vcc, s44, v201
    s_nop 1
    s_cbranch_vccz POLLDONE_55
    s_sleep 2
    s_sub_u32 s51, s51, 1
    s_cmp_lg_u32 s51, 0
    s_cbranch_scc1 POLL_56
POLLDONE_55:
    s_barrier
    buffer_load_dwordx4 v[144:147], v8, s[28:31], 0 offen offset:0 sc1
    buffer_load_dwordx4 v[148:151], v8, s[28:31], 0 offen offset:1024 sc1
    buffer_load_dwordx4 v[152:155], v8, s[28:31], 0 offen offset:2048 sc1
    buffer_load_dwordx4 v[156:159], v8, s[28:31], 0 offen offset:3072 sc1
    buffer_load_dwordx4 v[160:163], v9, s[28:31], 0 offen sc1
    s_add_u32 m0, s61, 0
    s_mov_b32 s64, 0
    buffer_load_dwordx4 v5, s[28:31], s64 offen sc1 lds
    buffer_load_dwordx4 v6, s[28:31], s64 offen offset:1024 sc1 lds
    s_add_u32 m0, s61, 8192
    s_mov_b32 s64, 1024
    buffer_load_dwordx4 v5, s[28:31], s64 offen sc1 lds
    buffer_load_dwordx4 v6, s[28:31], s64 offen offset:1024 sc1 lds
    s_add_u32 m0, s61, 16384
    s_mov_b32 s64, 2048
    buffer_load_dwordx4 v5, s[28:31], s64 offen sc1 lds
    buffer_load_dwordx4 v6, s[28:31], s64 offen offset:1024 sc1 lds
    s_add_u32 m0, s61, 24576
    s_mov_b32 s64, 3072
    buffer_load_dwordx4 v5, s[28:31], s64 offen sc1 lds
    buffer_load_dwordx4 v6, s[28:31], s64 offen offset:1024 sc1 lds
    s_add_u32 m0, s61, 32768
    s_mov_b32 s64, 4096
    buffer_load_dwordx4 v5, s[28:31], s64 offen sc1 lds
    buffer_load_dwordx4 v6, s[28:31], s64 offen offset:1024 sc1 lds
    s_add_u32 m0, s61, 40960
    s_mov_b32 s64, 5120
    buffer_load_dwordx4 v5, s[28:31], s64 offen sc1 lds
    buffer_load_dwordx4 v6, s[28:31], s64 offen offset:1024 sc1 lds
    s_add_u32 m0, s61, 49152
    s_mov_b32 s64, 6144
    buffer_load_dwordx4 v5, s[28:31], s64 offen sc1 lds
    buffer_load_dwordx4 v6, s[28:31], s64 offen offset:1024 sc1 lds
    s_waitcnt vmcnt(14)
    s_mov_b32 s55, 0x3f803f80
    v_mov_b32 v164, 0
    v_mov_b32 v165, 0
    v_mov_b32 v166, 0
    v_mov_b32 v167, 0
    v_dot2_f32_bf16 v164, v144, s55, v164
    v_dot2_f32_bf16 v165, v144, v144, v165
    v_dot2_f32_bf16 v166, v145, s55, v166
    v_dot2_f32_bf16 v167, v145, v145, v167
    v_dot2_f32_bf16 v164, v146, s55, v164
    v_dot2_f32_bf16 v165, v146, v146, v165
    v_dot2_f32_bf16 v166, v147, s55, v166
    v_dot2_f32_bf16 v167, v147, v147, v167
    v_dot2_f32_bf16 v164, v148, s55, v164
    v_dot2_f32_bf16 v165, v148, v148, v165
    v_dot2_f32_bf16 v166, v149, s55, v166
    v_dot2_f32_bf16 v167, v149, v149, v167
    v_dot2_f32_bf16 v164, v150, s55, v164
    v_dot2_f32_bf16 v165, v150, v150, v165
    v_dot2_f32_bf16 v166, v151, s55, v166
    v_dot2_f32_bf16 v167, v151, v151, v167
    v_dot2_f32_bf16 v164, v152, s55, v164
    v_dot2_f32_bf16 v165, v152, v152, v165
    v_dot2_f32_bf16 v166, v153, s55, v166
    v_dot2_f32_bf16 v167, v153, v153, v167
    v_dot2_f32_bf16 v164, v154, s55, v164
    v_dot2_f32_bf16 v165, v154, v154, v165
    v_dot2_f32_bf16 v166, v155, s55, v166
    v_dot2_f32_bf16 v167, v155, v155, v167
    v_dot2_f32_bf16 v164, v156, s55, v164
    v_dot2_f32_bf16 v165, v156, v156, v165
    v_dot2_f32_bf16 v166, v157, s55, v166
    v_dot2_f32_bf16 v167, v157, v157, v167
    v_dot2_f32_bf16 v164, v158, s55, v164
    v_dot2_f32_bf16 v165, v158, v158, v165
    v_dot2_f32_bf16 v166, v159, s55, v166
    v_dot2_f32_bf16 v167, v159, v159, v167
    v_dot2_f32_bf16 v164, v160, s55, v164
    v_dot2_f32_bf16 v165, v160, v160, v165
    v_dot2_f32_bf16 v166, v161, s55, v166
    v_dot2_f32_bf16 v167, v161, v161, v167
    v_dot2_f32_bf16 v164, v162, s55, v164
    v_dot2_f32_bf16 v165, v162, v162, v165
    v_dot2_f32_bf16 v166, v163, s55, v166
    v_dot2_f32_bf16 v167, v163, v163, v167
    s_nop 1
    v_add_f32 v164, v164, v166
    v_add_f32 v165, v165, v167
    v_mov_b32 v168, v164
    v_mov_b32 v169, v165
    s_nop 0
    v_permlane16_swap_b32 v164, v168
    v_permlane16_swap_b32 v165, v169
    v_add_f32 v164, v164, v168
    v_add_f32 v165, v165, v169
    v_mov_b32 v168, v164
    v_mov_b32 v169, v165
    s_nop 0
    v_permlane32_swap_b32 v164, v168
    v_permlane32_swap_b32 v165, v169
    v_add_f32 v164, v164, v168
    v_add_f32 v165, v165, v169
    s_lshl_b32 s55, s3, 7
    s_add_u32 s55, s55, 151552
    v_lshl_add_u32 v15, v2, 3, s55
    s_mov_b64 exec, 0xffff
    ds_write_b64 v15, v[164:165]
    s_mov_b64 exec, -1
    s_waitcnt lgkmcnt(0)
    s_waitcnt vmcnt(12)
    s_barrier
    v_lshlrev_b32 v15, 3, v2
    v_add_u32 v15, 151552, v15
    ds_read_b64 v[144:145], v15 offset:0
    ds_read_b64 v[146:147], v15 offset:128
    ds_read_b64 v[148:149], v15 offset:256
    ds_read_b64 v[150:151], v15 offset:384
    ds_read_b128 a[160:163], v12 offset:0
    ds_read_b128 a[164:167], v12 offset:1024
    ds_read_b128 a[168:171], v12 offset:2048
    ds_read_b128 a[172:175], v12 offset:3072
    ds_read_b128 a[176:179], v12 offset:4096
    ds_read_b128 a[180:183], v12 offset:5120
    ds_read_b128 a[184:187], v12 offset:6144
    ds_read_b128 a[188:191], v12 offset:7168
    s_waitcnt lgkmcnt(8)
    v_mov_b32 v176, 0x3727c5ac
    s_mov_b32 s55, 0x3acccccd
    s_mov_b32 s56, 0xbacccccd
    v_add_f32 v144, v144, v146
    v_add_f32 v148, v148, v150
    v_add_f32 v145, v145, v147
    v_add_f32 v149, v149, v151
    v_add_f32 v144, v144, v148
    v_add_f32 v145, v145, v149
    v_mul_f32 v168, s56, v144
    v_fma_f32 v169, v145, s55, v176
    v_fma_f32 v169, -v168, v168, v169
    v_max_f32 v169, v169, v176
    v_rsq_f32 v169, v169
    v_mov_b32 v170, s44
    v_mov_b32 v171, 0
    s_lshl_b32 s55, s60, 8
    s_add_u32 s55, s55, 0xb60000
    v_lshl_add_u32 v15, v2, 4, s55
    s_cmp_eq_u32 s3, 0
    s_cselect_b64 s[56:57], 0xffff, 0
    v_mov_b32 v14, 0x7ff00000
    v_cndmask_b32 v15, v14, v15, s[56:57]
    buffer_store_dwordx4 v[168:171], v15, s[28:31], 0 offen sc1
    s_waitcnt lgkmcnt(0)
    v_mfma_f32_16x16x32_bf16 v[20:23], a[0:3], a[160:163], 0
    s_waitcnt vmcnt(9)
    s_barrier
    v_mfma_f32_16x16x32_bf16 v[56:59], a[4:7], a[160:163], 0
    ds_read_b128 a[192:195], v12 offset:8192
    s_add_u32 m0, s61, 57344
    v_mfma_f32_16x16x32_bf16 v[24:27], a[0:3], a[164:167], 0
    ds_read_b128 a[196:199], v12 offset:9216
    s_mov_b32 s64, 7168
    v_mfma_f32_16x16x32_bf16 v[60:63], a[4:7], a[164:167], 0
    buffer_load_dwordx4 v5, s[28:31], s64 offen sc1 lds
    v_mfma_f32_16x16x32_bf16 v[28:31], a[0:3], a[168:171], 0
    ds_read_b128 a[200:203], v12 offset:10240
    s_lshl_b32 s54, s45, 3
    v_mfma_f32_16x16x32_bf16 v[64:67], a[4:7], a[168:171], 0
    buffer_load_dwordx4 v6, s[28:31], s64 offen offset:1024 sc1 lds
    v_mfma_f32_16x16x32_bf16 v[32:35], a[0:3], a[172:175], 0
    ds_read_b128 a[204:207], v12 offset:11264
    s_lshl_b32 s49, s54, 2
    s_add_u32 s49, s49, 0xb41400
    v_add_u32 v248, 0, v1
    v_min_u32 v248, 7, v248
    v_lshl_add_u32 v248, v248, 2, s49
    buffer_load_dword v249, v248, s[28:31], 0 offen sc1
    v_mfma_f32_16x16x32_bf16 v[68:71], a[4:7], a[172:175], 0
    ds_read_b128 a[208:211], v12 offset:12288
    v_mfma_f32_16x16x32_bf16 v[36:39], a[0:3], a[176:179], 0
    ds_read_b128 a[212:215], v12 offset:13312
    v_mfma_f32_16x16x32_bf16 v[72:75], a[4:7], a[176:179], 0
    ds_read_b128 a[216:219], v12 offset:14336
    v_mfma_f32_16x16x32_bf16 v[40:43], a[0:3], a[180:183], 0
    ds_read_b128 a[220:223], v12 offset:15360
    v_mfma_f32_16x16x32_bf16 v[76:79], a[4:7], a[180:183], 0
    s_add_u32 m0, s61, 65536
    v_mfma_f32_16x16x32_bf16 v[44:47], a[0:3], a[184:187], 0
    s_mov_b32 s64, 8192
    v_mfma_f32_16x16x32_bf16 v[80:83], a[4:7], a[184:187], 0
    buffer_load_dwordx4 v5, s[28:31], s64 offen sc1 lds
    v_mfma_f32_16x16x32_bf16 v[48:51], a[0:3], a[188:191], 0
    buffer_load_dwordx4 v6, s[28:31], s64 offen offset:1024 sc1 lds
    v_mfma_f32_16x16x32_bf16 v[84:87], a[4:7], a[188:191], 0
    s_waitcnt lgkmcnt(4)
    v_mfma_f32_16x16x32_bf16 v[20:23], a[8:11], a[192:195], v[20:23]
    v_mfma_f32_16x16x32_bf16 v[56:59], a[12:15], a[192:195], v[56:59]
    ds_read_b128 a[160:163], v12 offset:16384
    s_add_u32 m0, s61, 73728
    v_mfma_f32_16x16x32_bf16 v[24:27], a[8:11], a[196:199], v[24:27]
    ds_read_b128 a[164:167], v12 offset:17408
    s_mov_b32 s64, 9216
    v_mfma_f32_16x16x32_bf16 v[60:63], a[12:15], a[196:199], v[60:63]
    buffer_load_dwordx4 v5, s[28:31], s64 offen sc1 lds
    v_mfma_f32_16x16x32_bf16 v[28:31], a[8:11], a[200:203], v[28:31]
    ds_read_b128 a[168:171], v12 offset:18432
    v_mfma_f32_16x16x32_bf16 v[64:67], a[12:15], a[200:203], v[64:67]
    buffer_load_dwordx4 v6, s[28:31], s64 offen offset:1024 sc1 lds
    v_mfma_f32_16x16x32_bf16 v[32:35], a[8:11], a[204:207], v[32:35]
    ds_read_b128 a[172:175], v12 offset:19456
    v_mfma_f32_16x16x32_bf16 v[68:71], a[12:15], a[204:207], v[68:71]
    ds_read_b128 a[176:179], v12 offset:20480
    s_waitcnt lgkmcnt(5)
    v_mfma_f32_16x16x32_bf16 v[36:39], a[8:11], a[208:211], v[36:39]
    ds_read_b128 a[180:183], v12 offset:21504
    v_mfma_f32_16x16x32_bf16 v[72:75], a[12:15], a[208:211], v[72:75]
    ds_read_b128 a[184:187], v12 offset:22528
    v_mfma_f32_16x16x32_bf16 v[40:43], a[8:11], a[212:215], v[40:43]
    ds_read_b128 a[188:191], v12 offset:23552
    v_mfma_f32_16x16x32_bf16 v[76:79], a[12:15], a[212:215], v[76:79]
    s_add_u32 m0, s61, 81920
    v_mfma_f32_16x16x32_bf16 v[44:47], a[8:11], a[216:219], v[44:47]
    s_mov_b32 s64, 10240
    v_mfma_f32_16x16x32_bf16 v[80:83], a[12:15], a[216:219], v[80:83]
    buffer_load_dwordx4 v5, s[28:31], s64 offen sc1 lds
    v_mfma_f32_16x16x32_bf16 v[48:51], a[8:11], a[220:223], v[48:51]
    buffer_load_dwordx4 v6, s[28:31], s64 offen offset:1024 sc1 lds
    v_mfma_f32_16x16x32_bf16 v[84:87], a[12:15], a[220:223], v[84:87]
    s_waitcnt lgkmcnt(4)
    v_mfma_f32_16x16x32_bf16 v[20:23], a[16:19], a[160:163], v[20:23]
    s_waitcnt vmcnt(14)
    s_barrier
    v_mfma_f32_16x16x32_bf16 v[56:59], a[20:23], a[160:163], v[56:59]
    ds_read_b128 a[192:195], v12 offset:24576
    s_add_u32 m0, s61, 90112
    v_mfma_f32_16x16x32_bf16 v[24:27], a[16:19], a[164:167], v[24:27]
    ds_read_b128 a[196:199], v12 offset:25600
    s_mov_b32 s64, 11264
    v_mfma_f32_16x16x32_bf16 v[60:63], a[20:23], a[164:167], v[60:63]
    buffer_load_dwordx4 v5, s[28:31], s64 offen sc1 lds
    v_mfma_f32_16x16x32_bf16 v[28:31], a[16:19], a[168:171], v[28:31]
    ds_read_b128 a[200:203], v12 offset:26624
    v_mfma_f32_16x16x32_bf16 v[64:67], a[20:23], a[168:171], v[64:67]
    buffer_load_dwordx4 v6, s[28:31], s64 offen offset:1024 sc1 lds
    v_mfma_f32_16x16x32_bf16 v[32:35], a[16:19], a[172:175], v[32:35]
    ds_read_b128 a[204:207], v12 offset:27648
    v_mfma_f32_16x16x32_bf16 v[68:71], a[20:23], a[172:175], v[68:71]
    ds_read_b128 a[208:211], v12 offset:28672
    s_waitcnt lgkmcnt(5)
    v_mfma_f32_16x16x32_bf16 v[36:39], a[16:19], a[176:179], v[36:39]
    ds_read_b128 a[212:215], v12 offset:29696
    v_mfma_f32_16x16x32_bf16 v[72:75], a[20:23], a[176:179], v[72:75]
    ds_read_b128 a[216:219], v12 offset:30720
    v_mfma_f32_16x16x32_bf16 v[40:43], a[16:19], a[180:183], v[40:43]
    ds_read_b128 a[220:223], v12 offset:31744
    v_mfma_f32_16x16x32_bf16 v[76:79], a[20:23], a[180:183], v[76:79]
    s_add_u32 m0, s61, 98304
    v_mfma_f32_16x16x32_bf16 v[44:47], a[16:19], a[184:187], v[44:47]
    s_mov_b32 s64, 12288
    v_mfma_f32_16x16x32_bf16 v[80:83], a[20:23], a[184:187], v[80:83]
    buffer_load_dwordx4 v5, s[28:31], s64 offen sc1 lds
    v_mfma_f32_16x16x32_bf16 v[48:51], a[16:19], a[188:191], v[48:51]
    buffer_load_dwordx4 v6, s[28:31], s64 offen offset:1024 sc1 lds
    v_mfma_f32_16x16x32_bf16 v[84:87], a[20:23], a[188:191], v[84:87]
    s_waitcnt lgkmcnt(4)
    v_mfma_f32_16x16x32_bf16 v[20:23], a[24:27], a[192:195], v[20:23]
    v_mfma_f32_16x16x32_bf16 v[56:59], a[28:31], a[192:195], v[56:59]
    ds_read_b128 a[160:163], v12 offset:32768
    s_add_u32 m0, s61, 106496
    v_mfma_f32_16x16x32_bf16 v[24:27], a[24:27], a[196:199], v[24:27]
    ds_read_b128 a[164:167], v12 offset:33792
    s_mov_b32 s64, 13312
    v_mfma_f32_16x16x32_bf16 v[60:63], a[28:31], a[196:199], v[60:63]
    buffer_load_dwordx4 v5, s[28:31], s64 offen sc1 lds
    v_mfma_f32_16x16x32_bf16 v[28:31], a[24:27], a[200:203], v[28:31]
    ds_read_b128 a[168:171], v12 offset:34816
    s_waitcnt vmcnt(11)
    s_cmp_eq_u32 s45, 0
    s_cbranch_scc1 HFOK_57
    v_cmp_ne_u32 vcc, s44, v249
    s_nop 1
    s_cbranch_vccz HFOK_57
    s_mov_b32 s51, 0x8000
POLL_58:
    buffer_load_dword v249, v248, s[28:31], 0 offen sc1
    s_waitcnt vmcnt(0)
    v_cmp_ne_u32 vcc, s44, v249
    s_nop 1
    s_cbranch_vccz HFOK_57
    s_sleep 4
    s_sub_u32 s51, s51, 1
    s_cmp_lg_u32 s51, 0
    s_cbranch_scc1 POLL_58
HFOK_57:
    v_mfma_f32_16x16x32_bf16 v[64:67], a[28:31], a[200:203], v[64:67]
    buffer_load_dwordx4 v6, s[28:31], s64 offen offset:1024 sc1 lds
    v_mfma_f32_16x16x32_bf16 v[32:35], a[24:27], a[204:207], v[32:35]
    ds_read_b128 a[172:175], v12 offset:35840
    v_mfma_f32_16x16x32_bf16 v[68:71], a[28:31], a[204:207], v[68:71]
    ds_read_b128 a[176:179], v12 offset:36864
    s_waitcnt lgkmcnt(5)
    v_mfma_f32_16x16x32_bf16 v[36:39], a[24:27], a[208:211], v[36:39]
    ds_read_b128 a[180:183], v12 offset:37888
    v_mfma_f32_16x16x32_bf16 v[72:75], a[28:31], a[208:211], v[72:75]
    ds_read_b128 a[184:187], v12 offset:38912
    v_mfma_f32_16x16x32_bf16 v[40:43], a[24:27], a[212:215], v[40:43]
    ds_read_b128 a[188:191], v12 offset:39936
    v_mfma_f32_16x16x32_bf16 v[76:79], a[28:31], a[212:215], v[76:79]
    v_mfma_f32_16x16x32_bf16 v[44:47], a[24:27], a[216:219], v[44:47]
    v_mfma_f32_16x16x32_bf16 v[80:83], a[28:31], a[216:219], v[80:83]
    v_mfma_f32_16x16x32_bf16 v[48:51], a[24:27], a[220:223], v[48:51]
    v_mfma_f32_16x16x32_bf16 v[84:87], a[28:31], a[220:223], v[84:87]
    s_waitcnt lgkmcnt(4)
    v_mfma_f32_16x16x32_bf16 v[20:23], a[32:35], a[160:163], v[20:23]
    s_barrier
    v_mfma_f32_16x16x32_bf16 v[56:59], a[36:39], a[160:163], v[56:59]
    ds_read_b128 a[192:195], v12 offset:40960
    s_add_u32 m0, s61, 114688
    v_mfma_f32_16x16x32_bf16 v[24:27], a[32:35], a[164:167], v[24:27]
    ds_read_b128 a[196:199], v12 offset:41984
    s_mov_b32 s64, 14336
    v_mfma_f32_16x16x32_bf16 v[60:63], a[36:39], a[164:167], v[60:63]
    buffer_load_dwordx4 v5, s[28:31], s64 offen sc1 lds
    v_mfma_f32_16x16x32_bf16 v[28:31], a[32:35], a[168:171], v[28:31]
    ds_read_b128 a[200:203], v12 offset:43008
    v_mfma_f32_16x16x32_bf16 v[64:67], a[36:39], a[168:171], v[64:67]
    buffer_load_dwordx4 v6, s[28:31], s64 offen offset:1024 sc1 lds
    v_mfma_f32_16x16x32_bf16 v[32:35], a[32:35], a[172:175], v[32:35]
    ds_read_b128 a[204:207], v12 offset:44032
    v_mfma_f32_16x16x32_bf16 v[68:71], a[36:39], a[172:175], v[68:71]
    ds_read_b128 a[208:211], v12 offset:45056
    s_add_u32 m0, s62, 0
    s_mov_b32 s66, 0
    s_waitcnt lgkmcnt(5)
    v_mfma_f32_16x16x32_bf16 v[36:39], a[32:35], a[176:179], v[36:39]
    ds_read_b128 a[212:215], v12 offset:46080
    buffer_load_dwordx4 v7, s[28:31], s66 offen sc1 lds
    v_mfma_f32_16x16x32_bf16 v[72:75], a[36:39], a[176:179], v[72:75]
    ds_read_b128 a[216:219], v12 offset:47104
    v_mfma_f32_16x16x32_bf16 v[40:43], a[32:35], a[180:183], v[40:43]
    ds_read_b128 a[220:223], v12 offset:48128
    v_mfma_f32_16x16x32_bf16 v[76:79], a[36:39], a[180:183], v[76:79]
    v_mfma_f32_16x16x32_bf16 v[44:47], a[32:35], a[184:187], v[44:47]
    v_mfma_f32_16x16x32_bf16 v[80:83], a[36:39], a[184:187], v[80:83]
    v_mfma_f32_16x16x32_bf16 v[48:51], a[32:35], a[188:191], v[48:51]
    v_mfma_f32_16x16x32_bf16 v[84:87], a[36:39], a[188:191], v[84:87]
    s_waitcnt lgkmcnt(4)
    v_mfma_f32_16x16x32_bf16 v[20:23], a[40:43], a[192:195], v[20:23]
    v_mfma_f32_16x16x32_bf16 v[56:59], a[44:47], a[192:195], v[56:59]
    ds_read_b128 a[160:163], v12 offset:49152
    s_add_u32 m0, s61, 122880
    v_mfma_f32_16x16x32_bf16 v[24:27], a[40:43], a[196:199], v[24:27]
    ds_read_b128 a[164:167], v12 offset:50176
    s_mov_b32 s64, 15360
    v_mfma_f32_16x16x32_bf16 v[60:63], a[44:47], a[196:199], v[60:63]
    buffer_load_dwordx4 v5, s[28:31], s64 offen sc1 lds
    v_mfma_f32_16x16x32_bf16 v[28:31], a[40:43], a[200:203], v[28:31]
    ds_read_b128 a[168:171], v12 offset:51200
    v_mfma_f32_16x16x32_bf16 v[64:67], a[44:47], a[200:203], v[64:67]
    buffer_load_dwordx4 v6, s[28:31], s64 offen offset:1024 sc1 lds
    v_mfma_f32_16x16x32_bf16 v[32:35], a[40:43], a[204:207], v[32:35]
    ds_read_b128 a[172:175], v12 offset:52224
    v_mfma_f32_16x16x32_bf16 v[68:71], a[44:47], a[204:207], v[68:71]
    ds_read_b128 a[176:179], v12 offset:53248
    s_add_u32 m0, s62, 1024
    s_mov_b32 s66, 1024
    s_waitcnt lgkmcnt(5)
    v_mfma_f32_16x16x32_bf16 v[36:39], a[40:43], a[208:211], v[36:39]
    ds_read_b128 a[180:183], v12 offset:54272
    buffer_load_dwordx4 v7, s[28:31], s66 offen sc1 lds
    v_mfma_f32_16x16x32_bf16 v[72:75], a[44:47], a[208:211], v[72:75]
    ds_read_b128 a[184:187], v12 offset:55296
    v_mfma_f32_16x16x32_bf16 v[40:43], a[40:43], a[212:215], v[40:43]
    ds_read_b128 a[188:191], v12 offset:56320
    v_mfma_f32_16x16x32_bf16 v[76:79], a[44:47], a[212:215], v[76:79]
    v_mfma_f32_16x16x32_bf16 v[44:47], a[40:43], a[216:219], v[44:47]
    v_mfma_f32_16x16x32_bf16 v[80:83], a[44:47], a[216:219], v[80:83]
    v_mfma_f32_16x16x32_bf16 v[48:51], a[40:43], a[220:223], v[48:51]
    v_mfma_f32_16x16x32_bf16 v[84:87], a[44:47], a[220:223], v[84:87]
    s_waitcnt lgkmcnt(4)
    v_mfma_f32_16x16x32_bf16 v[20:23], a[48:51], a[160:163], v[20:23]
    s_waitcnt vmcnt(16)
    s_barrier
    v_mfma_f32_16x16x32_bf16 v[56:59], a[52:55], a[160:163], v[56:59]
    ds_read_b128 a[192:195], v12 offset:57344
    s_add_u32 m0, s61, 0
    v_mfma_f32_16x16x32_bf16 v[24:27], a[48:51], a[164:167], v[24:27]
    ds_read_b128 a[196:199], v12 offset:58368
    s_mov_b32 s64, 16384
    v_mfma_f32_16x16x32_bf16 v[60:63], a[52:55], a[164:167], v[60:63]
    buffer_load_dwordx4 v5, s[28:31], s64 offen sc1 lds
    v_mfma_f32_16x16x32_bf16 v[28:31], a[48:51], a[168:171], v[28:31]
    ds_read_b128 a[200:203], v12 offset:59392
    v_mfma_f32_16x16x32_bf16 v[64:67], a[52:55], a[168:171], v[64:67]
    buffer_load_dwordx4 v6, s[28:31], s64 offen offset:1024 sc1 lds
    v_mfma_f32_16x16x32_bf16 v[32:35], a[48:51], a[172:175], v[32:35]
    ds_read_b128 a[204:207], v12 offset:60416
    v_mfma_f32_16x16x32_bf16 v[68:71], a[52:55], a[172:175], v[68:71]
    ds_read_b128 a[208:211], v12 offset:61440
    s_add_u32 m0, s62, 2048
    s_mov_b32 s66, 2048
    s_waitcnt lgkmcnt(5)
    v_mfma_f32_16x16x32_bf16 v[36:39], a[48:51], a[176:179], v[36:39]
    ds_read_b128 a[212:215], v12 offset:62464
    buffer_load_dwordx4 v7, s[28:31], s66 offen sc1 lds
    v_mfma_f32_16x16x32_bf16 v[72:75], a[52:55], a[176:179], v[72:75]
    ds_read_b128 a[216:219], v12 offset:63488
    v_mfma_f32_16x16x32_bf16 v[40:43], a[48:51], a[180:183], v[40:43]
    ds_read_b128 a[220:223], v12 offset:64512
    v_mfma_f32_16x16x32_bf16 v[76:79], a[52:55], a[180:183], v[76:79]
    v_mfma_f32_16x16x32_bf16 v[44:47], a[48:51], a[184:187], v[44:47]
    v_mfma_f32_16x16x32_bf16 v[80:83], a[52:55], a[184:187], v[80:83]
    v_mfma_f32_16x16x32_bf16 v[48:51], a[48:51], a[188:191], v[48:51]
    v_mfma_f32_16x16x32_bf16 v[84:87], a[52:55], a[188:191], v[84:87]
    s_waitcnt lgkmcnt(4)
    v_mfma_f32_16x16x32_bf16 v[20:23], a[56:59], a[192:195], v[20:23]
    v_mfma_f32_16x16x32_bf16 v[56:59], a[60:63], a[192:195], v[56:59]
    ds_read_b128 a[160:163], v13 offset:0
    s_add_u32 m0, s61, 8192
    v_mfma_f32_16x16x32_bf16 v[24:27], a[56:59], a[196:199], v[24:27]
    ds_read_b128 a[164:167], v13 offset:1024
    s_mov_b32 s64, 17408
    v_mfma_f32_16x16x32_bf16 v[60:63], a[60:63], a[196:199], v[60:63]
    buffer_load_dwordx4 v5, s[28:31], s64 offen sc1 lds
    v_mfma_f32_16x16x32_bf16 v[28:31], a[56:59], a[200:203], v[28:31]
    ds_read_b128 a[168:171], v13 offset:2048
    v_mfma_f32_16x16x32_bf16 v[64:67], a[60:63], a[200:203], v[64:67]
    buffer_load_dwordx4 v6, s[28:31], s64 offen offset:1024 sc1 lds
    v_mfma_f32_16x16x32_bf16 v[32:35], a[56:59], a[204:207], v[32:35]
    ds_read_b128 a[172:175], v13 offset:3072
    v_mfma_f32_16x16x32_bf16 v[68:71], a[60:63], a[204:207], v[68:71]
    ds_read_b128 a[176:179], v13 offset:4096
    s_add_u32 m0, s62, 3072
    s_mov_b32 s66, 3072
    s_waitcnt lgkmcnt(5)
    v_mfma_f32_16x16x32_bf16 v[36:39], a[56:59], a[208:211], v[36:39]
    ds_read_b128 a[180:183], v13 offset:5120
    buffer_load_dwordx4 v7, s[28:31], s66 offen sc1 lds
    v_mfma_f32_16x16x32_bf16 v[72:75], a[60:63], a[208:211], v[72:75]
    ds_read_b128 a[184:187], v13 offset:6144
    v_mfma_f32_16x16x32_bf16 v[40:43], a[56:59], a[212:215], v[40:43]
    ds_read_b128 a[188:191], v13 offset:7168
    v_mfma_f32_16x16x32_bf16 v[76:79], a[60:63], a[212:215], v[76:79]
    v_mfma_f32_16x16x32_bf16 v[44:47], a[56:59], a[216:219], v[44:47]
    v_mfma_f32_16x16x32_bf16 v[80:83], a[60:63], a[216:219], v[80:83]
    v_mfma_f32_16x16x32_bf16 v[48:51], a[56:59], a[220:223], v[48:51]
    v_mfma_f32_16x16x32_bf16 v[84:87], a[60:63], a[220:223], v[84:87]
    s_waitcnt lgkmcnt(4)
    v_mfma_f32_16x16x32_bf16 v[20:23], a[64:67], a[160:163], v[20:23]
    s_waitcnt vmcnt(18)
    s_barrier
    v_mfma_f32_16x16x32_bf16 v[56:59], a[68:71], a[160:163], v[56:59]
    ds_read_b128 a[192:195], v13 offset:8192
    s_add_u32 m0, s61, 16384
    v_mfma_f32_16x16x32_bf16 v[24:27], a[64:67], a[164:167], v[24:27]
    ds_read_b128 a[196:199], v13 offset:9216
    s_mov_b32 s64, 18432
    v_mfma_f32_16x16x32_bf16 v[60:63], a[68:71], a[164:167], v[60:63]
    buffer_load_dwordx4 v5, s[28:31], s64 offen sc1 lds
    v_mfma_f32_16x16x32_bf16 v[28:31], a[64:67], a[168:171], v[28:31]
    ds_read_b128 a[200:203], v13 offset:10240
    s_sub_u32 s55, s58, 1
    s_add_u32 s55, s55, s3
    v_mfma_f32_16x16x32_bf16 v[64:67], a[68:71], a[168:171], v[64:67]
    buffer_load_dwordx4 v6, s[28:31], s64 offen offset:1024 sc1 lds
    v_mfma_f32_16x16x32_bf16 v[32:35], a[64:67], a[172:175], v[32:35]
    ds_read_b128 a[204:207], v13 offset:11264
    s_lshl_b32 s55, s55, 8
    s_add_u32 s55, s55, 0xb60000
    v_mfma_f32_16x16x32_bf16 v[68:71], a[68:71], a[172:175], v[68:71]
    ds_read_b128 a[208:211], v13 offset:12288
    s_add_u32 m0, s62, 4096
    s_mov_b32 s66, 4096
    s_waitcnt lgkmcnt(5)
    v_mfma_f32_16x16x32_bf16 v[36:39], a[64:67], a[176:179], v[36:39]
    ds_read_b128 a[212:215], v13 offset:13312
    buffer_load_dwordx4 v7, s[28:31], s66 offen sc1 lds
    v_lshl_add_u32 v11, v2, 4, s55
    v_mfma_f32_16x16x32_bf16 v[72:75], a[68:71], a[176:179], v[72:75]
    ds_read_b128 a[216:219], v13 offset:14336
    s_or_b32 s55, s45, s3
    s_cmp_eq_u32 s55, 0
    s_cselect_b32 s55, 256, 0
    v_mfma_f32_16x16x32_bf16 v[40:43], a[64:67], a[180:183], v[40:43]
    ds_read_b128 a[220:223], v13 offset:15360
    v_add_u32 v15, s55, v11
    v_mfma_f32_16x16x32_bf16 v[76:79], a[68:71], a[180:183], v[76:79]
    s_movk_i32 s55, 1024
    s_cmp_eq_u32 s3, 0
    s_cselect_b32 s55, 2048, s55
    v_add_u32 v14, s55, v11
    v_mfma_f32_16x16x32_bf16 v[44:47], a[64:67], a[184:187], v[44:47]
    buffer_load_dwordx3 v[88:90], v15, s[28:31], 0 offen sc1
    buffer_load_dwordx3 v[92:94], v11, s[28:31], 0 offen offset:1024 sc1
    buffer_load_dwordx3 v[96:98], v14, s[28:31], 0 offen sc1
    v_mfma_f32_16x16x32_bf16 v[80:83], a[68:71], a[184:187], v[80:83]
    v_mfma_f32_16x16x32_bf16 v[48:51], a[64:67], a[188:191], v[48:51]
    v_mfma_f32_16x16x32_bf16 v[84:87], a[68:71], a[188:191], v[84:87]
    s_waitcnt lgkmcnt(4)
    v_mfma_f32_16x16x32_bf16 v[20:23], a[72:75], a[192:195], v[20:23]
    v_mfma_f32_16x16x32_bf16 v[56:59], a[76:79], a[192:195], v[56:59]
    ds_read_b128 a[160:163], v13 offset:16384
    s_add_u32 m0, s61, 24576
    v_mfma_f32_16x16x32_bf16 v[24:27], a[72:75], a[196:199], v[24:27]
    ds_read_b128 a[164:167], v13 offset:17408
    s_mov_b32 s64, 19456
    v_mfma_f32_16x16x32_bf16 v[60:63], a[76:79], a[196:199], v[60:63]
    buffer_load_dwordx4 v5, s[28:31], s64 offen sc1 lds
    v_mfma_f32_16x16x32_bf16 v[28:31], a[72:75], a[200:203], v[28:31]
    ds_read_b128 a[168:171], v13 offset:18432
    v_mfma_f32_16x16x32_bf16 v[64:67], a[76:79], a[200:203], v[64:67]
    buffer_load_dwordx4 v6, s[28:31], s64 offen offset:1024 sc1 lds
    v_mfma_f32_16x16x32_bf16 v[32:35], a[72:75], a[204:207], v[32:35]
    ds_read_b128 a[172:175], v13 offset:19456
    v_mfma_f32_16x16x32_bf16 v[68:71], a[76:79], a[204:207], v[68:71]
    ds_read_b128 a[176:179], v13 offset:20480
    s_waitcnt lgkmcnt(5)
    v_mfma_f32_16x16x32_bf16 v[36:39], a[72:75], a[208:211], v[36:39]
    ds_read_b128 a[180:183], v13 offset:21504
    v_mfma_f32_16x16x32_bf16 v[72:75], a[76:79], a[208:211], v[72:75]
    ds_read_b128 a[184:187], v13 offset:22528
    v_mfma_f32_16x16x32_bf16 v[40:43], a[72:75], a[212:215], v[40:43]
    ds_read_b128 a[188:191], v13 offset:23552
    v_mfma_f32_16x16x32_bf16 v[76:79], a[76:79], a[212:215], v[76:79]
    v_mfma_f32_16x16x32_bf16 v[44:47], a[72:75], a[216:219], v[44:47]
    v_mfma_f32_16x16x32_bf16 v[80:83], a[76:79], a[216:219], v[80:83]
    v_mfma_f32_16x16x32_bf16 v[48:51], a[72:75], a[220:223], v[48:51]
    v_mfma_f32_16x16x32_bf16 v[84:87], a[76:79], a[220:223], v[84:87]
    s_waitcnt lgkmcnt(4)
    v_mfma_f32_16x16x32_bf16 v[20:23], a[80:83], a[160:163], v[20:23]
    s_waitcnt vmcnt(5)
    s_barrier
    v_mfma_f32_16x16x32_bf16 v[56:59], a[84:87], a[160:163], v[56:59]
    ds_read_b128 a[192:195], v13 offset:24576
    v_mfma_f32_16x16x32_bf16 v[24:27], a[80:83], a[164:167], v[24:27]
    ds_read_b128 a[196:199], v13 offset:25600
    v_mfma_f32_16x16x32_bf16 v[60:63], a[84:87], a[164:167], v[60:63]
    v_mfma_f32_16x16x32_bf16 v[28:31], a[80:83], a[168:171], v[28:31]
    ds_read_b128 a[200:203], v13 offset:26624
    v_mfma_f32_16x16x32_bf16 v[64:67], a[84:87], a[168:171], v[64:67]
    v_mfma_f32_16x16x32_bf16 v[32:35], a[80:83], a[172:175], v[32:35]
    ds_read_b128 a[204:207], v13 offset:27648
    v_mfma_f32_16x16x32_bf16 v[68:71], a[84:87], a[172:175], v[68:71]
    ds_read_b128 a[208:211], v13 offset:28672
    s_waitcnt lgkmcnt(5)
    v_mfma_f32_16x16x32_bf16 v[36:39], a[80:83], a[176:179], v[36:39]
    ds_read_b128 a[212:215], v13 offset:29696
    v_mfma_f32_16x16x32_bf16 v[72:75], a[84:87], a[176:179], v[72:75]
    ds_read_b128 a[216:219], v13 offset:30720
    v_mfma_f32_16x16x32_bf16 v[40:43], a[80:83], a[180:183], v[40:43]
    ds_read_b128 a[220:223], v13 offset:31744
    v_mfma_f32_16x16x32_bf16 v[76:79], a[84:87], a[180:183], v[76:79]
    v_mfma_f32_16x16x32_bf16 v[44:47], a[80:83], a[184:187], v[44:47]
    v_mfma_f32_16x16x32_bf16 v[80:83], a[84:87], a[184:187], v[80:83]
    v_mfma_f32_16x16x32_bf16 v[48:51], a[80:83], a[188:191], v[48:51]
    v_mfma_f32_16x16x32_bf16 v[84:87], a[84:87], a[188:191], v[84:87]
    s_waitcnt lgkmcnt(4)
    v_mfma_f32_16x16x32_bf16 v[20:23], a[88:91], a[192:195], v[20:23]
    v_mfma_f32_16x16x32_bf16 v[56:59], a[92:95], a[192:195], v[56:59]
    ds_read_b128 a[160:163], v13 offset:32768
    v_mfma_f32_16x16x32_bf16 v[24:27], a[88:91], a[196:199], v[24:27]
    ds_read_b128 a[164:167], v13 offset:33792
    v_mfma_f32_16x16x32_bf16 v[60:63], a[92:95], a[196:199], v[60:63]
    v_mfma_f32_16x16x32_bf16 v[28:31], a[88:91], a[200:203], v[28:31]
    ds_read_b128 a[168:171], v13 offset:34816
    v_mfma_f32_16x16x32_bf16 v[64:67], a[92:95], a[200:203], v[64:67]
    v_mfma_f32_16x16x32_bf16 v[32:35], a[88:91], a[204:207], v[32:35]
    ds_read_b128 a[172:175], v13 offset:35840
    v_mfma_f32_16x16x32_bf16 v[68:71], a[92:95], a[204:207], v[68:71]
    ds_read_b128 a[176:179], v13 offset:36864
    s_waitcnt lgkmcnt(5)
    v_mfma_f32_16x16x32_bf16 v[36:39], a[88:91], a[208:211], v[36:39]
    ds_read_b128 a[180:183], v13 offset:37888
    v_mfma_f32_16x16x32_bf16 v[72:75], a[92:95], a[208:211], v[72:75]
    ds_read_b128 a[184:187], v13 offset:38912
    v_mfma_f32_16x16x32_bf16 v[40:43], a[88:91], a[212:215], v[40:43]
    ds_read_b128 a[188:191], v13 offset:39936
    v_mfma_f32_16x16x32_bf16 v[76:79], a[92:95], a[212:215], v[76:79]
    v_mfma_f32_16x16x32_bf16 v[44:47], a[88:91], a[216:219], v[44:47]
    v_mfma_f32_16x16x32_bf16 v[80:83], a[92:95], a[216:219], v[80:83]
    v_mfma_f32_16x16x32_bf16 v[48:51], a[88:91], a[220:223], v[48:51]
    v_mfma_f32_16x16x32_bf16 v[84:87], a[92:95], a[220:223], v[84:87]
    s_waitcnt lgkmcnt(4)
    v_mfma_f32_16x16x32_bf16 v[20:23], a[96:99], a[160:163], v[20:23]
    s_barrier
    v_mfma_f32_16x16x32_bf16 v[56:59], a[100:103], a[160:163], v[56:59]
    ds_read_b128 a[192:195], v13 offset:40960
    v_mfma_f32_16x16x32_bf16 v[24:27], a[96:99], a[164:167], v[24:27]
    ds_read_b128 a[196:199], v13 offset:41984
    v_mfma_f32_16x16x32_bf16 v[60:63], a[100:103], a[164:167], v[60:63]
    v_mfma_f32_16x16x32_bf16 v[28:31], a[96:99], a[168:171], v[28:31]
    ds_read_b128 a[200:203], v13 offset:43008
    v_mfma_f32_16x16x32_bf16 v[64:67], a[100:103], a[168:171], v[64:67]
    v_mfma_f32_16x16x32_bf16 v[32:35], a[96:99], a[172:175], v[32:35]
    ds_read_b128 a[204:207], v13 offset:44032
    v_mfma_f32_16x16x32_bf16 v[68:71], a[100:103], a[172:175], v[68:71]
    ds_read_b128 a[208:211], v13 offset:45056
    s_waitcnt lgkmcnt(5)
    v_mfma_f32_16x16x32_bf16 v[36:39], a[96:99], a[176:179], v[36:39]
    ds_read_b128 a[212:215], v13 offset:46080
    v_mfma_f32_16x16x32_bf16 v[72:75], a[100:103], a[176:179], v[72:75]
    ds_read_b128 a[216:219], v13 offset:47104
    v_mfma_f32_16x16x32_bf16 v[40:43], a[96:99], a[180:183], v[40:43]
    ds_read_b128 a[220:223], v13 offset:48128
    v_mfma_f32_16x16x32_bf16 v[76:79], a[100:103], a[180:183], v[76:79]
    v_mfma_f32_16x16x32_bf16 v[44:47], a[96:99], a[184:187], v[44:47]
    v_mfma_f32_16x16x32_bf16 v[80:83], a[100:103], a[184:187], v[80:83]
    v_mfma_f32_16x16x32_bf16 v[48:51], a[96:99], a[188:191], v[48:51]
    v_mfma_f32_16x16x32_bf16 v[84:87], a[100:103], a[188:191], v[84:87]
    s_waitcnt lgkmcnt(4)
    v_mfma_f32_16x16x32_bf16 v[20:23], a[104:107], a[192:195], v[20:23]
    v_mfma_f32_16x16x32_bf16 v[56:59], a[108:111], a[192:195], v[56:59]
    ds_read_b128 a[160:163], v13 offset:49152
    v_mfma_f32_16x16x32_bf16 v[24:27], a[104:107], a[196:199], v[24:27]
    ds_read_b128 a[164:167], v13 offset:50176
    v_mfma_f32_16x16x32_bf16 v[60:63], a[108:111], a[196:199], v[60:63]
    v_mfma_f32_16x16x32_bf16 v[28:31], a[104:107], a[200:203], v[28:31]
    ds_read_b128 a[168:171], v13 offset:51200
    ds_read_b128 v[144:147], v10 offset:0
    v_mfma_f32_16x16x32_bf16 v[64:67], a[108:111], a[200:203], v[64:67]
    v_mfma_f32_16x16x32_bf16 v[32:35], a[104:107], a[204:207], v[32:35]
    ds_read_b128 a[172:175], v13 offset:52224
    ds_read_b128 v[148:151], v10 offset:1024
    v_mfma_f32_16x16x32_bf16 v[68:71], a[108:111], a[204:207], v[68:71]
    ds_read_b128 a[176:179], v13 offset:53248
    s_waitcnt lgkmcnt(7)
    v_mfma_f32_16x16x32_bf16 v[36:39], a[104:107], a[208:211], v[36:39]
    ds_read_b128 a[180:183], v13 offset:54272
    ds_read_b128 v[152:155], v10 offset:2048
    v_mfma_f32_16x16x32_bf16 v[72:75], a[108:111], a[208:211], v[72:75]
    ds_read_b128 a[184:187], v13 offset:55296
    ds_read_b128 v[156:159], v10 offset:3072
    v_mfma_f32_16x16x32_bf16 v[40:43], a[104:107], a[212:215], v[40:43]
    ds_read_b128 a[188:191], v13 offset:56320
    ds_read_b128 v[160:163], v10 offset:4096
    v_mfma_f32_16x16x32_bf16 v[76:79], a[108:111], a[212:215], v[76:79]
    ds_read_b128 v[164:167], v10 offset:5120
    ds_read_b128 v[168:171], v10 offset:6144
    v_mfma_f32_16x16x32_bf16 v[44:47], a[104:107], a[216:219], v[44:47]
    ds_read_b128 v[172:175], v10 offset:7168
    ds_read_b128 v[176:179], v10 offset:8192
    v_mfma_f32_16x16x32_bf16 v[80:83], a[108:111], a[216:219], v[80:83]
    ds_read_b128 v[180:183], v10 offset:9216
    ds_read_b128 v[184:187], v10 offset:10240
    v_mfma_f32_16x16x32_bf16 v[48:51], a[104:107], a[220:223], v[48:51]
    ds_read_b128 v[188:191], v10 offset:11264
    v_mfma_f32_16x16x32_bf16 v[84:87], a[108:111], a[220:223], v[84:87]
    s_waitcnt lgkmcnt(15)
    v_mfma_f32_16x16x32_bf16 v[20:23], a[112:115], a[160:163], v[20:23]
    s_barrier
    v_mfma_f32_16x16x32_bf16 v[56:59], a[116:119], a[160:163], v[56:59]
    ds_read_b128 a[192:195], v13 offset:57344
    v_mfma_f32_16x16x32_bf16 v[24:27], a[112:115], a[164:167], v[24:27]
    ds_read_b128 a[196:199], v13 offset:58368
    v_mfma_f32_16x16x32_bf16 v[60:63], a[116:119], a[164:167], v[60:63]
    v_mfma_f32_16x16x32_bf16 v[28:31], a[112:115], a[168:171], v[28:31]
    ds_read_b128 a[200:203], v13 offset:59392
    ds_read_b128 v[192:195], v10 offset:12288
    v_mfma_f32_16x16x32_bf16 v[64:67], a[116:119], a[168:171], v[64:67]
    v_mfma_f32_16x16x32_bf16 v[32:35], a[112:115], a[172:175], v[32:35]
    ds_read_b128 a[204:207], v13 offset:60416
    ds_read_b128 v[196:199], v10 offset:13312
    v_mfma_f32_16x16x32_bf16 v[68:71], a[116:119], a[172:175], v[68:71]
    ds_read_b128 a[208:211], v13 offset:61440
    s_waitcnt lgkmcnt(15)
    v_mfma_f32_16x16x32_bf16 v[36:39], a[112:115], a[176:179], v[36:39]
    ds_read_b128 a[212:215], v13 offset:62464
    ds_read_b128 v[200:203], v10 offset:14336
    v_mfma_f32_16x16x32_bf16 v[72:75], a[116:119], a[176:179], v[72:75]
    ds_read_b128 a[216:219], v13 offset:63488
    ds_read_b128 v[204:207], v10 offset:15360
    v_mfma_f32_16x16x32_bf16 v[40:43], a[112:115], a[180:183], v[40:43]
    ds_read_b128 a[220:223], v13 offset:64512
    ds_read_b128 v[208:211], v10 offset:16384
    v_mfma_f32_16x16x32_bf16 v[76:79], a[116:119], a[180:183], v[76:79]
    ds_read_b128 v[212:215], v10 offset:17408
    ds_read_b128 v[216:219], v10 offset:18432
    v_mfma_f32_16x16x32_bf16 v[44:47], a[112:115], a[184:187], v[44:47]
    ds_read_b128 v[220:223], v10 offset:19456
    v_mfma_f32_16x16x32_bf16 v[80:83], a[116:119], a[184:187], v[80:83]
    v_mfma_f32_16x16x32_bf16 v[48:51], a[112:115], a[188:191], v[48:51]
    v_mfma_f32_16x16x32_bf16 v[84:87], a[116:119], a[188:191], v[84:87]
    s_waitcnt lgkmcnt(11)
    v_mfma_f32_16x16x32_bf16 v[20:23], a[120:123], a[192:195], v[20:23]
    v_mfma_f32_16x16x32_bf16 v[56:59], a[124:127], a[192:195], v[56:59]
    ds_read_b128 a[160:163], v12 offset:0
    v_mfma_f32_16x16x32_bf16 v[24:27], a[120:123], a[196:199], v[24:27]
    ds_read_b128 a[164:167], v12 offset:1024
    v_mfma_f32_16x16x32_bf16 v[60:63], a[124:127], a[196:199], v[60:63]
    v_mfma_f32_16x16x32_bf16 v[28:31], a[120:123], a[200:203], v[28:31]
    ds_read_b128 a[168:171], v12 offset:2048
    v_mfma_f32_16x16x32_bf16 v[64:67], a[124:127], a[200:203], v[64:67]
    v_mfma_f32_16x16x32_bf16 v[32:35], a[120:123], a[204:207], v[32:35]
    ds_read_b128 a[172:175], v12 offset:3072
    v_mfma_f32_16x16x32_bf16 v[68:71], a[124:127], a[204:207], v[68:71]
    ds_read_b128 a[176:179], v12 offset:4096
    s_waitcnt lgkmcnt(9)
    v_mfma_f32_16x16x32_bf16 v[36:39], a[120:123], a[208:211], v[36:39]
    ds_read_b128 a[180:183], v12 offset:5120
    v_mfma_f32_16x16x32_bf16 v[72:75], a[124:127], a[208:211], v[72:75]
    ds_read_b128 a[184:187], v12 offset:6144
    v_mfma_f32_16x16x32_bf16 v[40:43], a[120:123], a[212:215], v[40:43]
    ds_read_b128 a[188:191], v12 offset:7168
    v_mfma_f32_16x16x32_bf16 v[76:79], a[124:127], a[212:215], v[76:79]
    v_mfma_f32_16x16x32_bf16 v[44:47], a[120:123], a[216:219], v[44:47]
    v_mfma_f32_16x16x32_bf16 v[80:83], a[124:127], a[216:219], v[80:83]
    v_mfma_f32_16x16x32_bf16 v[48:51], a[120:123], a[220:223], v[48:51]
    v_mfma_f32_16x16x32_bf16 v[84:87], a[124:127], a[220:223], v[84:87]
    s_waitcnt lgkmcnt(4)
    v_mfma_f32_16x16x32_bf16 v[20:23], a[128:131], a[160:163], v[20:23]
    s_barrier
    v_mfma_f32_16x16x32_bf16 v[56:59], a[132:135], a[160:163], v[56:59]
    ds_read_b128 a[192:195], v12 offset:8192
    v_mfma_f32_16x16x32_bf16 v[24:27], a[128:131], a[164:167], v[24:27]
    ds_read_b128 a[196:199], v12 offset:9216
    v_mfma_f32_16x16x32_bf16 v[60:63], a[132:135], a[164:167], v[60:63]
    v_mfma_f32_16x16x32_bf16 v[28:31], a[128:131], a[168:171], v[28:31]
    ds_read_b128 a[200:203], v12 offset:10240
    v_mfma_f32_16x16x32_bf16 v[64:67], a[132:135], a[168:171], v[64:67]
    v_mfma_f32_16x16x32_bf16 v[32:35], a[128:131], a[172:175], v[32:35]
    ds_read_b128 a[204:207], v12 offset:11264
    v_mfma_f32_16x16x32_bf16 v[68:71], a[132:135], a[172:175], v[68:71]
    ds_read_b128 a[208:211], v12 offset:12288
    s_waitcnt lgkmcnt(5)
    v_mfma_f32_16x16x32_bf16 v[36:39], a[128:131], a[176:179], v[36:39]
    ds_read_b128 a[212:215], v12 offset:13312
    v_mfma_f32_16x16x32_bf16 v[72:75], a[132:135], a[176:179], v[72:75]
    ds_read_b128 a[216:219], v12 offset:14336
    v_mfma_f32_16x16x32_bf16 v[40:43], a[128:131], a[180:183], v[40:43]
    ds_read_b128 a[220:223], v12 offset:15360
    v_mfma_f32_16x16x32_bf16 v[76:79], a[132:135], a[180:183], v[76:79]
    v_mfma_f32_16x16x32_bf16 v[44:47], a[128:131], a[184:187], v[44:47]
    v_mfma_f32_16x16x32_bf16 v[80:83], a[132:135], a[184:187], v[80:83]
    v_mfma_f32_16x16x32_bf16 v[48:51], a[128:131], a[188:191], v[48:51]
    v_mfma_f32_16x16x32_bf16 v[84:87], a[132:135], a[188:191], v[84:87]
    s_waitcnt lgkmcnt(4)
    v_mfma_f32_16x16x32_bf16 v[20:23], a[136:139], a[192:195], v[20:23]
    v_mfma_f32_16x16x32_bf16 v[56:59], a[140:143], a[192:195], v[56:59]
    ds_read_b128 a[160:163], v12 offset:16384
    v_mfma_f32_16x16x32_bf16 v[24:27], a[136:139], a[196:199], v[24:27]
    ds_read_b128 a[164:167], v12 offset:17408
    v_mfma_f32_16x16x32_bf16 v[60:63], a[140:143], a[196:199], v[60:63]
    v_mfma_f32_16x16x32_bf16 v[28:31], a[136:139], a[200:203], v[28:31]
    ds_read_b128 a[168:171], v12 offset:18432
    v_mfma_f32_16x16x32_bf16 v[64:67], a[140:143], a[200:203], v[64:67]
    v_mfma_f32_16x16x32_bf16 v[32:35], a[136:139], a[204:207], v[32:35]
    ds_read_b128 a[172:175], v12 offset:19456
    v_mfma_f32_16x16x32_bf16 v[68:71], a[140:143], a[204:207], v[68:71]
    ds_read_b128 a[176:179], v12 offset:20480
    s_waitcnt lgkmcnt(5)
    v_mfma_f32_16x16x32_bf16 v[36:39], a[136:139], a[208:211], v[36:39]
    ds_read_b128 a[180:183], v12 offset:21504
    v_mfma_f32_16x16x32_bf16 v[72:75], a[140:143], a[208:211], v[72:75]
    ds_read_b128 a[184:187], v12 offset:22528
    v_mfma_f32_16x16x32_bf16 v[40:43], a[136:139], a[212:215], v[40:43]
    ds_read_b128 a[188:191], v12 offset:23552
    v_mfma_f32_16x16x32_bf16 v[76:79], a[140:143], a[212:215], v[76:79]
    v_mfma_f32_16x16x32_bf16 v[44:47], a[136:139], a[216:219], v[44:47]
    v_mfma_f32_16x16x32_bf16 v[80:83], a[140:143], a[216:219], v[80:83]
    v_mfma_f32_16x16x32_bf16 v[48:51], a[136:139], a[220:223], v[48:51]
    v_mfma_f32_16x16x32_bf16 v[84:87], a[140:143], a[220:223], v[84:87]
    s_waitcnt lgkmcnt(4)
    v_mfma_f32_16x16x32_bf16 v[20:23], a[144:147], a[160:163], v[20:23]
    s_waitcnt vmcnt(0)
    s_barrier
    v_mfma_f32_16x16x32_bf16 v[56:59], a[148:151], a[160:163], v[56:59]
    ds_read_b128 a[192:195], v12 offset:24576
    v_mfma_f32_16x16x32_bf16 v[24:27], a[144:147], a[164:167], v[24:27]
    ds_read_b128 a[196:199], v12 offset:25600
    v_mfma_f32_16x16x32_bf16 v[60:63], a[148:151], a[164:167], v[60:63]
    v_mfma_f32_16x16x32_bf16 v[28:31], a[144:147], a[168:171], v[28:31]
    ds_read_b128 a[200:203], v12 offset:26624
    v_mfma_f32_16x16x32_bf16 v[64:67], a[148:151], a[168:171], v[64:67]
    v_mfma_f32_16x16x32_bf16 v[32:35], a[144:147], a[172:175], v[32:35]
    ds_read_b128 a[204:207], v12 offset:27648
    v_mfma_f32_16x16x32_bf16 v[68:71], a[148:151], a[172:175], v[68:71]
    ds_read_b128 a[208:211], v12 offset:28672
    s_waitcnt lgkmcnt(5)
    v_mfma_f32_16x16x32_bf16 v[36:39], a[144:147], a[176:179], v[36:39]
    ds_read_b128 a[212:215], v12 offset:29696
    v_mfma_f32_16x16x32_bf16 v[72:75], a[148:151], a[176:179], v[72:75]
    ds_read_b128 a[216:219], v12 offset:30720
    v_mfma_f32_16x16x32_bf16 v[40:43], a[144:147], a[180:183], v[40:43]
    ds_read_b128 a[220:223], v12 offset:31744
    v_mfma_f32_16x16x32_bf16 v[76:79], a[148:151], a[180:183], v[76:79]
    v_mfma_f32_16x16x32_bf16 v[44:47], a[144:147], a[184:187], v[44:47]
    v_mfma_f32_16x16x32_bf16 v[80:83], a[148:151], a[184:187], v[80:83]
    v_mfma_f32_16x16x32_bf16 v[48:51], a[144:147], a[188:191], v[48:51]
    v_mfma_f32_16x16x32_bf16 v[84:87], a[148:151], a[188:191], v[84:87]
    s_waitcnt lgkmcnt(4)
    v_mfma_f32_16x16x32_bf16 v[20:23], a[152:155], a[192:195], v[20:23]
    v_mfma_f32_16x16x32_bf16 v[56:59], a[156:159], a[192:195], v[56:59]
    v_mfma_f32_16x16x32_bf16 v[24:27], a[152:155], a[196:199], v[24:27]
    v_mfma_f32_16x16x32_bf16 v[60:63], a[156:159], a[196:199], v[60:63]
    v_mfma_f32_16x16x32_bf16 v[28:31], a[152:155], a[200:203], v[28:31]
    v_mfma_f32_16x16x32_bf16 v[64:67], a[156:159], a[200:203], v[64:67]
    v_mfma_f32_16x16x32_bf16 v[32:35], a[152:155], a[204:207], v[32:35]
    v_mfma_f32_16x16x32_bf16 v[68:71], a[156:159], a[204:207], v[68:71]
    s_waitcnt lgkmcnt(0)
    v_mfma_f32_16x16x32_bf16 v[36:39], a[152:155], a[208:211], v[36:39]
    v_mfma_f32_16x16x32_bf16 v[72:75], a[156:159], a[208:211], v[72:75]
    v_mfma_f32_16x16x32_bf16 v[40:43], a[152:155], a[212:215], v[40:43]
    v_mfma_f32_16x16x32_bf16 v[76:79], a[156:159], a[212:215], v[76:79]
    v_mfma_f32_16x16x32_bf16 v[44:47], a[152:155], a[216:219], v[44:47]
    v_mfma_f32_16x16x32_bf16 v[80:83], a[156:159], a[216:219], v[80:83]
    v_mfma_f32_16x16x32_bf16 v[48:51], a[152:155], a[220:223], v[48:51]
    v_mfma_f32_16x16x32_bf16 v[84:87], a[156:159], a[220:223], v[84:87]
    s_mov_b32 s54, 0x4000
STCHK_59:
    v_cmp_ne_u32 vcc, s44, v90
    v_cmp_ne_u32 s[52:53], s44, v94
    s_nop 1
    s_or_b64 vcc, vcc, s[52:53]
    v_cmp_ne_u32 s[52:53], s44, v98
    s_nop 1
    s_or_b64 vcc, vcc, s[52:53]
    s_cbranch_vccz STOK_60
    buffer_load_dwordx3 v[88:90], v15, s[28:31], 0 offen sc1
    buffer_load_dwordx3 v[92:94], v11, s[28:31], 0 offen offset:1024 sc1
    buffer_load_dwordx3 v[96:98], v14, s[28:31], 0 offen sc1
    s_waitcnt vmcnt(0)
    s_sub_u32 s54, s54, 1
    s_cmp_lg_u32 s54, 0
    s_cbranch_scc1 STCHK_59
STOK_60:
    s_lshl_b32 s55, s3, 7
    s_add_u32 s55, s55, 153600
    v_lshl_add_u32 v11, v2, 3, s55
    s_movk_i32 s55, 512
    s_cmp_eq_u32 s3, 0
    s_cselect_b32 s55, 1024, s55
    v_add_u32 v14, s55, v11
    s_mov_b64 exec, 0xffff
    ds_write_b64 v11, v[88:89]
    ds_write_b64 v11, v[92:93] offset:512
    ds_write_b64 v14, v[96:97]
    s_mov_b64 exec, -1
    s_waitcnt lgkmcnt(0)
    s_barrier
    v_lshlrev_b32 v11, 3, v2
    v_add_u32 v11, 153600, v11
    ds_read_b64 v[92:93], v11 offset:128
    ds_read_b64 v[96:97], v11 offset:256
    ds_read_b64 v[100:101], v11 offset:384
    ds_read_b64 v[104:105], v11 offset:512
    ds_read_b64 v[108:109], v11 offset:640
    ds_read_b64 v[112:113], v11 offset:768
    ds_read_b64 v[116:117], v11 offset:896
    ds_read_b64 v[120:121], v11 offset:1024
    ds_read_b64 v[88:89], v11 offset:0
    v_mfma_f32_16x16x32_bf16 v[16:19], a[0:3], v[144:147], 0
    s_waitcnt lgkmcnt(8)
    v_fmac_f32 v20, v124, v92
    v_mfma_f32_16x16x32_bf16 v[52:55], a[4:7], v[144:147], 0
    v_fmac_f32 v21, v125, v92
    v_fmac_f32 v22, v126, v92
    v_mfma_f32_16x16x32_bf16 v[16:19], a[8:11], v[148:151], v[16:19]
    v_fmac_f32 v23, v127, v92
    v_mul_f32 v20, v20, v93
    v_mfma_f32_16x16x32_bf16 v[52:55], a[12:15], v[148:151], v[52:55]
    v_mul_f32 v21, v21, v93
    v_mul_f32 v22, v22, v93
    v_mfma_f32_16x16x32_bf16 v[16:19], a[16:19], v[152:155], v[16:19]
    v_mul_f32 v23, v23, v93
    v_cvt_pk_bf16_f32 v20, v20, v21
    v_mfma_f32_16x16x32_bf16 v[52:55], a[20:23], v[152:155], v[52:55]
    v_cvt_pk_bf16_f32 v21, v22, v23
    ds_write_b64 v242, v[20:21] offset:4352
    v_mfma_f32_16x16x32_bf16 v[16:19], a[24:27], v[156:159], v[16:19]
    v_fmac_f32 v56, v128, v92
    v_fmac_f32 v57, v129, v92
    v_mfma_f32_16x16x32_bf16 v[52:55], a[28:31], v[156:159], v[52:55]
    v_fmac_f32 v58, v130, v92
    v_fmac_f32 v59, v131, v92
    v_mfma_f32_16x16x32_bf16 v[16:19], a[32:35], v[160:163], v[16:19]
    v_mul_f32 v56, v56, v93
    v_mul_f32 v57, v57, v93
    v_mfma_f32_16x16x32_bf16 v[52:55], a[36:39], v[160:163], v[52:55]
    v_mul_f32 v58, v58, v93
    v_mul_f32 v59, v59, v93
    v_mfma_f32_16x16x32_bf16 v[16:19], a[40:43], v[164:167], v[16:19]
    v_cvt_pk_bf16_f32 v56, v56, v57
    v_cvt_pk_bf16_f32 v57, v58, v59
    v_mfma_f32_16x16x32_bf16 v[52:55], a[44:47], v[164:167], v[52:55]
    ds_write_b64 v242, v[56:57] offset:4384
    s_waitcnt lgkmcnt(9)
    v_mfma_f32_16x16x32_bf16 v[16:19], a[48:51], v[168:171], v[16:19]
    v_fmac_f32 v24, v124, v96
    v_fmac_f32 v25, v125, v96
    v_mfma_f32_16x16x32_bf16 v[52:55], a[52:55], v[168:171], v[52:55]
    v_fmac_f32 v26, v126, v96
    v_fmac_f32 v27, v127, v96
    v_mfma_f32_16x16x32_bf16 v[16:19], a[56:59], v[172:175], v[16:19]
    v_mul_f32 v24, v24, v97
    v_mul_f32 v25, v25, v97
    v_mfma_f32_16x16x32_bf16 v[52:55], a[60:63], v[172:175], v[52:55]
    v_mul_f32 v26, v26, v97
    v_mul_f32 v27, v27, v97
    v_mfma_f32_16x16x32_bf16 v[16:19], a[64:67], v[176:179], v[16:19]
    v_cvt_pk_bf16_f32 v24, v24, v25
    v_cvt_pk_bf16_f32 v25, v26, v27
    v_mfma_f32_16x16x32_bf16 v[52:55], a[68:71], v[176:179], v[52:55]
    ds_write_b64 v242, v[24:25] offset:8704
    v_fmac_f32 v60, v128, v96
    v_mfma_f32_16x16x32_bf16 v[16:19], a[72:75], v[180:183], v[16:19]
    v_fmac_f32 v61, v129, v96
    v_fmac_f32 v62, v130, v96
    v_mfma_f32_16x16x32_bf16 v[52:55], a[76:79], v[180:183], v[52:55]
    v_fmac_f32 v63, v131, v96
    v_mul_f32 v60, v60, v97
    v_mfma_f32_16x16x32_bf16 v[16:19], a[80:83], v[184:187], v[16:19]
    v_mul_f32 v61, v61, v97
    v_mul_f32 v62, v62, v97
    v_mfma_f32_16x16x32_bf16 v[52:55], a[84:87], v[184:187], v[52:55]
    v_mul_f32 v63, v63, v97
    v_cvt_pk_bf16_f32 v60, v60, v61
    v_mfma_f32_16x16x32_bf16 v[16:19], a[88:91], v[188:191], v[16:19]
    v_cvt_pk_bf16_f32 v61, v62, v63
    ds_write_b64 v242, v[60:61] offset:8736
    v_mfma_f32_16x16x32_bf16 v[52:55], a[92:95], v[188:191], v[52:55]
    s_waitcnt lgkmcnt(10)
    v_fmac_f32 v28, v124, v100
    v_mfma_f32_16x16x32_bf16 v[16:19], a[96:99], v[192:195], v[16:19]
    v_fmac_f32 v29, v125, v100
    v_fmac_f32 v30, v126, v100
    v_mfma_f32_16x16x32_bf16 v[52:55], a[100:103], v[192:195], v[52:55]
    v_fmac_f32 v31, v127, v100
    v_mul_f32 v28, v28, v101
    v_mfma_f32_16x16x32_bf16 v[16:19], a[104:107], v[196:199], v[16:19]
    v_mul_f32 v29, v29, v101
    v_mul_f32 v30, v30, v101
    v_mfma_f32_16x16x32_bf16 v[52:55], a[108:111], v[196:199], v[52:55]
    v_mul_f32 v31, v31, v101
    v_cvt_pk_bf16_f32 v28, v28, v29
    v_mfma_f32_16x16x32_bf16 v[16:19], a[112:115], v[200:203], v[16:19]
    v_cvt_pk_bf16_f32 v29, v30, v31
    ds_write_b64 v242, v[28:29] offset:13056
    v_mfma_f32_16x16x32_bf16 v[52:55], a[116:119], v[200:203], v[52:55]
    v_fmac_f32 v64, v128, v100
    v_fmac_f32 v65, v129, v100
    v_mfma_f32_16x16x32_bf16 v[16:19], a[120:123], v[204:207], v[16:19]
    v_fmac_f32 v66, v130, v100
    v_fmac_f32 v67, v131, v100
    v_mfma_f32_16x16x32_bf16 v[52:55], a[124:127], v[204:207], v[52:55]
    v_mul_f32 v64, v64, v101
    v_mul_f32 v65, v65, v101
    v_mfma_f32_16x16x32_bf16 v[16:19], a[128:131], v[208:211], v[16:19]
    v_mul_f32 v66, v66, v101
    v_mul_f32 v67, v67, v101
    v_mfma_f32_16x16x32_bf16 v[52:55], a[132:135], v[208:211], v[52:55]
    v_cvt_pk_bf16_f32 v64, v64, v65
    v_cvt_pk_bf16_f32 v65, v66, v67
    v_mfma_f32_16x16x32_bf16 v[16:19], a[136:139], v[212:215], v[16:19]
    ds_write_b64 v242, v[64:65] offset:13088
    s_waitcnt lgkmcnt(11)
    v_mfma_f32_16x16x32_bf16 v[52:55], a[140:143], v[212:215], v[52:55]
    v_fmac_f32 v32, v124, v104
    v_fmac_f32 v33, v125, v104
    v_mfma_f32_16x16x32_bf16 v[16:19], a[144:147], v[216:219], v[16:19]
    v_fmac_f32 v34, v126, v104
    v_fmac_f32 v35, v127, v104
    v_mfma_f32_16x16x32_bf16 v[52:55], a[148:151], v[216:219], v[52:55]
    v_mul_f32 v32, v32, v105
    v_mul_f32 v33, v33, v105
    v_mfma_f32_16x16x32_bf16 v[16:19], a[152:155], v[220:223], v[16:19]
    v_mul_f32 v34, v34, v105
    v_mul_f32 v35, v35, v105
    v_mfma_f32_16x16x32_bf16 v[52:55], a[156:159], v[220:223], v[52:55]
    v_cvt_pk_bf16_f32 v32, v32, v33
    v_cvt_pk_bf16_f32 v33, v34, v35
    ds_write_b64 v242, v[32:33] offset:17408
    v_fmac_f32 v68, v128, v104
    v_fmac_f32 v69, v129, v104
    v_fmac_f32 v70, v130, v104
    v_fmac_f32 v71, v131, v104
    v_mul_f32 v68, v68, v105
    v_mul_f32 v69, v69, v105
    v_mul_f32 v70, v70, v105
    v_mul_f32 v71, v71, v105
    v_cvt_pk_bf16_f32 v68, v68, v69
    v_cvt_pk_bf16_f32 v69, v70, v71
    ds_write_b64 v242, v[68:69] offset:17440
    s_waitcnt lgkmcnt(12)
    v_fmac_f32 v36, v124, v108
    v_fmac_f32 v37, v125, v108
    v_fmac_f32 v38, v126, v108
    v_fmac_f32 v39, v127, v108
    v_mul_f32 v36, v36, v109
    v_mul_f32 v37, v37, v109
    v_mul_f32 v38, v38, v109
    v_mul_f32 v39, v39, v109
    v_cvt_pk_bf16_f32 v36, v36, v37
    v_cvt_pk_bf16_f32 v37, v38, v39
    ds_write_b64 v242, v[36:37] offset:21760
    v_fmac_f32 v72, v128, v108
    v_fmac_f32 v73, v129, v108
    v_fmac_f32 v74, v130, v108
    v_fmac_f32 v75, v131, v108
    v_mul_f32 v72, v72, v109
    v_mul_f32 v73, v73, v109
    v_mul_f32 v74, v74, v109
    v_mul_f32 v75, v75, v109
    v_cvt_pk_bf16_f32 v72, v72, v73
    v_cvt_pk_bf16_f32 v73, v74, v75
    ds_write_b64 v242, v[72:73] offset:21792
    s_waitcnt lgkmcnt(13)
    v_pk_fma_f32 v[40:41], v[124:125], v[112:113], v[40:41] op_sel:[0,0,0] op_sel_hi:[1,0,1]
    v_pk_fma_f32 v[42:43], v[126:127], v[112:113], v[42:43] op_sel:[0,0,0] op_sel_hi:[1,0,1]
    v_pk_mul_f32 v[40:41], v[40:41], v[112:113] op_sel:[0,1] op_sel_hi:[1,1]
    v_pk_mul_f32 v[42:43], v[42:43], v[112:113] op_sel:[0,1] op_sel_hi:[1,1]
    v_cvt_pk_bf16_f32 v40, v40, v41
    v_cvt_pk_bf16_f32 v41, v42, v43
    ds_write_b64 v242, v[40:41] offset:26112
    s_mov_b32 s55, 0
    s_add_u32 m0, s63, 0
    s_nop 0
    buffer_load_dwordx4 v243, s[28:31], s55 offen offset:0 sc1 lds
    v_pk_fma_f32 v[76:77], v[128:129], v[112:113], v[76:77] op_sel:[0,0,0] op_sel_hi:[1,0,1]
    v_pk_fma_f32 v[78:79], v[130:131], v[112:113], v[78:79] op_sel:[0,0,0] op_sel_hi:[1,0,1]
    v_pk_mul_f32 v[76:77], v[76:77], v[112:113] op_sel:[0,1] op_sel_hi:[1,1]
    v_pk_mul_f32 v[78:79], v[78:79], v[112:113] op_sel:[0,1] op_sel_hi:[1,1]
    v_cvt_pk_bf16_f32 v76, v76, v77
    v_cvt_pk_bf16_f32 v77, v78, v79
    ds_write_b64 v242, v[76:77] offset:26144
    buffer_load_dwordx4 v243, s[28:31], s55 offen offset:1024 sc1 lds
    s_waitcnt lgkmcnt(14)
    v_pk_fma_f32 v[44:45], v[124:125], v[116:117], v[44:45] op_sel:[0,0,0] op_sel_hi:[1,0,1]
    v_pk_fma_f32 v[46:47], v[126:127], v[116:117], v[46:47] op_sel:[0,0,0] op_sel_hi:[1,0,1]
    v_pk_mul_f32 v[44:45], v[44:45], v[116:117] op_sel:[0,1] op_sel_hi:[1,1]
    v_pk_mul_f32 v[46:47], v[46:47], v[116:117] op_sel:[0,1] op_sel_hi:[1,1]
    v_cvt_pk_bf16_f32 v44, v44, v45
    v_cvt_pk_bf16_f32 v45, v46, v47
    ds_write_b64 v242, v[44:45] offset:30464
    buffer_load_dwordx4 v243, s[28:31], s55 offen offset:2048 sc1 lds
    v_pk_fma_f32 v[80:81], v[128:129], v[116:117], v[80:81] op_sel:[0,0,0] op_sel_hi:[1,0,1]
    v_pk_fma_f32 v[82:83], v[130:131], v[116:117], v[82:83] op_sel:[0,0,0] op_sel_hi:[1,0,1]
    v_pk_mul_f32 v[80:81], v[80:81], v[116:117] op_sel:[0,1] op_sel_hi:[1,1]
    v_pk_mul_f32 v[82:83], v[82:83], v[116:117] op_sel:[0,1] op_sel_hi:[1,1]
    v_cvt_pk_bf16_f32 v80, v80, v81
    v_cvt_pk_bf16_f32 v81, v82, v83
    ds_write_b64 v242, v[80:81] offset:30496
    buffer_load_dwordx4 v243, s[28:31], s55 offen offset:3072 sc1 lds
    s_waitcnt lgkmcnt(15)
    v_pk_fma_f32 v[48:49], v[124:125], v[120:121], v[48:49] op_sel:[0,0,0] op_sel_hi:[1,0,1]
    v_pk_fma_f32 v[50:51], v[126:127], v[120:121], v[50:51] op_sel:[0,0,0] op_sel_hi:[1,0,1]
    v_pk_mul_f32 v[48:49], v[48:49], v[120:121] op_sel:[0,1] op_sel_hi:[1,1]
    v_pk_mul_f32 v[50:51], v[50:51], v[120:121] op_sel:[0,1] op_sel_hi:[1,1]
    v_cvt_pk_bf16_f32 v48, v48, v49
    v_cvt_pk_bf16_f32 v49, v50, v51
    ds_write_b64 v242, v[48:49] offset:34816
    s_mov_b32 s55, 4096
    s_add_u32 m0, s63, 4096
    s_nop 0
    buffer_load_dwordx4 v243, s[28:31], s55 offen offset:0 sc1 lds
    v_pk_fma_f32 v[84:85], v[128:129], v[120:121], v[84:85] op_sel:[0,0,0] op_sel_hi:[1,0,1]
    v_pk_fma_f32 v[86:87], v[130:131], v[120:121], v[86:87] op_sel:[0,0,0] op_sel_hi:[1,0,1]
    v_pk_mul_f32 v[84:85], v[84:85], v[120:121] op_sel:[0,1] op_sel_hi:[1,1]
    v_pk_mul_f32 v[86:87], v[86:87], v[120:121] op_sel:[0,1] op_sel_hi:[1,1]
    v_cvt_pk_bf16_f32 v84, v84, v85
    v_cvt_pk_bf16_f32 v85, v86, v87
    ds_write_b64 v242, v[84:85] offset:34848
    s_mov_b32 s55, 40960
    s_add_u32 m0, s63, 5120
    s_nop 0
    buffer_load_dwordx4 v243, s[28:31], s55 offen offset:0 sc1 lds
    s_waitcnt lgkmcnt(15)
    v_pk_fma_f32 v[16:17], v[124:125], v[88:89], v[16:17] op_sel:[0,0,0] op_sel_hi:[1,0,1]
    v_pk_fma_f32 v[18:19], v[126:127], v[88:89], v[18:19] op_sel:[0,0,0] op_sel_hi:[1,0,1]
    v_pk_mul_f32 v[16:17], v[16:17], v[88:89] op_sel:[0,1] op_sel_hi:[1,1]
    v_pk_mul_f32 v[18:19], v[18:19], v[88:89] op_sel:[0,1] op_sel_hi:[1,1]
    v_cvt_pk_bf16_f32 v16, v16, v17
    v_cvt_pk_bf16_f32 v17, v18, v19
    ds_write_b64 v242, v[16:17] offset:0
    buffer_load_dwordx4 v243, s[28:31], s55 offen offset:1024 sc1 lds
    v_pk_fma_f32 v[52:53], v[128:129], v[88:89], v[52:53] op_sel:[0,0,0] op_sel_hi:[1,0,1]
    v_pk_fma_f32 v[54:55], v[130:131], v[88:89], v[54:55] op_sel:[0,0,0] op_sel_hi:[1,0,1]
    v_pk_mul_f32 v[52:53], v[52:53], v[88:89] op_sel:[0,1] op_sel_hi:[1,1]
    v_pk_mul_f32 v[54:55], v[54:55], v[88:89] op_sel:[0,1] op_sel_hi:[1,1]
    v_cvt_pk_bf16_f32 v52, v52, v53
    v_cvt_pk_bf16_f32 v53, v54, v55
    ds_write_b64 v242, v[52:53] offset:32
    buffer_load_dwordx4 v243, s[28:31], s55 offen offset:2048 sc1 lds
    s_waitcnt lgkmcnt(0)
    s_barrier
    ds_read_b64 v[164:165], v237 offset:64
    ds_read_b64 v[166:167], v236 offset:144
    ds_read_b64 v[168:169], v237 offset:96
    ds_read_b64 v[170:171], v236 offset:152
    ds_read_b64 v[172:173], v237 offset:4416
    ds_read_b64 v[174:175], v236 offset:4496
    ds_read_b64 v[176:177], v237 offset:4448
    ds_read_b64 v[178:179], v236 offset:4504
    ds_read_b64 v[180:181], v237 offset:8768
    ds_read_b64 v[182:183], v236 offset:8848
    ds_read_b64 v[184:185], v237 offset:8800
    ds_read_b64 v[186:187], v236 offset:8856
    ds_read_b64 v[188:189], v237 offset:4352
    ds_read_b64 v[190:191], v238 offset:4352
    ds_read_b64 v[192:193], v237 offset:4384
    ds_read_b64 v[194:195], v238 offset:4360
    ds_read_b64 v[196:197], v237 offset:8704
    ds_read_b64 v[198:199], v238 offset:8704
    ds_read_b64 v[200:201], v237 offset:8736
    ds_read_b64 v[202:203], v238 offset:8712
    ds_read_b64_tr_b16 v[204:205], v239 offset:160
    ds_read_b64_tr_b16 v[210:211], v239 offset:192
    ds_read_b64_tr_b16 v[216:217], v239 offset:224
    ds_read_b64_tr_b16 v[206:207], v239 offset:4512
    ds_read_b64_tr_b16 v[212:213], v239 offset:4544
    ds_read_b64_tr_b16 v[218:219], v239 offset:4576
    ds_read_b64_tr_b16 v[208:209], v239 offset:8864
    ds_read_b64_tr_b16 v[214:215], v239 offset:8896
    ds_read_b64_tr_b16 v[220:221], v239 offset:8928
    s_waitcnt lgkmcnt(9)
    v_mfma_f32_16x16x32_bf16 v[16:19], v[164:167], v[188:191], v[232:235]
    v_mfma_f32_16x16x32_bf16 v[20:23], v[172:175], v[188:191], v[224:227]
    v_mfma_f32_16x16x32_bf16 v[24:27], v[168:171], v[192:195], v[232:235]
    v_mfma_f32_16x16x32_bf16 v[28:31], v[176:179], v[192:195], v[224:227]
    v_mfma_f32_16x16x32_bf16 v[32:35], v[172:175], v[196:199], v[228:231]
    v_mfma_f32_16x16x32_bf16 v[36:39], v[180:183], v[196:199], v[224:227]
    v_mfma_f32_16x16x32_bf16 v[40:43], v[176:179], v[200:203], v[228:231]
    v_mfma_f32_16x16x32_bf16 v[44:47], v[184:187], v[200:203], v[224:227]
    s_nop 0
    v_max3_f32 v48, v16, v17, v18
    v_max3_f32 v48, v48, v19, v20
    v_max3_f32 v48, v48, v21, v22
    v_max_f32 v48, v48, v23
    buffer_load_dwordx4 v243, s[28:31], s55 offen offset:3072 sc1 lds
    v_max3_f32 v52, v24, v25, v26
    v_max3_f32 v52, v52, v27, v28
    v_max3_f32 v52, v52, v29, v30
    v_max_f32 v52, v52, v31
    s_mov_b32 s55, 45056
    s_add_u32 m0, s63, 9216
    s_nop 0
    buffer_load_dwordx4 v243, s[28:31], s55 offen offset:0 sc1 lds
    v_max3_f32 v56, v32, v33, v34
    v_max3_f32 v56, v56, v35, v36
    v_max3_f32 v56, v56, v37, v38
    v_max_f32 v56, v56, v39
    s_mov_b32 s55, 81920
    s_add_u32 m0, s63, 10240
    s_nop 0
    buffer_load_dwordx4 v243, s[28:31], s55 offen offset:0 sc1 lds
    v_max3_f32 v60, v40, v41, v42
    v_max3_f32 v60, v60, v43, v44
    v_max3_f32 v60, v60, v45, v46
    v_max_f32 v60, v60, v47
    buffer_load_dwordx4 v243, s[28:31], s55 offen offset:1024 sc1 lds
    v_mov_b32 v49, v48
    v_mov_b32 v53, v52
    v_mov_b32 v57, v56
    v_mov_b32 v61, v60
    v_permlane16_swap_b32 v48, v49
    v_permlane16_swap_b32 v52, v53
    v_permlane16_swap_b32 v56, v57
    v_permlane16_swap_b32 v60, v61
    v_max_f32 v48, v48, v49
    v_max_f32 v52, v52, v53
    v_max_f32 v56, v56, v57
    v_max_f32 v60, v60, v61
    v_mov_b32 v49, v48
    v_mov_b32 v53, v52
    v_mov_b32 v57, v56
    v_mov_b32 v61, v60
    v_permlane32_swap_b32 v48, v49
    v_permlane32_swap_b32 v52, v53
    v_permlane32_swap_b32 v56, v57
    v_permlane32_swap_b32 v60, v61
    v_max_f32 v48, v48, v49
    v_max_f32 v52, v52, v53
    v_max_f32 v56, v56, v57
    v_max_f32 v60, v60, v61
    s_mov_b32 s50, 0x3ea52b5c
    v_mov_b32 v64, s50
    v_mul_f32 v48, s50, v48
    v_mul_f32 v52, s50, v52
    v_mul_f32 v56, s50, v56
    v_mul_f32 v60, s50, v60
    v_pk_fma_f32 v[16:17], v[16:17], v[64:65], v[48:49] op_sel_hi:[1,0,0] neg_lo:[0,0,1] neg_hi:[0,0,1]
    v_pk_fma_f32 v[18:19], v[18:19], v[64:65], v[48:49] op_sel_hi:[1,0,0] neg_lo:[0,0,1] neg_hi:[0,0,1]
    v_pk_fma_f32 v[20:21], v[20:21], v[64:65], v[48:49] op_sel_hi:[1,0,0] neg_lo:[0,0,1] neg_hi:[0,0,1]
    v_pk_fma_f32 v[22:23], v[22:23], v[64:65], v[48:49] op_sel_hi:[1,0,0] neg_lo:[0,0,1] neg_hi:[0,0,1]
    v_pk_fma_f32 v[24:25], v[24:25], v[64:65], v[52:53] op_sel_hi:[1,0,0] neg_lo:[0,0,1] neg_hi:[0,0,1]
    v_pk_fma_f32 v[26:27], v[26:27], v[64:65], v[52:53] op_sel_hi:[1,0,0] neg_lo:[0,0,1] neg_hi:[0,0,1]
    v_pk_fma_f32 v[28:29], v[28:29], v[64:65], v[52:53] op_sel_hi:[1,0,0] neg_lo:[0,0,1] neg_hi:[0,0,1]
    v_pk_fma_f32 v[30:31], v[30:31], v[64:65], v[52:53] op_sel_hi:[1,0,0] neg_lo:[0,0,1] neg_hi:[0,0,1]
    v_pk_fma_f32 v[32:33], v[32:33], v[64:65], v[56:57] op_sel_hi:[1,0,0] neg_lo:[0,0,1] neg_hi:[0,0,1]
    v_pk_fma_f32 v[34:35], v[34:35], v[64:65], v[56:57] op_sel_hi:[1,0,0] neg_lo:[0,0,1] neg_hi:[0,0,1]
    v_pk_fma_f32 v[36:37], v[36:37], v[64:65], v[56:57] op_sel_hi:[1,0,0] neg_lo:[0,0,1] neg_hi:[0,0,1]
    v_pk_fma_f32 v[38:39], v[38:39], v[64:65], v[56:57] op_sel_hi:[1,0,0] neg_lo:[0,0,1] neg_hi:[0,0,1]
    v_pk_fma_f32 v[40:41], v[40:41], v[64:65], v[60:61] op_sel_hi:[1,0,0] neg_lo:[0,0,1] neg_hi:[0,0,1]
    v_pk_fma_f32 v[42:43], v[42:43], v[64:65], v[60:61] op_sel_hi:[1,0,0] neg_lo:[0,0,1] neg_hi:[0,0,1]
    v_pk_fma_f32 v[44:45], v[44:45], v[64:65], v[60:61] op_sel_hi:[1,0,0] neg_lo:[0,0,1] neg_hi:[0,0,1]
    v_pk_fma_f32 v[46:47], v[46:47], v[64:65], v[60:61] op_sel_hi:[1,0,0] neg_lo:[0,0,1] neg_hi:[0,0,1]
    v_exp_f32 v16, v16
    v_exp_f32 v17, v17
    v_exp_f32 v18, v18
    v_exp_f32 v19, v19
    v_exp_f32 v20, v20
    v_exp_f32 v21, v21
    v_exp_f32 v22, v22
    v_exp_f32 v23, v23
    buffer_load_dwordx4 v243, s[28:31], s55 offen offset:2048 sc1 lds
    v_exp_f32 v24, v24
    v_exp_f32 v25, v25
    v_exp_f32 v26, v26
    v_exp_f32 v27, v27
    v_exp_f32 v28, v28
    v_exp_f32 v29, v29
    v_exp_f32 v30, v30
    v_exp_f32 v31, v31
    buffer_load_dwordx4 v243, s[28:31], s55 offen offset:3072 sc1 lds
    v_exp_f32 v32, v32
    v_exp_f32 v33, v33
    v_exp_f32 v34, v34
    v_exp_f32 v35, v35
    v_exp_f32 v36, v36
    v_exp_f32 v37, v37
    v_exp_f32 v38, v38
    v_exp_f32 v39, v39
    s_mov_b32 s55, 86016
    s_add_u32 m0, s63, 14336
    s_nop 0
    buffer_load_dwordx4 v243, s[28:31], s55 offen offset:0 sc1 lds
    v_exp_f32 v40, v40
    v_exp_f32 v41, v41
    v_exp_f32 v42, v42
    v_exp_f32 v43, v43
    v_exp_f32 v44, v44
    v_exp_f32 v45, v45
    v_exp_f32 v46, v46
    v_exp_f32 v47, v47
    s_mov_b32 s55, 122880
    s_add_u32 m0, s63, 15360
    s_nop 0
    buffer_load_dwordx4 v243, s[28:31], s55 offen offset:0 sc1 lds
    v_cvt_pk_bf16_f32 v68, v16, v17
    v_cvt_pk_bf16_f32 v69, v18, v19
    v_cvt_pk_bf16_f32 v70, v20, v21
    v_cvt_pk_bf16_f32 v71, v22, v23
    v_pk_add_f32 v[16:17], v[16:17], v[18:19]
    v_pk_add_f32 v[20:21], v[20:21], v[22:23]
    v_pk_add_f32 v[16:17], v[16:17], v[20:21]
    v_add_f32 v50, v16, v17
    buffer_load_dwordx4 v243, s[28:31], s55 offen offset:1024 sc1 lds
    v_cvt_pk_bf16_f32 v72, v24, v25
    v_cvt_pk_bf16_f32 v73, v26, v27
    v_cvt_pk_bf16_f32 v74, v28, v29
    v_cvt_pk_bf16_f32 v75, v30, v31
    v_pk_add_f32 v[24:25], v[24:25], v[26:27]
    v_pk_add_f32 v[28:29], v[28:29], v[30:31]
    v_pk_add_f32 v[24:25], v[24:25], v[28:29]
    v_add_f32 v54, v24, v25
    buffer_load_dwordx4 v243, s[28:31], s55 offen offset:2048 sc1 lds
    v_cvt_pk_bf16_f32 v76, v32, v33
    v_cvt_pk_bf16_f32 v77, v34, v35
    v_cvt_pk_bf16_f32 v78, v36, v37
    v_cvt_pk_bf16_f32 v79, v38, v39
    v_pk_add_f32 v[32:33], v[32:33], v[34:35]
    v_pk_add_f32 v[36:37], v[36:37], v[38:39]
    v_pk_add_f32 v[32:33], v[32:33], v[36:37]
    v_add_f32 v58, v32, v33
    buffer_load_dwordx4 v243, s[28:31], s55 offen offset:3072 sc1 lds
    v_cvt_pk_bf16_f32 v80, v40, v41
    v_cvt_pk_bf16_f32 v81, v42, v43
    v_cvt_pk_bf16_f32 v82, v44, v45
    v_cvt_pk_bf16_f32 v83, v46, v47
    v_pk_add_f32 v[40:41], v[40:41], v[42:43]
    v_pk_add_f32 v[44:45], v[44:45], v[46:47]
    v_pk_add_f32 v[40:41], v[40:41], v[44:45]
    v_add_f32 v62, v40, v41
    s_mov_b32 s55, 126976
    s_add_u32 m0, s63, 19456
    s_nop 0
    buffer_load_dwordx4 v243, s[28:31], s55 offen offset:0 sc1 lds
    s_waitcnt lgkmcnt(0)
    v_mfma_f32_16x16x32_bf16 v[88:91], v[204:207], v[68:71], 0
    v_mfma_f32_16x16x32_bf16 v[92:95], v[216:219], v[68:71], 0
    v_mfma_f32_16x16x32_bf16 v[96:99], v[210:213], v[72:75], 0
    v_mfma_f32_16x16x32_bf16 v[100:103], v[216:219], v[72:75], 0
    v_mfma_f32_16x16x32_bf16 v[104:107], v[206:209], v[76:79], 0
    v_mfma_f32_16x16x32_bf16 v[108:111], v[218:221], v[76:79], 0
    v_mfma_f32_16x16x32_bf16 v[112:115], v[212:215], v[80:83], 0
    v_mfma_f32_16x16x32_bf16 v[116:119], v[218:221], v[80:83], 0
    v_mov_b32 v51, v50
    v_mov_b32 v55, v54
    v_mov_b32 v59, v58
    v_mov_b32 v63, v62
    v_permlane16_swap_b32 v50, v51
    v_permlane16_swap_b32 v54, v55
    v_permlane16_swap_b32 v58, v59
    v_permlane16_swap_b32 v62, v63
    v_add_f32 v50, v50, v51
    v_add_f32 v54, v54, v55
    v_add_f32 v58, v58, v59
    v_add_f32 v62, v62, v63
    v_mov_b32 v51, v50
    v_mov_b32 v55, v54
    v_mov_b32 v59, v58
    v_mov_b32 v63, v62
    v_permlane32_swap_b32 v50, v51
    v_permlane32_swap_b32 v54, v55
    v_permlane32_swap_b32 v58, v59
    v_permlane32_swap_b32 v62, v63
    v_add_f32 v50, v50, v51
    v_add_f32 v54, v54, v55
    v_add_f32 v58, v58, v59
    v_add_f32 v62, v62, v63
    v_rcp_f32 v50, v50
    v_rcp_f32 v54, v54
    v_rcp_f32 v58, v58
    v_rcp_f32 v62, v62
    v_pk_mul_f32 v[88:89], v[88:89], v[50:51] op_sel_hi:[1,0]
    v_pk_mul_f32 v[90:91], v[90:91], v[50:51] op_sel_hi:[1,0]
    v_pk_mul_f32 v[92:93], v[92:93], v[50:51] op_sel_hi:[1,0]
    v_pk_mul_f32 v[94:95], v[94:95], v[50:51] op_sel_hi:[1,0]
    v_pk_mul_f32 v[96:97], v[96:97], v[54:55] op_sel_hi:[1,0]
    v_pk_mul_f32 v[98:99], v[98:99], v[54:55] op_sel_hi:[1,0]
    v_pk_mul_f32 v[100:101], v[100:101], v[54:55] op_sel_hi:[1,0]
    v_pk_mul_f32 v[102:103], v[102:103], v[54:55] op_sel_hi:[1,0]
    v_pk_mul_f32 v[104:105], v[104:105], v[58:59] op_sel_hi:[1,0]
    v_pk_mul_f32 v[106:107], v[106:107], v[58:59] op_sel_hi:[1,0]
    v_pk_mul_f32 v[108:109], v[108:109], v[58:59] op_sel_hi:[1,0]
    v_pk_mul_f32 v[110:111], v[110:111], v[58:59] op_sel_hi:[1,0]
    v_pk_mul_f32 v[112:113], v[112:113], v[62:63] op_sel_hi:[1,0]
    v_pk_mul_f32 v[114:115], v[114:115], v[62:63] op_sel_hi:[1,0]
    v_pk_mul_f32 v[116:117], v[116:117], v[62:63] op_sel_hi:[1,0]
    v_pk_mul_f32 v[118:119], v[118:119], v[62:63] op_sel_hi:[1,0]
    v_cvt_pk_bf16_f32 v16, v88, v89
    v_cvt_pk_bf16_f32 v17, v90, v91
    v_cvt_pk_bf16_f32 v18, v96, v97
    v_cvt_pk_bf16_f32 v19, v98, v99
    v_cvt_pk_bf16_f32 v20, v92, v93
    v_cvt_pk_bf16_f32 v21, v94, v95
    v_cvt_pk_bf16_f32 v24, v100, v101
    v_cvt_pk_bf16_f32 v25, v102, v103
    s_nop 0
    v_permlane16_swap_b32 v24, v22
    v_permlane16_swap_b32 v25, v23
    v_cvt_pk_bf16_f32 v28, v104, v105
    v_cvt_pk_bf16_f32 v29, v106, v107
    v_cvt_pk_bf16_f32 v30, v112, v113
    v_cvt_pk_bf16_f32 v31, v114, v115
    v_cvt_pk_bf16_f32 v32, v108, v109
    v_cvt_pk_bf16_f32 v33, v110, v111
    v_cvt_pk_bf16_f32 v36, v116, v117
    v_cvt_pk_bf16_f32 v37, v118, v119
    s_nop 0
    v_permlane16_swap_b32 v36, v34
    v_permlane16_swap_b32 v37, v35
    s_mov_b32 s55, 163840
    s_add_u32 m0, s63, 20480
    s_nop 0
    buffer_load_dwordx4 v243, s[28:31], s55 offen offset:0 sc1 lds
    buffer_load_dwordx4 v243, s[28:31], s55 offen offset:1024 sc1 lds
    buffer_load_dwordx4 v243, s[28:31], s55 offen offset:2048 sc1 lds
    buffer_load_dwordx4 v243, s[28:31], s55 offen offset:3072 sc1 lds
    s_mov_b32 s55, 167936
    s_add_u32 m0, s63, 24576
    s_nop 0
    buffer_load_dwordx4 v243, s[28:31], s55 offen offset:0 sc1 lds
    s_movk_i32 s55, 20480
    buffer_store_dwordx4 v[16:19], v240, s[28:31], 0 offen sc1
    buffer_store_dwordx4 v[28:31], v240, s[28:31], s55 offen sc1
    s_mov_b64 exec, 0xffff
    buffer_store_dwordx4 v[20:23], v241, s[28:31], 0 offen sc1
    buffer_store_dwordx4 v[32:35], v241, s[28:31], s55 offen sc1
    s_mov_b64 exec, -1
    s_lshl_b32 s58, s45, 4
    s_add_u32 s58, s58, s46
    s_waitcnt vmcnt(0)
    s_barrier
    s_cmp_lg_u32 s3, 0
    s_cbranch_scc1 NOFLAG_61
    s_lshl_b32 s49, s58, 2
    s_add_u32 s49, s49, 0xb41000
    v_mov_b32 v8, s49
    v_mov_b32 v9, s44
    s_mov_b64 exec, 1
    s_cmp_eq_u32 s67, 0
    s_cbranch_scc1 STG_63
    buffer_store_dword v9, v8, s[28:31], 0 offen
    s_branch STE_64
STG_63:
    buffer_store_dword v9, v8, s[28:31], 0 offen sc1
STE_64:
    s_mov_b64 exec, -1
    s_branch FLAGEND_62
NOFLAG_61:
    s_movk_i32 s57, 20480
    buffer_load_dword v252, v240, s[28:31], 0 offen sc1
    buffer_load_dword v252, v241, s[28:31], 0 offen sc1
    buffer_load_dword v252, v240, s[28:31], s57 offen sc1
    buffer_load_dword v252, v241, s[28:31], s57 offen sc1
    s_cmp_lg_u32 s3, 1
    s_cbranch_scc1 RBX_65
    v_subrev_u32 v253, 40960, v240
    v_subrev_u32 v254, 40960, v241
    buffer_load_dword v252, v253, s[28:31], 0 offen sc1
    buffer_load_dword v252, v254, s[28:31], 0 offen sc1
    buffer_load_dword v252, v253, s[28:31], s57 offen sc1
    buffer_load_dword v252, v254, s[28:31], s57 offen sc1
RBX_65:
FLAGEND_62:
    s_lshl_b32 s58, s47, 2
    s_add_u32 s58, s58, s3
    s_mul_i32 s59, s58, 20480
    s_mul_i32 s49, s48, 2560
    s_add_u32 s49, s49, s59
    v_lshlrev_b32 v8, 7, v3
    v_lshl_add_u32 v8, v2, 3, v8
    v_add_u32 v8, s49, v8
    s_add_u32 s49, s59, 0x1600000
    v_add_u32 v6, s49, v4
    v_mov_b32 v10, v4
    v_add_u32 v11, 61440, v4
    ds_read_b128 v[144:147], v10 offset:0
    ds_read_b128 v[148:151], v10 offset:1024
    ds_read_b128 v[152:155], v10 offset:2048
    ds_read_b128 v[156:159], v10 offset:3072
    ds_read_b128 v[160:163], v10 offset:4096
    ds_read_b128 v[164:167], v10 offset:5120
    ds_read_b128 v[168:171], v10 offset:6144
    ds_read_b128 v[172:175], v10 offset:7168
    ds_read_b128 v[176:179], v10 offset:8192
    ds_read_b128 v[180:183], v10 offset:9216
    s_mov_b32 s60, 0
    s_mov_b32 s61, 4096
    s_mov_b32 s62, 8192
    s_mov_b32 s63, 12288
    s_mov_b32 s64, 16384
    s_mov_b32 s52, 0xffff0000
    v_lshlrev_b32 v40, 16, v132
    v_and_b32 v41, s52, v132
    v_lshlrev_b32 v42, 16, v133
    v_and_b32 v43, s52, v133
    v_lshlrev_b32 v44, 16, v134
    v_and_b32 v45, s52, v134
    v_lshlrev_b32 v46, 16, v135
    v_and_b32 v47, s52, v135
    v_lshlrev_b32 v48, 16, v136
    v_and_b32 v49, s52, v136
    v_lshlrev_b32 v50, 16, v137
    v_and_b32 v51, s52, v137
    v_lshlrev_b32 v52, 16, v138
    v_and_b32 v53, s52, v138
    v_lshlrev_b32 v54, 16, v139
    v_and_b32 v55, s52, v139
    v_lshlrev_b32 v56, 16, v140
    v_and_b32 v57, s52, v140
    v_lshlrev_b32 v58, 16, v141
    v_and_b32 v59, s52, v141
    s_mov_b32 s32, s22
    s_mov_b32 s33, s23
    s_mov_b32 s34, 0x280000
    s_mov_b32 s35, 0x20000
    s_lshl_b32 s49, s58, 4
    v_add_u32 v12, s49, v2
    v_mul_u32_u24 v12, 1280, v12
    s_mul_i32 s49, s48, 160
    v_lshl_add_u32 v12, v3, 3, v12
    v_add_u32 v12, s49, v12
    s_lshr_b32 s54, s47, 1
    s_lshl_b32 s54, s54, 4
    s_cmp_lg_u32 s3, 0
    s_cbranch_scc1 POLLDONE_66
    s_lshl_b32 s49, s54, 2
    s_add_u32 s49, s49, 0xb41000
    v_add_u32 v240, 0, v1
    v_min_u32 v240, 15, v240
    v_lshl_add_u32 v240, v240, 2, s49
    s_mov_b32 s51, 0x8000
POLL_67:
    buffer_load_dword v241, v240, s[28:31], 0 offen sc1
    s_waitcnt vmcnt(0)
    v_cmp_ne_u32 vcc, s44, v241
    s_nop 1
    s_cbranch_vccz POLLDONE_66
    s_sleep 2
    s_sub_u32 s51, s51, 1
    s_cmp_lg_u32 s51, 0
    s_cbranch_scc1 POLL_67
POLLDONE_66:
    s_barrier
    buffer_load_dwordx4 a[160:163], v6, s[28:31], s60 offen offset:0 sc1
    buffer_load_dwordx4 a[164:167], v6, s[28:31], s60 offen offset:1024 sc1
    buffer_load_dwordx4 a[168:171], v6, s[28:31], s60 offen offset:2048 sc1
    buffer_load_dwordx4 a[172:175], v6, s[28:31], s60 offen offset:3072 sc1
    buffer_load_dwordx4 a[176:179], v6, s[28:31], s61 offen offset:0 sc1
    buffer_load_dwordx4 a[180:183], v6, s[28:31], s61 offen offset:1024 sc1
    buffer_load_dwordx4 a[184:187], v6, s[28:31], s61 offen offset:2048 sc1
    buffer_load_dwordx4 a[188:191], v6, s[28:31], s61 offen offset:3072 sc1
    buffer_load_dwordx4 a[192:195], v6, s[28:31], s62 offen offset:0 sc1
    buffer_load_dwordx4 a[196:199], v6, s[28:31], s62 offen offset:1024 sc1
    buffer_load_dwordx4 a[200:203], v6, s[28:31], s62 offen offset:2048 sc1
    buffer_load_dwordx4 a[204:207], v6, s[28:31], s62 offen offset:3072 sc1
    buffer_load_dwordx4 a[208:211], v6, s[28:31], s63 offen offset:0 sc1
    buffer_load_dwordx4 a[212:215], v6, s[28:31], s63 offen offset:1024 sc1
    buffer_load_dwordx4 a[216:219], v6, s[28:31], s63 offen offset:2048 sc1
    buffer_load_dwordx4 a[220:223], v6, s[28:31], s63 offen offset:3072 sc1
    buffer_load_dwordx4 a[224:227], v6, s[28:31], s64 offen offset:0 sc1
    buffer_load_dwordx4 a[228:231], v6, s[28:31], s64 offen offset:1024 sc1
    buffer_load_dwordx4 a[232:235], v6, s[28:31], s64 offen offset:2048 sc1
    buffer_load_dwordx4 a[236:239], v6, s[28:31], s64 offen offset:3072 sc1
    s_waitcnt lgkmcnt(0)
    s_waitcnt vmcnt(18)
    v_mfma_f32_16x16x32_bf16 v[40:43], v[144:147], a[160:163], v[40:43]
    ds_read_b128 v[184:187], v10 offset:10240
    v_mfma_f32_16x16x32_bf16 v[44:47], v[148:151], a[160:163], v[44:47]
    ds_read_b128 v[188:191], v10 offset:11264
    v_mfma_f32_16x16x32_bf16 v[48:51], v[152:155], a[160:163], v[48:51]
    ds_read_b128 v[192:195], v10 offset:12288
    v_mfma_f32_16x16x32_bf16 v[52:55], v[156:159], a[160:163], v[52:55]
    ds_read_b128 v[196:199], v10 offset:13312
    v_mfma_f32_16x16x32_bf16 v[56:59], v[160:163], a[160:163], v[56:59]
    ds_read_b128 v[200:203], v10 offset:14336
    v_mfma_f32_16x16x32_bf16 v[40:43], v[164:167], a[164:167], v[40:43]
    ds_read_b128 v[204:207], v10 offset:15360
    v_mfma_f32_16x16x32_bf16 v[44:47], v[168:171], a[164:167], v[44:47]
    ds_read_b128 v[208:211], v10 offset:16384
    v_mfma_f32_16x16x32_bf16 v[48:51], v[172:175], a[164:167], v[48:51]
    ds_read_b128 v[212:215], v10 offset:17408
    v_mfma_f32_16x16x32_bf16 v[52:55], v[176:179], a[164:167], v[52:55]
    ds_read_b128 v[216:219], v10 offset:18432
    v_mfma_f32_16x16x32_bf16 v[56:59], v[180:183], a[164:167], v[56:59]
    ds_read_b128 v[220:223], v10 offset:19456
    s_waitcnt lgkmcnt(0)
    s_waitcnt vmcnt(16)
    v_mfma_f32_16x16x32_bf16 v[40:43], v[184:187], a[168:171], v[40:43]
    ds_read_b128 v[144:147], v10 offset:20480
    v_mfma_f32_16x16x32_bf16 v[44:47], v[188:191], a[168:171], v[44:47]
    ds_read_b128 v[148:151], v10 offset:21504
    v_mfma_f32_16x16x32_bf16 v[48:51], v[192:195], a[168:171], v[48:51]
    ds_read_b128 v[152:155], v10 offset:22528
    v_mfma_f32_16x16x32_bf16 v[52:55], v[196:199], a[168:171], v[52:55]
    ds_read_b128 v[156:159], v10 offset:23552
    v_mfma_f32_16x16x32_bf16 v[56:59], v[200:203], a[168:171], v[56:59]
    ds_read_b128 v[160:163], v10 offset:24576
    v_mfma_f32_16x16x32_bf16 v[40:43], v[204:207], a[172:175], v[40:43]
    ds_read_b128 v[164:167], v10 offset:25600
    v_mfma_f32_16x16x32_bf16 v[44:47], v[208:211], a[172:175], v[44:47]
    ds_read_b128 v[168:171], v10 offset:26624
    v_mfma_f32_16x16x32_bf16 v[48:51], v[212:215], a[172:175], v[48:51]
    ds_read_b128 v[172:175], v10 offset:27648
    v_mfma_f32_16x16x32_bf16 v[52:55], v[216:219], a[172:175], v[52:55]
    ds_read_b128 v[176:179], v10 offset:28672
    v_mfma_f32_16x16x32_bf16 v[56:59], v[220:223], a[172:175], v[56:59]
    ds_read_b128 v[180:183], v10 offset:29696
    s_waitcnt lgkmcnt(0)
    s_waitcnt vmcnt(14)
    v_mfma_f32_16x16x32_bf16 v[40:43], v[144:147], a[176:179], v[40:43]
    ds_read_b128 v[184:187], v10 offset:30720
    v_mfma_f32_16x16x32_bf16 v[44:47], v[148:151], a[176:179], v[44:47]
    ds_read_b128 v[188:191], v10 offset:31744
    v_mfma_f32_16x16x32_bf16 v[48:51], v[152:155], a[176:179], v[48:51]
    ds_read_b128 v[192:195], v10 offset:32768
    v_mfma_f32_16x16x32_bf16 v[52:55], v[156:159], a[176:179], v[52:55]
    ds_read_b128 v[196:199], v10 offset:33792
    v_mfma_f32_16x16x32_bf16 v[56:59], v[160:163], a[176:179], v[56:59]
    ds_read_b128 v[200:203], v10 offset:34816
    v_mfma_f32_16x16x32_bf16 v[40:43], v[164:167], a[180:183], v[40:43]
    ds_read_b128 v[204:207], v10 offset:35840
    v_mfma_f32_16x16x32_bf16 v[44:47], v[168:171], a[180:183], v[44:47]
    ds_read_b128 v[208:211], v10 offset:36864
    v_mfma_f32_16x16x32_bf16 v[48:51], v[172:175], a[180:183], v[48:51]
    ds_read_b128 v[212:215], v10 offset:37888
    v_mfma_f32_16x16x32_bf16 v[52:55], v[176:179], a[180:183], v[52:55]
    ds_read_b128 v[216:219], v10 offset:38912
    v_mfma_f32_16x16x32_bf16 v[56:59], v[180:183], a[180:183], v[56:59]
    ds_read_b128 v[220:223], v10 offset:39936
    s_waitcnt lgkmcnt(0)
    s_waitcnt vmcnt(12)
    v_mfma_f32_16x16x32_bf16 v[40:43], v[184:187], a[184:187], v[40:43]
    ds_read_b128 v[144:147], v10 offset:40960
    v_mfma_f32_16x16x32_bf16 v[44:47], v[188:191], a[184:187], v[44:47]
    ds_read_b128 v[148:151], v10 offset:41984
    v_mfma_f32_16x16x32_bf16 v[48:51], v[192:195], a[184:187], v[48:51]
    ds_read_b128 v[152:155], v10 offset:43008
    v_mfma_f32_16x16x32_bf16 v[52:55], v[196:199], a[184:187], v[52:55]
    ds_read_b128 v[156:159], v10 offset:44032
    v_mfma_f32_16x16x32_bf16 v[56:59], v[200:203], a[184:187], v[56:59]
    ds_read_b128 v[160:163], v10 offset:45056
    v_mfma_f32_16x16x32_bf16 v[40:43], v[204:207], a[188:191], v[40:43]
    ds_read_b128 v[164:167], v10 offset:46080
    v_mfma_f32_16x16x32_bf16 v[44:47], v[208:211], a[188:191], v[44:47]
    ds_read_b128 v[168:171], v10 offset:47104
    v_mfma_f32_16x16x32_bf16 v[48:51], v[212:215], a[188:191], v[48:51]
    ds_read_b128 v[172:175], v10 offset:48128
    v_mfma_f32_16x16x32_bf16 v[52:55], v[216:219], a[188:191], v[52:55]
    ds_read_b128 v[176:179], v10 offset:49152
    v_mfma_f32_16x16x32_bf16 v[56:59], v[220:223], a[188:191], v[56:59]
    ds_read_b128 v[180:183], v10 offset:50176
    s_waitcnt lgkmcnt(0)
    s_waitcnt vmcnt(10)
    v_mfma_f32_16x16x32_bf16 v[40:43], v[144:147], a[192:195], v[40:43]
    ds_read_b128 v[184:187], v10 offset:51200
    v_mfma_f32_16x16x32_bf16 v[44:47], v[148:151], a[192:195], v[44:47]
    ds_read_b128 v[188:191], v10 offset:52224
    v_mfma_f32_16x16x32_bf16 v[48:51], v[152:155], a[192:195], v[48:51]
    ds_read_b128 v[192:195], v10 offset:53248
    v_mfma_f32_16x16x32_bf16 v[52:55], v[156:159], a[192:195], v[52:55]
    ds_read_b128 v[196:199], v10 offset:54272
    v_mfma_f32_16x16x32_bf16 v[56:59], v[160:163], a[192:195], v[56:59]
    ds_read_b128 v[200:203], v10 offset:55296
    v_mfma_f32_16x16x32_bf16 v[40:43], v[164:167], a[196:199], v[40:43]
    ds_read_b128 v[204:207], v10 offset:56320
    v_mfma_f32_16x16x32_bf16 v[44:47], v[168:171], a[196:199], v[44:47]
    ds_read_b128 v[208:211], v10 offset:57344
    v_mfma_f32_16x16x32_bf16 v[48:51], v[172:175], a[196:199], v[48:51]
    ds_read_b128 v[212:215], v10 offset:58368
    v_mfma_f32_16x16x32_bf16 v[52:55], v[176:179], a[196:199], v[52:55]
    ds_read_b128 v[216:219], v10 offset:59392
    v_mfma_f32_16x16x32_bf16 v[56:59], v[180:183], a[196:199], v[56:59]
    ds_read_b128 v[220:223], v10 offset:60416
    s_waitcnt lgkmcnt(0)
    s_waitcnt vmcnt(8)
    v_mfma_f32_16x16x32_bf16 v[40:43], v[184:187], a[200:203], v[40:43]
    ds_read_b128 v[144:147], v11 offset:0
    v_mfma_f32_16x16x32_bf16 v[44:47], v[188:191], a[200:203], v[44:47]
    ds_read_b128 v[148:151], v11 offset:1024
    v_mfma_f32_16x16x32_bf16 v[48:51], v[192:195], a[200:203], v[48:51]
    ds_read_b128 v[152:155], v11 offset:2048
    v_mfma_f32_16x16x32_bf16 v[52:55], v[196:199], a[200:203], v[52:55]
    ds_read_b128 v[156:159], v11 offset:3072
    v_mfma_f32_16x16x32_bf16 v[56:59], v[200:203], a[200:203], v[56:59]
    ds_read_b128 v[160:163], v11 offset:4096
    v_mfma_f32_16x16x32_bf16 v[40:43], v[204:207], a[204:207], v[40:43]
    ds_read_b128 v[164:167], v11 offset:5120
    v_mfma_f32_16x16x32_bf16 v[44:47], v[208:211], a[204:207], v[44:47]
    ds_read_b128 v[168:171], v11 offset:6144
    v_mfma_f32_16x16x32_bf16 v[48:51], v[212:215], a[204:207], v[48:51]
    ds_read_b128 v[172:175], v11 offset:7168
    v_mfma_f32_16x16x32_bf16 v[52:55], v[216:219], a[204:207], v[52:55]
    ds_read_b128 v[176:179], v11 offset:8192
    v_mfma_f32_16x16x32_bf16 v[56:59], v[220:223], a[204:207], v[56:59]
    ds_read_b128 v[180:183], v11 offset:9216
    s_waitcnt lgkmcnt(0)
    s_waitcnt vmcnt(6)
    v_mfma_f32_16x16x32_bf16 v[40:43], v[144:147], a[208:211], v[40:43]
    ds_read_b128 v[184:187], v11 offset:10240
    v_mfma_f32_16x16x32_bf16 v[44:47], v[148:151], a[208:211], v[44:47]
    ds_read_b128 v[188:191], v11 offset:11264
    v_mfma_f32_16x16x32_bf16 v[48:51], v[152:155], a[208:211], v[48:51]
    ds_read_b128 v[192:195], v11 offset:12288
    v_mfma_f32_16x16x32_bf16 v[52:55], v[156:159], a[208:211], v[52:55]
    ds_read_b128 v[196:199], v11 offset:13312
    v_mfma_f32_16x16x32_bf16 v[56:59], v[160:163], a[208:211], v[56:59]
    ds_read_b128 v[200:203], v11 offset:14336
    v_mfma_f32_16x16x32_bf16 v[40:43], v[164:167], a[212:215], v[40:43]
    ds_read_b128 v[204:207], v11 offset:15360
    v_mfma_f32_16x16x32_bf16 v[44:47], v[168:171], a[212:215], v[44:47]
    ds_read_b128 v[208:211], v11 offset:16384
    v_mfma_f32_16x16x32_bf16 v[48:51], v[172:175], a[212:215], v[48:51]
    ds_read_b128 v[212:215], v11 offset:17408
    v_mfma_f32_16x16x32_bf16 v[52:55], v[176:179], a[212:215], v[52:55]
    ds_read_b128 v[216:219], v11 offset:18432
    v_mfma_f32_16x16x32_bf16 v[56:59], v[180:183], a[212:215], v[56:59]
    ds_read_b128 v[220:223], v11 offset:19456
    s_waitcnt lgkmcnt(0)
    s_waitcnt vmcnt(4)
    v_mfma_f32_16x16x32_bf16 v[40:43], v[184:187], a[216:219], v[40:43]
    ds_read_b128 v[144:147], v11 offset:20480
    v_mfma_f32_16x16x32_bf16 v[44:47], v[188:191], a[216:219], v[44:47]
    ds_read_b128 v[148:151], v11 offset:21504
    v_mfma_f32_16x16x32_bf16 v[48:51], v[192:195], a[216:219], v[48:51]
    ds_read_b128 v[152:155], v11 offset:22528
    v_mfma_f32_16x16x32_bf16 v[52:55], v[196:199], a[216:219], v[52:55]
    ds_read_b128 v[156:159], v11 offset:23552
    v_mfma_f32_16x16x32_bf16 v[56:59], v[200:203], a[216:219], v[56:59]
    ds_read_b128 v[160:163], v11 offset:24576
    v_mfma_f32_16x16x32_bf16 v[40:43], v[204:207], a[220:223], v[40:43]
    ds_read_b128 v[164:167], v11 offset:25600
    v_mfma_f32_16x16x32_bf16 v[44:47], v[208:211], a[220:223], v[44:47]
    ds_read_b128 v[168:171], v11 offset:26624
    v_mfma_f32_16x16x32_bf16 v[48:51], v[212:215], a[220:223], v[48:51]
    ds_read_b128 v[172:175], v11 offset:27648
    v_mfma_f32_16x16x32_bf16 v[52:55], v[216:219], a[220:223], v[52:55]
    ds_read_b128 v[176:179], v11 offset:28672
    v_mfma_f32_16x16x32_bf16 v[56:59], v[220:223], a[220:223], v[56:59]
    ds_read_b128 v[180:183], v11 offset:29696
    s_waitcnt lgkmcnt(0)
    s_waitcnt vmcnt(2)
    v_mfma_f32_16x16x32_bf16 v[40:43], v[144:147], a[224:227], v[40:43]
    ds_read_b128 v[184:187], v11 offset:30720
    v_mfma_f32_16x16x32_bf16 v[44:47], v[148:151], a[224:227], v[44:47]
    ds_read_b128 v[188:191], v11 offset:31744
    v_mfma_f32_16x16x32_bf16 v[48:51], v[152:155], a[224:227], v[48:51]
    ds_read_b128 v[192:195], v11 offset:32768
    v_mfma_f32_16x16x32_bf16 v[52:55], v[156:159], a[224:227], v[52:55]
    ds_read_b128 v[196:199], v11 offset:33792
    v_mfma_f32_16x16x32_bf16 v[56:59], v[160:163], a[224:227], v[56:59]
    ds_read_b128 v[200:203], v11 offset:34816
    v_mfma_f32_16x16x32_bf16 v[40:43], v[164:167], a[228:231], v[40:43]
    ds_read_b128 v[204:207], v11 offset:35840
    v_mfma_f32_16x16x32_bf16 v[44:47], v[168:171], a[228:231], v[44:47]
    ds_read_b128 v[208:211], v11 offset:36864
    v_mfma_f32_16x16x32_bf16 v[48:51], v[172:175], a[228:231], v[48:51]
    ds_read_b128 v[212:215], v11 offset:37888
    v_mfma_f32_16x16x32_bf16 v[52:55], v[176:179], a[228:231], v[52:55]
    ds_read_b128 v[216:219], v11 offset:38912
    v_mfma_f32_16x16x32_bf16 v[56:59], v[180:183], a[228:231], v[56:59]
    ds_read_b128 v[220:223], v11 offset:39936
    s_waitcnt lgkmcnt(0)
    s_waitcnt vmcnt(0)
    v_mfma_f32_16x16x32_bf16 v[40:43], v[184:187], a[232:235], v[40:43]
    v_mfma_f32_16x16x32_bf16 v[44:47], v[188:191], a[232:235], v[44:47]
    v_mfma_f32_16x16x32_bf16 v[48:51], v[192:195], a[232:235], v[48:51]
    v_mfma_f32_16x16x32_bf16 v[52:55], v[196:199], a[232:235], v[52:55]
    v_mfma_f32_16x16x32_bf16 v[56:59], v[200:203], a[232:235], v[56:59]
    v_mfma_f32_16x16x32_bf16 v[40:43], v[204:207], a[236:239], v[40:43]
    v_mfma_f32_16x16x32_bf16 v[44:47], v[208:211], a[236:239], v[44:47]
    v_mfma_f32_16x16x32_bf16 v[48:51], v[212:215], a[236:239], v[48:51]
    v_mfma_f32_16x16x32_bf16 v[52:55], v[216:219], a[236:239], v[52:55]
    v_mfma_f32_16x16x32_bf16 v[56:59], v[220:223], a[236:239], v[56:59]
    s_nop 3
    v_cvt_pk_bf16_f32 v16, v40, v41
    v_cvt_pk_bf16_f32 v17, v42, v43
    v_cvt_pk_bf16_f32 v18, v44, v45
    v_cvt_pk_bf16_f32 v19, v46, v47
    v_cvt_pk_bf16_f32 v20, v48, v49
    v_cvt_pk_bf16_f32 v21, v50, v51
    v_cvt_pk_bf16_f32 v22, v52, v53
    v_cvt_pk_bf16_f32 v23, v54, v55
    v_cvt_pk_bf16_f32 v24, v56, v57
    v_cvt_pk_bf16_f32 v25, v58, v59
    buffer_store_dwordx2 v[16:17], v12, s[32:35], 0 offen offset:0
    buffer_store_dwordx2 v[18:19], v12, s[32:35], 0 offen offset:32
    buffer_store_dwordx2 v[20:21], v12, s[32:35], 0 offen offset:64
    buffer_store_dwordx2 v[22:23], v12, s[32:35], 0 offen offset:96
    buffer_store_dwordx2 v[24:25], v12, s[32:35], 0 offen offset:128
    s_or_b32 s49, s2, s3
    s_cmp_lg_u32 s49, 0
    s_cbranch_scc1 NONONCE_68
    v_mov_b32 v8, 0xb4c000
    v_mov_b32 v9, s44
    s_mov_b64 exec, 1
    buffer_store_dword v9, v8, s[28:31], 0 offen sc1
    s_mov_b64 exec, -1
NONONCE_68:
MEGA_END:
    s_endpgm
MEGA_LAST:
    s_endpgm
.section .rodata,"a"
.p2align 6
.amdhsa_kernel interleave_layers__ssm_conv_h3__sliding_local_dilated__prompt_kernel
  .amdhsa_next_free_vgpr 512
  .amdhsa_next_free_sgpr 102
  .amdhsa_accum_offset 256
  .amdhsa_group_segment_fixed_size 0
  .amdhsa_kernarg_size 96
  .amdhsa_user_sgpr_count 2
  .amdhsa_user_sgpr_kernarg_segment_ptr 1
  .amdhsa_system_sgpr_workgroup_id_x 1
  .amdhsa_float_denorm_mode_32 3
.end_amdhsa_kernel
```
